```python
import torch

def _softmax(x, axis=-1):
    return torch.softmax(x, dim=axis)
def _gelu(x):
    return torch.nn.functional.gelu(x, approximate="tanh")
def _silu(x):
    return torch.nn.functional.silu(x)
def _sigmoid(x):
    return torch.sigmoid(x)
def _layernorm(x, axis=-1, eps=1e-5):
    m = x.mean(dim=axis, keepdim=True)
    v = x.var(dim=axis, keepdim=True, unbiased=False)
    return (x - m) / torch.sqrt(v + eps)
def _scatter_add(tgt, idx, src, axis=0):
    return tgt.clone().index_add_(axis, idx, src)
def _segment_sum(src, seg, n):
    out = torch.zeros((n,) + src.shape[1:], dtype=src.dtype)
    return out.index_add_(0, seg, src)
def _pad(x, pw):
    flat = tuple(v for pair in reversed(pw) for v in pair)
    return torch.nn.functional.pad(x, flat)

kernel_name = 'parallel_sum__linear_kernel_hedgehog__mixer_token_mlp__prompt'

def setup_inputs():

    _w = (lambda a: (lambda t: t.to(torch.bfloat16) if t.is_floating_point() else t)(torch.as_tensor(a)))
    def _A_setup():
        B, S, D, H = 1, 2048, 640, 32
        Dh = D // H
        return {
            "x": _w((lambda *s: torch.randn(*s, dtype=torch.bfloat16) * 0.05)(B, S, D)),
            "wqkv": _w((lambda *s: torch.randn(*s, dtype=torch.bfloat16) * 0.2)(D, 3 * D)),
            "w_phi": _w((lambda *s: torch.randn(*s, dtype=torch.bfloat16) * 0.2)(H, Dh, Dh) * (Dh ** -0.5)),
            "wo": _w((lambda *s: torch.randn(*s, dtype=torch.bfloat16) * 0.05)(D, D)),
        }
    _A_in = _A_setup()

    def _B_setup():
        B, S, D, F = 1, 2048, 640, 1728
        return {
            "x": _w((lambda *s: torch.randn(*s, dtype=torch.bfloat16) * 0.05)(B, S, D)),
            "w1": _w((lambda *s: torch.randn(*s, dtype=torch.bfloat16) * 0.8)(S, F) * (S ** -0.5)),
            "b1": _w((lambda *s: torch.randn(*s, dtype=torch.bfloat16) * 12.8)(F) * 0.02),
            "w2": _w((lambda *s: torch.randn(*s, dtype=torch.bfloat16) * 0.1)(F, S) * (F ** -0.5)),
            "b2": _w((lambda *s: torch.randn(*s, dtype=torch.bfloat16) * 1.6)(S) * 0.02),
        }
    _B_in = _B_setup()

    return {
        "A_x": _A_in["x"],
        "A_wqkv": _A_in["wqkv"],
        "A_w_phi": _A_in["w_phi"],
        "A_wo": _A_in["wo"],
        "B_x": _B_in["x"],
        "B_w1": _B_in["w1"],
        "B_b1": _B_in["b1"],
        "B_w2": _B_in["w2"],
        "B_b2": _B_in["b2"],
    }

def reference(A_x, A_wqkv, A_w_phi, A_wo, B_x, B_w1, B_b1, B_w2, B_b2):
    def _A_ref(x, wqkv, w_phi, wo):
        B, S, D = x.shape
        H = 32; Dh = D // H
        qkv = (lambda x, *d: x.permute(*d))((x @ wqkv).reshape(B, S, 3, H, Dh), 2, 0, 3, 1, 4)
        q, k, v = qkv[0], qkv[1], qkv[2]
        pq = torch.einsum("bhsd,hdf->bhsf", q, w_phi)
        pk = torch.einsum("bhsd,hdf->bhsf", k, w_phi)
        phi_q = torch.concatenate([_softmax(pq, axis=-1), _softmax(-pq, axis=-1)], axis=-1)
        phi_k = torch.concatenate([_softmax(pk, axis=-1), _softmax(-pk, axis=-1)], axis=-1)
        kv = torch.einsum("bhsf,bhsd->bhfd", phi_k, v)
        z  = torch.einsum("bhsf->bhf", phi_k)
        num = torch.einsum("bhqf,bhfd->bhqd", phi_q, kv)
        den = torch.einsum("bhqf,bhf->bhq", phi_q, z)[..., None] + 1e-6
        o = num / den
        return (lambda x, *d: x.permute(*d))(o, 0, 2, 1, 3).reshape(B, S, D) @ wo

    def _B_ref(x, w1, b1, w2, b2):
        B, S, D = x.shape
        h = _layernorm(x, axis=-1)
        u = torch.einsum("bsd,sf->bdf", h, w1) + b1
        u = _gelu(u)
        y = torch.einsum("bdf,fs->bds", u, w2) + b2
        return (lambda x, *d: x.permute(*d))(y, 0, 2, 1)

    x = A_x
    xn = _layernorm(x, axis=-1)
    return x + _A_ref(xn, A_wqkv, A_w_phi, A_wo) + _B_ref(xn, B_w1, B_b1, B_w2, B_b2)
```

```asm
; @launch grid=(256,1,1) block=(512,1,1) lds=163840
.amdgcn_target "amdgcn-amd-amdhsa--gfx950"
.text
.globl parallel_sum__linear_kernel_hedgehog__mixer_token_mlp__prompt_kernel
.p2align 8
.type parallel_sum__linear_kernel_hedgehog__mixer_token_mlp__prompt_kernel,@function
parallel_sum__linear_kernel_hedgehog__mixer_token_mlp__prompt_kernel:
L_start:
	s_cmp_ge_u32 s2, 256
	s_cbranch_scc1 L_end
	s_load_dwordx16 s[16:31], s[0:1], 0
	s_load_dwordx8 s[32:39], s[0:1], 64
	v_and_b32 v1, 63, v0
	v_lshrrev_b32 v6, 6, v0
	s_nop 0
	v_readfirstlane_b32 s90, v6
	v_lshrrev_b32 v2, 4, v1
	v_and_b32 v3, 15, v1
	v_lshrrev_b32 v4, 2, v3
	v_and_b32 v5, 3, v1
	v_lshl_add_u32 v7, v2, 2, v4
	v_and_b32 v40, 255, v0
	s_and_b32 s3, s90, 3
	s_lshr_b32 s91, s90, 2
	s_mov_b32 s70, s2
	s_waitcnt lgkmcnt(0)
	s_add_u32 s4, s38, 20344832
	s_addc_u32 s5, s39, 0
	s_load_dword s75, s[4:5], 0
	s_mov_b32 s44, s16
	s_and_b32 s45, s17, 0xffff
	s_mov_b32 s46, 2621440
	s_mov_b32 s47, 0x20000
	s_mov_b32 s40, s38
	s_and_b32 s41, s39, 0xffff
	s_mov_b32 s42, 20476416
	s_mov_b32 s43, 0x20000
	s_mov_b32 s56, s30
	s_and_b32 s57, s31, 0xffff
	s_mov_b32 s58, 7077888
	s_mov_b32 s59, 0x20000
	s_cmp_eq_u32 s91, 0
	s_cbranch_scc1 L_prio
	s_setprio 1
L_prio:
	s_cmp_ge_u32 s70, 128
	s_cbranch_scc1 L_not_a
	s_and_b32 s4, s70, 7
	s_lshr_b32 s5, s70, 3
	s_and_b32 s6, s4, 1
	s_lshl_b32 s6, s6, 2
	s_and_b32 s7, s5, 3
	s_add_u32 s68, s6, s7
	s_lshr_b32 s6, s4, 1
	s_lshl_b32 s6, s6, 2
	s_lshr_b32 s7, s5, 2
	s_add_u32 s6, s6, s7
	s_mov_b32 s69, s6
	s_lshl_b32 s6, s6, 3
	s_add_u32 s15, s6, s68
	s_lshl_b32 s12, s15, 1
	s_add_u32 s12, s12, s91
	s_lshl_b32 s4, s12, 2
	s_add_u32 s4, s4, s3
	s_mul_i32 s4, s4, 2560
	v_mul_u32_u24 v24, 40, v1
	buffer_load_dwordx4 v[156:159], v24, s[44:47], s4 offen
	buffer_load_dwordx4 v[160:163], v24, s[44:47], s4 offen offset:16
	buffer_load_dwordx2 v[164:165], v24, s[44:47], s4 offen offset:32
	s_mov_b32 s48, s18
	s_and_b32 s49, s19, 0xffff
	s_mov_b32 s50, 2457600
	s_mov_b32 s51, 0x20000
	v_lshlrev_b32 v8, 4, v1
	v_add_u32 v9, 4096, v8
	s_mul_i32 s74, s90, 5120
	s_lshl_b32 s10, s15, 2
	s_add_u32 s10, s10, s3
	s_mul_i32 s4, s10, 1093
	s_lshr_b32 s4, s4, 16
	s_mul_i32 s5, s4, 60
	s_sub_u32 s5, s10, s5
	s_lshr_b32 s6, s5, 1
	s_and_b32 s7, s5, 1
	s_add_u32 s7, s7, 1
	s_sub_u32 s8, s5, 40
	s_cmp_ge_u32 s5, 40
	s_cselect_b32 s6, s8, s6
	s_cselect_b32 s7, 0, s7
	s_mul_i32 s6, s6, 122880
	s_mul_i32 s7, s7, 1280
	s_mul_i32 s4, s4, 160
	s_add_u32 s6, s6, s7
	s_add_u32 s6, s6, s4
	s_cmp_eq_u32 s91, 0
	s_cselect_b32 s10, 480, s10
	v_add_u32 v18, 0, v1
	v_mul_u32_u24 v19, 6554, v18
	v_lshrrev_b32 v19, 16, v19
	v_mul_u32_u24 v20, 10, v19
	v_sub_u32 v18, v18, v20
	v_bfe_u32 v20, v19, 2, 2
	v_lshlrev_b32 v20, 3, v20
	v_and_b32 v12, 3, v19
	v_add_u32 v20, v20, v12
	v_lshrrev_b32 v19, 4, v19
	v_lshl_add_u32 v19, v19, 2, v20
	v_mul_u32_u24 v19, 3840, v19
	v_lshl_add_u32 v12, v18, 4, v19
	v_add_u32 v18, 64, v1
	v_mul_u32_u24 v19, 6554, v18
	v_lshrrev_b32 v19, 16, v19
	v_mul_u32_u24 v20, 10, v19
	v_sub_u32 v18, v18, v20
	v_bfe_u32 v20, v19, 2, 2
	v_lshlrev_b32 v20, 3, v20
	v_and_b32 v13, 3, v19
	v_add_u32 v20, v20, v13
	v_lshrrev_b32 v19, 4, v19
	v_lshl_add_u32 v19, v19, 2, v20
	v_mul_u32_u24 v19, 3840, v19
	v_lshl_add_u32 v13, v18, 4, v19
	v_subrev_u32 v13, 1024, v13
	v_add_u32 v18, 128, v1
	v_mul_u32_u24 v19, 6554, v18
	v_lshrrev_b32 v19, 16, v19
	v_mul_u32_u24 v20, 10, v19
	v_sub_u32 v18, v18, v20
	v_bfe_u32 v20, v19, 2, 2
	v_lshlrev_b32 v20, 3, v20
	v_and_b32 v14, 3, v19
	v_add_u32 v20, v20, v14
	v_lshrrev_b32 v19, 4, v19
	v_lshl_add_u32 v19, v19, 2, v20
	v_mul_u32_u24 v19, 3840, v19
	v_lshl_add_u32 v14, v18, 4, v19
	v_subrev_u32 v14, 2048, v14
	v_add_u32 v18, 192, v1
	v_mul_u32_u24 v19, 6554, v18
	v_lshrrev_b32 v19, 16, v19
	v_mul_u32_u24 v20, 10, v19
	v_sub_u32 v18, v18, v20
	v_bfe_u32 v20, v19, 2, 2
	v_lshlrev_b32 v20, 3, v20
	v_and_b32 v15, 3, v19
	v_add_u32 v20, v20, v15
	v_lshrrev_b32 v19, 4, v19
	v_lshl_add_u32 v19, v19, 2, v20
	v_mul_u32_u24 v19, 3840, v19
	v_lshl_add_u32 v15, v18, 4, v19
	v_subrev_u32 v15, 3072, v15
	v_add_u32 v18, 256, v1
	v_mul_u32_u24 v19, 6554, v18
	v_lshrrev_b32 v19, 16, v19
	v_mul_u32_u24 v20, 10, v19
	v_sub_u32 v18, v18, v20
	v_bfe_u32 v20, v19, 2, 2
	v_lshlrev_b32 v20, 3, v20
	v_and_b32 v16, 3, v19
	v_add_u32 v20, v20, v16
	v_lshrrev_b32 v19, 4, v19
	v_lshl_add_u32 v19, v19, 2, v20
	v_mul_u32_u24 v19, 3840, v19
	v_lshl_add_u32 v16, v18, 4, v19
	s_cmp_ge_u32 s10, 480
	s_cselect_b32 s7, 1073741824, 0
	v_add_u32 v12, s7, v12
	v_add_u32 v13, s7, v13
	v_add_u32 v14, s7, v14
	v_add_u32 v15, s7, v15
	v_add_u32 v16, s7, v16
	s_add_u32 m0, s74, 0
	s_nop 0
	buffer_load_dwordx4 v12, s[48:51], s6 offen lds
	buffer_load_dwordx4 v13, s[48:51], s6 offen offset:1024 lds
	buffer_load_dwordx4 v14, s[48:51], s6 offen offset:2048 lds
	buffer_load_dwordx4 v15, s[48:51], s6 offen offset:3072 lds
	s_add_u32 m0, s74, 4096
	s_nop 0
	buffer_load_dwordx4 v16, s[48:51], s6 offen lds
	s_mul_i32 s13, s91, 24576
	s_add_u32 s13, s13, 65536
	s_add_u32 s14, s13, 12288
	s_mov_b32 s60, s20
	s_and_b32 s61, s21, 0xffff
	s_mov_b32 s62, 25600
	s_mov_b32 s63, 0x20000
	s_mul_i32 s6, s68, 3200
	s_lshl_b32 s7, s3, 10
	s_add_u32 s6, s6, s7
	v_lshl_add_u32 v10, v1, 4, s6
	s_add_u32 m0, s7, 126976
	s_nop 0
	buffer_load_dwordx4 v10, s[60:63], 0 offen lds
	v_mov_b32 v44, 0
	v_mov_b32 v45, 0
	v_mov_b32 v46, 0
	v_mov_b32 v47, 0
	v_lshlrev_b32 v18, 4, v40
	v_add_u32 v18, 122880, v18
	ds_write_b128 v18, v[44:47]
	v_mov_b32 v10, 131072
	v_mov_b32 v11, 0
	ds_write2_b32 v10, v11, v11 offset0:0 offset1:1
	v_mov_b32 v34, 0x3f803f80
	v_mov_b32 v36, 0
	v_mov_b32 v37, 0
	v_mov_b32 v38, 0
	v_mov_b32 v39, 0
	s_waitcnt lgkmcnt(0)
	s_add_u32 s75, s75, 1
	s_waitcnt vmcnt(6)
	v_dot2c_f32_bf16 v36, v156, v34
	v_dot2c_f32_bf16 v38, v156, v156
	v_dot2c_f32_bf16 v37, v157, v34
	v_dot2c_f32_bf16 v39, v157, v157
	v_dot2c_f32_bf16 v36, v158, v34
	v_dot2c_f32_bf16 v38, v158, v158
	v_dot2c_f32_bf16 v37, v159, v34
	v_dot2c_f32_bf16 v39, v159, v159
	v_dot2c_f32_bf16 v36, v160, v34
	v_dot2c_f32_bf16 v38, v160, v160
	v_dot2c_f32_bf16 v37, v161, v34
	v_dot2c_f32_bf16 v39, v161, v161
	v_dot2c_f32_bf16 v36, v162, v34
	v_dot2c_f32_bf16 v38, v162, v162
	v_dot2c_f32_bf16 v37, v163, v34
	v_dot2c_f32_bf16 v39, v163, v163
	v_dot2c_f32_bf16 v36, v164, v34
	v_dot2c_f32_bf16 v38, v164, v164
	v_dot2c_f32_bf16 v37, v165, v34
	v_dot2c_f32_bf16 v39, v165, v165
	s_nop 1
	v_add_f32 v36, v36, v37
	v_add_f32 v38, v38, v39
	s_nop 0
	v_add_f32_dpp v36, v36, v36 row_ror:8 row_mask:0xf bank_mask:0xf
	v_add_f32_dpp v38, v38, v38 row_ror:8 row_mask:0xf bank_mask:0xf
	s_nop 0
	v_add_f32_dpp v36, v36, v36 row_ror:4 row_mask:0xf bank_mask:0xf
	v_add_f32_dpp v38, v38, v38 row_ror:4 row_mask:0xf bank_mask:0xf
	s_nop 0
	v_add_f32_dpp v36, v36, v36 row_ror:2 row_mask:0xf bank_mask:0xf
	v_add_f32_dpp v38, v38, v38 row_ror:2 row_mask:0xf bank_mask:0xf
	s_nop 0
	v_add_f32_dpp v36, v36, v36 row_ror:1 row_mask:0xf bank_mask:0xf
	v_add_f32_dpp v38, v38, v38 row_ror:1 row_mask:0xf bank_mask:0xf
	v_mov_b32 v37, v36
	s_nop 1
	v_permlane16_swap_b32 v36, v37
	v_add_f32 v36, v36, v37
	v_mov_b32 v39, v38
	s_nop 1
	v_permlane16_swap_b32 v38, v39
	v_add_f32 v38, v38, v39
	v_mul_f32 v36, 0x3acccccd, v36
	v_mul_f32 v38, 0x3acccccd, v38
	v_fma_f32 v38, -v36, v36, v38
	v_max_f32 v38, 0, v38
	v_add_f32 v37, 0x3727c5ac, v38
	v_rsq_f32 v168, v37
	s_nop 0
	v_mul_f32 v170, v36, v168
	v_sub_f32 v170, 0, v170
	v_mul_f32 v37, v168, v168
	v_mov_b32 v39, 0x3727c5ac
	v_fmac_f32 v39, v37, v38
	v_rsq_f32 v38, v39
	v_lshlrev_b32 v172, 16, v156
	v_and_b32 v173, 0xffff0000, v156
	v_lshlrev_b32 v174, 16, v157
	v_and_b32 v175, 0xffff0000, v157
	v_lshlrev_b32 v176, 16, v158
	v_and_b32 v177, 0xffff0000, v158
	v_lshlrev_b32 v178, 16, v159
	v_and_b32 v179, 0xffff0000, v159
	v_lshlrev_b32 v180, 16, v160
	v_and_b32 v181, 0xffff0000, v160
	v_lshlrev_b32 v182, 16, v161
	v_and_b32 v183, 0xffff0000, v161
	v_lshlrev_b32 v184, 16, v162
	v_and_b32 v185, 0xffff0000, v162
	v_lshlrev_b32 v186, 16, v163
	v_and_b32 v187, 0xffff0000, v163
	v_lshlrev_b32 v188, 16, v164
	v_and_b32 v189, 0xffff0000, v164
	v_lshlrev_b32 v190, 16, v165
	v_and_b32 v191, 0xffff0000, v165
	v_pk_fma_f32 v[172:173], v[172:173], v[168:169], v[170:171] op_sel_hi:[1,0,0]
	v_pk_fma_f32 v[174:175], v[174:175], v[168:169], v[170:171] op_sel_hi:[1,0,0]
	v_pk_fma_f32 v[176:177], v[176:177], v[168:169], v[170:171] op_sel_hi:[1,0,0]
	v_pk_fma_f32 v[178:179], v[178:179], v[168:169], v[170:171] op_sel_hi:[1,0,0]
	v_pk_fma_f32 v[180:181], v[180:181], v[168:169], v[170:171] op_sel_hi:[1,0,0]
	v_pk_fma_f32 v[182:183], v[182:183], v[168:169], v[170:171] op_sel_hi:[1,0,0]
	v_pk_fma_f32 v[184:185], v[184:185], v[168:169], v[170:171] op_sel_hi:[1,0,0]
	v_pk_fma_f32 v[186:187], v[186:187], v[168:169], v[170:171] op_sel_hi:[1,0,0]
	v_pk_fma_f32 v[188:189], v[188:189], v[168:169], v[170:171] op_sel_hi:[1,0,0]
	v_pk_fma_f32 v[190:191], v[190:191], v[168:169], v[170:171] op_sel_hi:[1,0,0]
	v_cvt_pk_bf16_f32 v192, v172, v173
	v_cvt_pk_bf16_f32 v193, v174, v175
	v_cvt_pk_bf16_f32 v194, v176, v177
	v_cvt_pk_bf16_f32 v195, v178, v179
	v_cvt_pk_bf16_f32 v196, v180, v181
	v_cvt_pk_bf16_f32 v197, v182, v183
	v_cvt_pk_bf16_f32 v198, v184, v185
	v_cvt_pk_bf16_f32 v199, v186, v187
	v_cvt_pk_bf16_f32 v200, v188, v189
	v_cvt_pk_bf16_f32 v201, v190, v191
	v_pk_mul_f32 v[172:173], v[172:173], v[38:39] op_sel_hi:[1,0]
	v_pk_mul_f32 v[174:175], v[174:175], v[38:39] op_sel_hi:[1,0]
	v_pk_mul_f32 v[176:177], v[176:177], v[38:39] op_sel_hi:[1,0]
	v_pk_mul_f32 v[178:179], v[178:179], v[38:39] op_sel_hi:[1,0]
	v_pk_mul_f32 v[180:181], v[180:181], v[38:39] op_sel_hi:[1,0]
	v_pk_mul_f32 v[182:183], v[182:183], v[38:39] op_sel_hi:[1,0]
	v_pk_mul_f32 v[184:185], v[184:185], v[38:39] op_sel_hi:[1,0]
	v_pk_mul_f32 v[186:187], v[186:187], v[38:39] op_sel_hi:[1,0]
	v_pk_mul_f32 v[188:189], v[188:189], v[38:39] op_sel_hi:[1,0]
	v_pk_mul_f32 v[190:191], v[190:191], v[38:39] op_sel_hi:[1,0]
	v_cvt_pk_bf16_f32 v156, v172, v173
	v_cvt_pk_bf16_f32 v157, v174, v175
	v_cvt_pk_bf16_f32 v158, v176, v177
	v_cvt_pk_bf16_f32 v159, v178, v179
	v_cvt_pk_bf16_f32 v160, v180, v181
	v_cvt_pk_bf16_f32 v161, v182, v183
	v_cvt_pk_bf16_f32 v162, v184, v185
	v_cvt_pk_bf16_f32 v163, v186, v187
	v_cvt_pk_bf16_f32 v164, v188, v189
	v_cvt_pk_bf16_f32 v165, v190, v191
	s_mul_i32 s4, s3, 2592
	s_add_u32 s4, s4, s13
	v_mul_u32_u24 v24, 40, v1
	v_lshrrev_b32 v25, 5, v1
	v_lshl_add_u32 v24, v25, 4, v24
	v_add_u32 v24, s4, v24
	ds_write_b64 v24, v[192:193] offset:0
	ds_write_b64 v24, v[194:195] offset:8
	ds_write_b64 v24, v[196:197] offset:16
	ds_write_b64 v24, v[198:199] offset:24
	ds_write_b64 v24, v[200:201] offset:32
	v_and_b32 v25, 7, v40
	v_lshrrev_b32 v26, 3, v40
	v_mul_u32_u24 v28, 1296, v25
	v_lshl_add_u32 v28, v26, 4, v28
	v_add_u32 v28, s13, v28
	v_lshlrev_b32 v29, 8, v26
	v_lshl_add_u32 v29, v25, 4, v29
	s_lshr_b32 s4, s12, 1
	s_mul_i32 s4, s4, 20480
	s_and_b32 s5, s12, 1
	s_lshl_b32 s5, s5, 7
	s_add_u32 s4, s4, s5
	s_add_u32 s4, s4, 8273920
	v_add_u32 v29, s4, v29
	v_add_u32 v30, 8192, v29
	s_cmp_ge_u32 s3, 2
	s_cselect_b32 s4, 1073741824, 16384
	v_add_u32 v31, s4, v29
	s_mul_i32 s4, s3, 2560
	s_add_u32 s4, s4, s14
	v_mul_u32_u24 v24, 40, v1
	v_add_u32 v24, s4, v24
	ds_write_b64 v24, v[156:157] offset:0
	ds_write_b64 v24, v[158:159] offset:8
	ds_write_b64 v24, v[160:161] offset:16
	ds_write_b64 v24, v[162:163] offset:24
	ds_write_b64 v24, v[164:165] offset:32
	v_mul_u32_u24 v24, 1280, v4
	v_mul_u32_u24 v25, 160, v2
	v_add_u32 v24, v24, v25
	v_mul_u32_u24 v25, 40, v5
	v_add_u32 v24, v24, v25
	v_add_u32 v24, s14, v24
	v_mul_u32_u24 v25, 327680, v2
	v_lshl_add_u32 v25, v3, 4, v25
	s_lshr_b32 s4, s12, 2
	s_mul_i32 s4, s4, 5120
	s_and_b32 s5, s12, 3
	s_lshl_b32 s5, s5, 8
	s_add_u32 s4, s4, s5
	s_add_u32 s8, s4, 0
	s_waitcnt lgkmcnt(0)
	s_barrier
	ds_read_b128 v[192:195], v28 offset:0
	ds_read_b128 v[196:199], v28 offset:512
	ds_read_b128 v[200:203], v28 offset:1024
	s_waitcnt lgkmcnt(2)
	buffer_store_dwordx4 v[192:195], v29, s[40:43], 0 offen sc1
	s_waitcnt lgkmcnt(1)
	buffer_store_dwordx4 v[196:199], v30, s[40:43], 0 offen sc1
	s_waitcnt lgkmcnt(0)
	buffer_store_dwordx4 v[200:203], v31, s[40:43], 0 offen sc1
	s_add_u32 s4, s3, 0
	s_min_u32 s5, s4, 9
	s_cmp_ge_u32 s5, 5
	s_cselect_b32 s6, 600, 0
	s_cselect_b32 s7, 1305600, 0
	s_lshl_b32 s5, s5, 3
	s_add_u32 s5, s5, s6
	v_add_u32 v26, s5, v24
	ds_read_b64_tr_b16 v[172:173], v26
	ds_read_b64_tr_b16 v[174:175], v26 offset:5120
	s_lshl_b32 s5, s4, 10
	s_add_u32 s5, s5, s7
	s_add_u32 s5, s5, s8
	s_cmp_ge_u32 s4, 10
	s_cselect_b32 s5, 1073741824, s5
	v_add_u32 v34, s5, v25
	s_add_u32 s4, s3, 4
	s_min_u32 s5, s4, 9
	s_cmp_ge_u32 s5, 5
	s_cselect_b32 s6, 600, 0
	s_cselect_b32 s7, 1305600, 0
	s_lshl_b32 s5, s5, 3
	s_add_u32 s5, s5, s6
	v_add_u32 v26, s5, v24
	ds_read_b64_tr_b16 v[176:177], v26
	ds_read_b64_tr_b16 v[178:179], v26 offset:5120
	s_lshl_b32 s5, s4, 10
	s_add_u32 s5, s5, s7
	s_add_u32 s5, s5, s8
	s_cmp_ge_u32 s4, 10
	s_cselect_b32 s5, 1073741824, s5
	v_add_u32 v35, s5, v25
	s_add_u32 s4, s3, 8
	s_min_u32 s5, s4, 9
	s_cmp_ge_u32 s5, 5
	s_cselect_b32 s6, 600, 0
	s_cselect_b32 s7, 1305600, 0
	s_lshl_b32 s5, s5, 3
	s_add_u32 s5, s5, s6
	v_add_u32 v26, s5, v24
	ds_read_b64_tr_b16 v[180:181], v26
	ds_read_b64_tr_b16 v[182:183], v26 offset:5120
	s_lshl_b32 s5, s4, 10
	s_add_u32 s5, s5, s7
	s_add_u32 s5, s5, s8
	s_cmp_ge_u32 s4, 10
	s_cselect_b32 s5, 1073741824, s5
	v_add_u32 v36, s5, v25
	s_waitcnt lgkmcnt(4)
	buffer_store_dwordx4 v[172:175], v34, s[40:43], 0 offen sc1
	s_waitcnt lgkmcnt(2)
	buffer_store_dwordx4 v[176:179], v35, s[40:43], 0 offen sc1
	s_waitcnt lgkmcnt(0)
	buffer_store_dwordx4 v[180:183], v36, s[40:43], 0 offen sc1
	v_mul_u32_u24 v29, 160, v7
	v_mul_u32_u24 v24, 40, v5
	v_add_u32 v29, v29, v24
	v_add_u32 v29, s74, v29
	s_mul_i32 s4, s10, 5120
	s_add_u32 s4, s4, 10895360
	s_cmp_ge_u32 s10, 480
	s_cselect_b32 s4, 1073741824, s4
	v_add_u32 v24, s4, v8
	v_add_u32 v25, s4, v9
	s_lshl_b32 s5, s10, 7
	s_add_u32 s5, s5, 20279296
	s_cmp_ge_u32 s10, 480
	s_cselect_b32 s10, 1073741824, s5
	s_waitcnt vmcnt(7)
	ds_read_b64_tr_b16 v[68:69], v29 offset:0
	ds_read_b64_tr_b16 v[70:71], v29 offset:2560
	ds_read_b64_tr_b16 v[76:77], v29 offset:8
	ds_read_b64_tr_b16 v[78:79], v29 offset:2568
	ds_read_b64_tr_b16 v[84:85], v29 offset:16
	ds_read_b64_tr_b16 v[86:87], v29 offset:2576
	ds_read_b64_tr_b16 v[92:93], v29 offset:24
	ds_read_b64_tr_b16 v[94:95], v29 offset:2584
	ds_read_b64_tr_b16 v[100:101], v29 offset:32
	ds_read_b64_tr_b16 v[102:103], v29 offset:2592
	s_waitcnt lgkmcnt(8)
	buffer_store_dwordx4 v[68:71], v24, s[40:43], 0 offen offset:0 sc1
	s_waitcnt lgkmcnt(6)
	buffer_store_dwordx4 v[76:79], v24, s[40:43], 0 offen offset:1024 sc1
	s_waitcnt lgkmcnt(4)
	buffer_store_dwordx4 v[84:87], v24, s[40:43], 0 offen offset:2048 sc1
	s_waitcnt lgkmcnt(2)
	buffer_store_dwordx4 v[92:95], v24, s[40:43], 0 offen offset:3072 sc1
	s_waitcnt lgkmcnt(0)
	buffer_store_dwordx4 v[100:103], v25, s[40:43], 0 offen offset:0 sc1
	s_lshl_b32 s4, s91, 2
	s_add_u32 s4, s4, 131072
	v_mov_b32 v10, s4
	v_mov_b32 v11, 1
	s_waitcnt vmcnt(5)
	s_mov_b64 exec, 1
	ds_add_rtn_u32 v11, v10, v11
	s_mov_b64 exec, -1
	s_waitcnt lgkmcnt(0)
	v_readfirstlane_b32 s5, v11
	s_lshl_b32 s4, s12, 7
	s_add_u32 s4, s4, 19722240
	s_cmp_lg_u32 s5, 3
	s_nop 1
	s_cbranch_scc1 L_nofh
	v_lshl_add_u32 v42, v1, 2, s4
	v_mov_b32 v43, s75
	s_mov_b64 exec, 0xffffffff
	buffer_store_dword v43, v42, s[40:43], 0 offen sc1
	s_mov_b64 exec, -1
L_nofh:
	s_waitcnt vmcnt(0)
	v_lshl_add_u32 v42, v1, 2, s10
	v_mov_b32 v43, s75
	s_mov_b64 exec, 0xffffffff
	buffer_store_dword v43, v42, s[40:43], 0 offen sc1
	s_mov_b64 exec, -1
	s_mov_b32 s76, 0x3fb8aa3b
	s_mov_b32 s77, 0x3fb8aa3b
	s_mov_b32 s78, 0xbfb8aa3b
	s_mov_b32 s79, 0xbfb8aa3b
	s_mul_i32 s10, s68, 60
	s_lshl_b32 s4, s10, 7
	s_add_u32 s4, s4, 20279296
	v_min_u32 v20, 14, v3
	v_lshl_add_u32 v20, v20, 2, s3
	v_lshl_add_u32 v20, v20, 7, s4
	s_lshl_b32 s11, s69, 2
	s_add_u32 s11, s11, s3
	s_lshl_b32 s4, s11, 9
	s_add_u32 s4, s4, 19722240
	v_lshl_add_u32 v21, v5, 7, s4
	s_cmp_lg_u32 s91, 0
	s_cselect_b64 vcc, -1, 0
	v_cndmask_b32 v20, v21, v20, vcc
	s_add_u32 s10, s10, s3
	s_mul_i32 s10, s10, 5120
	s_add_u32 s10, s10, 10895360
	s_add_u32 s9, s10, 204800
	s_mul_i32 s74, s3, 5120
	s_mul_i32 s11, s11, 40960
	s_add_u32 s11, s11, 8273920
	v_add_u32 v10, 20480, v8
	v_add_u32 v26, 102400, v8
	v_add_u32 v27, 61440, v8
	s_barrier
	v_mul_u32_u24 v22, 800, v2
	v_mul_u32_u24 v23, 40, v4
	v_add_u32 v22, v22, v23
	v_add_u32 v22, 126976, v22
	v_mov_b32 v23, 122880
	v_cmp_eq_u32 vcc, v2, v5
	s_nop 1
	v_cndmask_b32 v22, v23, v22, vcc
	ds_read_b64_tr_b16 v[48:49], v22 offset:0
	ds_read_b64_tr_b16 v[50:51], v22 offset:160
	ds_read_b64_tr_b16 v[52:53], v22 offset:320
	ds_read_b64_tr_b16 v[54:55], v22 offset:480
	ds_read_b64_tr_b16 v[88:89], v22 offset:640
	ds_read_b64_tr_b16 v[56:57], v22 offset:8
	ds_read_b64_tr_b16 v[58:59], v22 offset:168
	ds_read_b64_tr_b16 v[60:61], v22 offset:328
	ds_read_b64_tr_b16 v[62:63], v22 offset:488
	ds_read_b64_tr_b16 v[90:91], v22 offset:648
	ds_read_b64_tr_b16 v[64:65], v22 offset:16
	ds_read_b64_tr_b16 v[66:67], v22 offset:176
	ds_read_b64_tr_b16 v[68:69], v22 offset:336
	ds_read_b64_tr_b16 v[70:71], v22 offset:496
	ds_read_b64_tr_b16 v[92:93], v22 offset:656
	ds_read_b64_tr_b16 v[72:73], v22 offset:24
	ds_read_b64_tr_b16 v[74:75], v22 offset:184
	ds_read_b64_tr_b16 v[76:77], v22 offset:344
	ds_read_b64_tr_b16 v[78:79], v22 offset:504
	ds_read_b64_tr_b16 v[94:95], v22 offset:664
	ds_read_b64_tr_b16 v[80:81], v22 offset:32
	ds_read_b64_tr_b16 v[82:83], v22 offset:192
	ds_read_b64_tr_b16 v[84:85], v22 offset:352
	ds_read_b64_tr_b16 v[86:87], v22 offset:512
	ds_read_b64_tr_b16 v[96:97], v22 offset:672
	s_waitcnt lgkmcnt(0)
	s_barrier
	buffer_load_dword v21, v20, s[40:43], 0 offen sc1
	s_waitcnt vmcnt(0)
	v_cmp_ne_u32 vcc, s75, v21
	s_nop 4
	s_cbranch_vccz L_ok_1
	s_mov_b32 s84, 0
L_poll_2:
	s_sleep 2
	buffer_load_dword v21, v20, s[40:43], 0 offen sc1
	s_waitcnt vmcnt(0)
	v_cmp_ne_u32 vcc, s75, v21
	s_nop 4
	s_cbranch_vccz L_ok_1
	s_add_u32 s84, s84, 1
	s_cmp_lt_u32 s84, 0x8000
	s_cbranch_scc1 L_poll_2
L_ok_1:
	s_cmp_lg_u32 s91, 0
	s_cbranch_scc1 L_a_upper
	s_setprio 2
	buffer_load_dwordx4 v[180:183], v8, s[40:43], s11 offen sc1
	buffer_load_dwordx4 v[184:187], v10, s[40:43], s11 offen sc1
	buffer_load_dwordx4 v[188:191], v8, s[40:43], s11 offen offset:1024 sc1
	buffer_load_dwordx4 v[192:195], v10, s[40:43], s11 offen offset:1024 sc1
	buffer_load_dwordx4 v[196:199], v8, s[40:43], s11 offen offset:2048 sc1
	buffer_load_dwordx4 v[200:203], v10, s[40:43], s11 offen offset:2048 sc1
	buffer_load_dwordx4 v[204:207], v8, s[40:43], s11 offen offset:3072 sc1
	buffer_load_dwordx4 v[208:211], v10, s[40:43], s11 offen offset:3072 sc1
	s_add_u32 s11, s11, 4096
	buffer_load_dwordx4 v[212:215], v8, s[40:43], s11 offen sc1
	buffer_load_dwordx4 v[216:219], v10, s[40:43], s11 offen sc1
	s_barrier
	ds_read_b128 v[228:231], v26 offset:0
	ds_read_b128 v[232:235], v26 offset:1024
	ds_read_b128 v[236:239], v26 offset:2048
	ds_read_b128 v[240:243], v26 offset:3072
	ds_read_b128 v[244:247], v26 offset:4096
	ds_read_b128 v[248:251], v26 offset:5120
	ds_read_b128 v[252:255], v26 offset:6144
	s_waitcnt vmcnt(8) lgkmcnt(6)
	v_mfma_f32_16x16x32_bf16 v[100:103], v[228:231], v[180:183], 0
	v_mfma_f32_16x16x32_bf16 v[104:107], v[228:231], v[184:187], 0
	ds_read_b128 v[228:231], v26 offset:7168
	s_waitcnt lgkmcnt(6)
	v_mfma_f32_16x16x32_bf16 v[108:111], v[232:235], v[180:183], 0
	v_mfma_f32_16x16x32_bf16 v[112:115], v[232:235], v[184:187], 0
	ds_read_b128 v[232:235], v26 offset:8192
	s_waitcnt lgkmcnt(6)
	v_mfma_f32_16x16x32_bf16 v[116:119], v[236:239], v[180:183], 0
	v_mfma_f32_16x16x32_bf16 v[120:123], v[236:239], v[184:187], 0
	buffer_load_dwordx4 v[220:223], v8, s[40:43], s11 offen offset:1024 sc1
	ds_read_b128 v[236:239], v26 offset:9216
	s_waitcnt lgkmcnt(6)
	v_mfma_f32_16x16x32_bf16 v[124:127], v[240:243], v[180:183], 0
	v_mfma_f32_16x16x32_bf16 v[128:131], v[240:243], v[184:187], 0
	ds_read_b128 v[240:243], v26 offset:10240
	s_waitcnt lgkmcnt(6)
	v_mfma_f32_16x16x32_bf16 v[132:135], v[244:247], v[180:183], 0
	v_mfma_f32_16x16x32_bf16 v[136:139], v[244:247], v[184:187], 0
	ds_read_b128 v[244:247], v26 offset:11264
	s_waitcnt lgkmcnt(6)
	v_mfma_f32_16x16x32_bf16 v[140:143], v[248:251], v[180:183], 0
	v_mfma_f32_16x16x32_bf16 v[144:147], v[248:251], v[184:187], 0
	ds_read_b128 v[248:251], v26 offset:12288
	s_waitcnt lgkmcnt(6)
	v_mfma_f32_16x16x32_bf16 v[148:151], v[252:255], v[180:183], 0
	v_mfma_f32_16x16x32_bf16 v[152:155], v[252:255], v[184:187], 0
	buffer_load_dwordx4 v[224:227], v10, s[40:43], s11 offen offset:1024 sc1
	ds_read_b128 v[252:255], v26 offset:13312
	s_waitcnt lgkmcnt(6)
	v_mfma_f32_16x16x32_bf16 v[156:159], v[228:231], v[180:183], 0
	v_mfma_f32_16x16x32_bf16 v[160:163], v[228:231], v[184:187], 0
	ds_read_b128 v[228:231], v26 offset:14336
	s_waitcnt lgkmcnt(6)
	v_mfma_f32_16x16x32_bf16 v[164:167], v[232:235], v[180:183], 0
	v_mfma_f32_16x16x32_bf16 v[168:171], v[232:235], v[184:187], 0
	ds_read_b128 v[232:235], v26 offset:15360
	s_waitcnt lgkmcnt(6)
	v_mfma_f32_16x16x32_bf16 v[172:175], v[236:239], v[180:183], 0
	v_mfma_f32_16x16x32_bf16 v[176:179], v[236:239], v[184:187], 0
	ds_read_b128 v[236:239], v26 offset:16384
	s_waitcnt vmcnt(8) lgkmcnt(6)
	v_mfma_f32_16x16x32_bf16 v[100:103], v[240:243], v[188:191], v[100:103]
	v_mfma_f32_16x16x32_bf16 v[104:107], v[240:243], v[192:195], v[104:107]
	ds_read_b128 v[240:243], v26 offset:17408
	s_waitcnt lgkmcnt(6)
	v_mfma_f32_16x16x32_bf16 v[108:111], v[244:247], v[188:191], v[108:111]
	v_mfma_f32_16x16x32_bf16 v[112:115], v[244:247], v[192:195], v[112:115]
	ds_read_b128 v[244:247], v26 offset:18432
	s_waitcnt lgkmcnt(6)
	v_mfma_f32_16x16x32_bf16 v[116:119], v[248:251], v[188:191], v[116:119]
	v_mfma_f32_16x16x32_bf16 v[120:123], v[248:251], v[192:195], v[120:123]
	buffer_load_dwordx4 v[180:183], v8, s[40:43], s11 offen offset:2048 sc1
	ds_read_b128 v[248:251], v26 offset:19456
	s_waitcnt lgkmcnt(6)
	v_mfma_f32_16x16x32_bf16 v[124:127], v[252:255], v[188:191], v[124:127]
	v_mfma_f32_16x16x32_bf16 v[128:131], v[252:255], v[192:195], v[128:131]
	s_waitcnt lgkmcnt(0)
	s_barrier
	ds_read_b128 v[252:255], v26 offset:20480
	v_mfma_f32_16x16x32_bf16 v[132:135], v[228:231], v[188:191], v[132:135]
	v_mfma_f32_16x16x32_bf16 v[136:139], v[228:231], v[192:195], v[136:139]
	ds_read_b128 v[228:231], v26 offset:21504
	v_mfma_f32_16x16x32_bf16 v[140:143], v[232:235], v[188:191], v[140:143]
	v_mfma_f32_16x16x32_bf16 v[144:147], v[232:235], v[192:195], v[144:147]
	ds_read_b128 v[232:235], v26 offset:22528
	v_mfma_f32_16x16x32_bf16 v[148:151], v[236:239], v[188:191], v[148:151]
	v_mfma_f32_16x16x32_bf16 v[152:155], v[236:239], v[192:195], v[152:155]
	buffer_load_dwordx4 v[184:187], v10, s[40:43], s11 offen offset:2048 sc1
	ds_read_b128 v[236:239], v26 offset:23552
	v_mfma_f32_16x16x32_bf16 v[156:159], v[240:243], v[188:191], v[156:159]
	v_mfma_f32_16x16x32_bf16 v[160:163], v[240:243], v[192:195], v[160:163]
	ds_read_b128 v[240:243], v26 offset:24576
	v_mfma_f32_16x16x32_bf16 v[164:167], v[244:247], v[188:191], v[164:167]
	v_mfma_f32_16x16x32_bf16 v[168:171], v[244:247], v[192:195], v[168:171]
	ds_read_b128 v[244:247], v26 offset:25600
	v_mfma_f32_16x16x32_bf16 v[172:175], v[248:251], v[188:191], v[172:175]
	v_mfma_f32_16x16x32_bf16 v[176:179], v[248:251], v[192:195], v[176:179]
	ds_read_b128 v[248:251], v26 offset:26624
	s_waitcnt vmcnt(8) lgkmcnt(6)
	v_mfma_f32_16x16x32_bf16 v[100:103], v[252:255], v[196:199], v[100:103]
	v_mfma_f32_16x16x32_bf16 v[104:107], v[252:255], v[200:203], v[104:107]
	ds_read_b128 v[252:255], v26 offset:27648
	s_waitcnt lgkmcnt(6)
	v_mfma_f32_16x16x32_bf16 v[108:111], v[228:231], v[196:199], v[108:111]
	v_mfma_f32_16x16x32_bf16 v[112:115], v[228:231], v[200:203], v[112:115]
	ds_read_b128 v[228:231], v26 offset:28672
	s_waitcnt lgkmcnt(6)
	v_mfma_f32_16x16x32_bf16 v[116:119], v[232:235], v[196:199], v[116:119]
	v_mfma_f32_16x16x32_bf16 v[120:123], v[232:235], v[200:203], v[120:123]
	buffer_load_dwordx4 v[188:191], v8, s[40:43], s11 offen offset:3072 sc1
	ds_read_b128 v[232:235], v26 offset:29696
	s_waitcnt lgkmcnt(6)
	v_mfma_f32_16x16x32_bf16 v[124:127], v[236:239], v[196:199], v[124:127]
	v_mfma_f32_16x16x32_bf16 v[128:131], v[236:239], v[200:203], v[128:131]
	ds_read_b128 v[236:239], v26 offset:30720
	s_waitcnt lgkmcnt(6)
	v_mfma_f32_16x16x32_bf16 v[132:135], v[240:243], v[196:199], v[132:135]
	v_mfma_f32_16x16x32_bf16 v[136:139], v[240:243], v[200:203], v[136:139]
	ds_read_b128 v[240:243], v26 offset:31744
	s_waitcnt lgkmcnt(6)
	v_mfma_f32_16x16x32_bf16 v[140:143], v[244:247], v[196:199], v[140:143]
	v_mfma_f32_16x16x32_bf16 v[144:147], v[244:247], v[200:203], v[144:147]
	ds_read_b128 v[244:247], v26 offset:32768
	s_waitcnt lgkmcnt(6)
	v_mfma_f32_16x16x32_bf16 v[148:151], v[248:251], v[196:199], v[148:151]
	v_mfma_f32_16x16x32_bf16 v[152:155], v[248:251], v[200:203], v[152:155]
	buffer_load_dwordx4 v[192:195], v10, s[40:43], s11 offen offset:3072 sc1
	s_add_u32 s11, s11, 4096
	ds_read_b128 v[248:251], v26 offset:33792
	s_waitcnt lgkmcnt(6)
	v_mfma_f32_16x16x32_bf16 v[156:159], v[252:255], v[196:199], v[156:159]
	v_mfma_f32_16x16x32_bf16 v[160:163], v[252:255], v[200:203], v[160:163]
	ds_read_b128 v[252:255], v26 offset:34816
	s_waitcnt lgkmcnt(6)
	v_mfma_f32_16x16x32_bf16 v[164:167], v[228:231], v[196:199], v[164:167]
	v_mfma_f32_16x16x32_bf16 v[168:171], v[228:231], v[200:203], v[168:171]
	ds_read_b128 v[228:231], v26 offset:35840
	s_waitcnt lgkmcnt(6)
	v_mfma_f32_16x16x32_bf16 v[172:175], v[232:235], v[196:199], v[172:175]
	v_mfma_f32_16x16x32_bf16 v[176:179], v[232:235], v[200:203], v[176:179]
	ds_read_b128 v[232:235], v26 offset:36864
	s_waitcnt vmcnt(8) lgkmcnt(6)
	v_mfma_f32_16x16x32_bf16 v[100:103], v[236:239], v[204:207], v[100:103]
	v_mfma_f32_16x16x32_bf16 v[104:107], v[236:239], v[208:211], v[104:107]
	ds_read_b128 v[236:239], v26 offset:37888
	s_waitcnt lgkmcnt(6)
	v_mfma_f32_16x16x32_bf16 v[108:111], v[240:243], v[204:207], v[108:111]
	v_mfma_f32_16x16x32_bf16 v[112:115], v[240:243], v[208:211], v[112:115]
	ds_read_b128 v[240:243], v26 offset:38912
	s_waitcnt lgkmcnt(6)
	v_mfma_f32_16x16x32_bf16 v[116:119], v[244:247], v[204:207], v[116:119]
	v_mfma_f32_16x16x32_bf16 v[120:123], v[244:247], v[208:211], v[120:123]
	buffer_load_dwordx4 v[196:199], v8, s[40:43], s11 offen sc1
	ds_read_b128 v[244:247], v26 offset:39936
	s_waitcnt lgkmcnt(6)
	v_mfma_f32_16x16x32_bf16 v[124:127], v[248:251], v[204:207], v[124:127]
	v_mfma_f32_16x16x32_bf16 v[128:131], v[248:251], v[208:211], v[128:131]
	s_waitcnt lgkmcnt(0)
	s_barrier
	ds_read_b128 v[248:251], v26 offset:40960
	v_mfma_f32_16x16x32_bf16 v[132:135], v[252:255], v[204:207], v[132:135]
	v_mfma_f32_16x16x32_bf16 v[136:139], v[252:255], v[208:211], v[136:139]
	ds_read_b128 v[252:255], v26 offset:41984
	v_mfma_f32_16x16x32_bf16 v[140:143], v[228:231], v[204:207], v[140:143]
	v_mfma_f32_16x16x32_bf16 v[144:147], v[228:231], v[208:211], v[144:147]
	ds_read_b128 v[228:231], v26 offset:43008
	v_mfma_f32_16x16x32_bf16 v[148:151], v[232:235], v[204:207], v[148:151]
	v_mfma_f32_16x16x32_bf16 v[152:155], v[232:235], v[208:211], v[152:155]
	buffer_load_dwordx4 v[200:203], v10, s[40:43], s11 offen sc1
	ds_read_b128 v[232:235], v26 offset:44032
	v_mfma_f32_16x16x32_bf16 v[156:159], v[236:239], v[204:207], v[156:159]
	v_mfma_f32_16x16x32_bf16 v[160:163], v[236:239], v[208:211], v[160:163]
	ds_read_b128 v[236:239], v26 offset:45056
	v_mfma_f32_16x16x32_bf16 v[164:167], v[240:243], v[204:207], v[164:167]
	v_mfma_f32_16x16x32_bf16 v[168:171], v[240:243], v[208:211], v[168:171]
	ds_read_b128 v[240:243], v26 offset:46080
	v_mfma_f32_16x16x32_bf16 v[172:175], v[244:247], v[204:207], v[172:175]
	v_mfma_f32_16x16x32_bf16 v[176:179], v[244:247], v[208:211], v[176:179]
	ds_read_b128 v[244:247], v26 offset:47104
	s_waitcnt vmcnt(8) lgkmcnt(6)
	v_mfma_f32_16x16x32_bf16 v[100:103], v[248:251], v[212:215], v[100:103]
	v_mfma_f32_16x16x32_bf16 v[104:107], v[248:251], v[216:219], v[104:107]
	ds_read_b128 v[248:251], v26 offset:48128
	s_waitcnt lgkmcnt(6)
	v_mfma_f32_16x16x32_bf16 v[108:111], v[252:255], v[212:215], v[108:111]
	v_mfma_f32_16x16x32_bf16 v[112:115], v[252:255], v[216:219], v[112:115]
	ds_read_b128 v[252:255], v26 offset:49152
	s_waitcnt lgkmcnt(6)
	v_mfma_f32_16x16x32_bf16 v[116:119], v[228:231], v[212:215], v[116:119]
	v_mfma_f32_16x16x32_bf16 v[120:123], v[228:231], v[216:219], v[120:123]
	buffer_load_dwordx4 v[204:207], v8, s[40:43], s11 offen offset:1024 sc1
	ds_read_b128 v[228:231], v26 offset:50176
	s_waitcnt lgkmcnt(6)
	v_mfma_f32_16x16x32_bf16 v[124:127], v[232:235], v[212:215], v[124:127]
	v_mfma_f32_16x16x32_bf16 v[128:131], v[232:235], v[216:219], v[128:131]
	ds_read_b128 v[232:235], v26 offset:51200
	s_waitcnt lgkmcnt(6)
	v_mfma_f32_16x16x32_bf16 v[132:135], v[236:239], v[212:215], v[132:135]
	v_mfma_f32_16x16x32_bf16 v[136:139], v[236:239], v[216:219], v[136:139]
	ds_read_b128 v[236:239], v26 offset:52224
	s_waitcnt lgkmcnt(6)
	v_mfma_f32_16x16x32_bf16 v[140:143], v[240:243], v[212:215], v[140:143]
	v_mfma_f32_16x16x32_bf16 v[144:147], v[240:243], v[216:219], v[144:147]
	ds_read_b128 v[240:243], v26 offset:53248
	s_waitcnt lgkmcnt(6)
	v_mfma_f32_16x16x32_bf16 v[148:151], v[244:247], v[212:215], v[148:151]
	v_mfma_f32_16x16x32_bf16 v[152:155], v[244:247], v[216:219], v[152:155]
	buffer_load_dwordx4 v[208:211], v10, s[40:43], s11 offen offset:1024 sc1
	ds_read_b128 v[244:247], v26 offset:54272
	s_waitcnt lgkmcnt(6)
	v_mfma_f32_16x16x32_bf16 v[156:159], v[248:251], v[212:215], v[156:159]
	v_mfma_f32_16x16x32_bf16 v[160:163], v[248:251], v[216:219], v[160:163]
	ds_read_b128 v[248:251], v26 offset:55296
	s_waitcnt lgkmcnt(6)
	v_mfma_f32_16x16x32_bf16 v[164:167], v[252:255], v[212:215], v[164:167]
	v_mfma_f32_16x16x32_bf16 v[168:171], v[252:255], v[216:219], v[168:171]
	ds_read_b128 v[252:255], v26 offset:56320
	s_waitcnt lgkmcnt(6)
	v_mfma_f32_16x16x32_bf16 v[172:175], v[228:231], v[212:215], v[172:175]
	v_mfma_f32_16x16x32_bf16 v[176:179], v[228:231], v[216:219], v[176:179]
	ds_read_b128 v[228:231], v26 offset:57344
	s_waitcnt vmcnt(8) lgkmcnt(6)
	v_mfma_f32_16x16x32_bf16 v[100:103], v[232:235], v[220:223], v[100:103]
	v_mfma_f32_16x16x32_bf16 v[104:107], v[232:235], v[224:227], v[104:107]
	ds_read_b128 v[232:235], v26 offset:58368
	s_waitcnt lgkmcnt(6)
	v_mfma_f32_16x16x32_bf16 v[108:111], v[236:239], v[220:223], v[108:111]
	v_mfma_f32_16x16x32_bf16 v[112:115], v[236:239], v[224:227], v[112:115]
	ds_read_b128 v[236:239], v26 offset:59392
	s_waitcnt lgkmcnt(6)
	v_mfma_f32_16x16x32_bf16 v[116:119], v[240:243], v[220:223], v[116:119]
	v_mfma_f32_16x16x32_bf16 v[120:123], v[240:243], v[224:227], v[120:123]
	buffer_load_dwordx4 v[212:215], v8, s[40:43], s11 offen offset:2048 sc1
	ds_read_b128 v[240:243], v26 offset:60416
	s_waitcnt lgkmcnt(6)
	v_mfma_f32_16x16x32_bf16 v[124:127], v[244:247], v[220:223], v[124:127]
	v_mfma_f32_16x16x32_bf16 v[128:131], v[244:247], v[224:227], v[128:131]
	s_waitcnt lgkmcnt(0)
	s_barrier
	ds_read_b128 v[244:247], v26 offset:0
	v_mfma_f32_16x16x32_bf16 v[132:135], v[248:251], v[220:223], v[132:135]
	v_mfma_f32_16x16x32_bf16 v[136:139], v[248:251], v[224:227], v[136:139]
	ds_read_b128 v[248:251], v26 offset:1024
	v_mfma_f32_16x16x32_bf16 v[140:143], v[252:255], v[220:223], v[140:143]
	v_mfma_f32_16x16x32_bf16 v[144:147], v[252:255], v[224:227], v[144:147]
	ds_read_b128 v[252:255], v26 offset:2048
	v_mfma_f32_16x16x32_bf16 v[148:151], v[228:231], v[220:223], v[148:151]
	v_mfma_f32_16x16x32_bf16 v[152:155], v[228:231], v[224:227], v[152:155]
	buffer_load_dwordx4 v[216:219], v10, s[40:43], s11 offen offset:2048 sc1
	ds_read_b128 v[228:231], v26 offset:3072
	v_mfma_f32_16x16x32_bf16 v[156:159], v[232:235], v[220:223], v[156:159]
	v_mfma_f32_16x16x32_bf16 v[160:163], v[232:235], v[224:227], v[160:163]
	ds_read_b128 v[232:235], v26 offset:4096
	v_mfma_f32_16x16x32_bf16 v[164:167], v[236:239], v[220:223], v[164:167]
	v_mfma_f32_16x16x32_bf16 v[168:171], v[236:239], v[224:227], v[168:171]
	ds_read_b128 v[236:239], v26 offset:5120
	v_mfma_f32_16x16x32_bf16 v[172:175], v[240:243], v[220:223], v[172:175]
	v_mfma_f32_16x16x32_bf16 v[176:179], v[240:243], v[224:227], v[176:179]
	ds_read_b128 v[240:243], v26 offset:6144
	s_waitcnt vmcnt(8) lgkmcnt(6)
	v_mfma_f32_16x16x32_bf16 v[100:103], v[244:247], v[180:183], v[100:103]
	v_mfma_f32_16x16x32_bf16 v[104:107], v[244:247], v[184:187], v[104:107]
	ds_read_b128 v[244:247], v26 offset:7168
	s_waitcnt lgkmcnt(6)
	v_mfma_f32_16x16x32_bf16 v[108:111], v[248:251], v[180:183], v[108:111]
	v_mfma_f32_16x16x32_bf16 v[112:115], v[248:251], v[184:187], v[112:115]
	ds_read_b128 v[248:251], v26 offset:8192
	s_waitcnt lgkmcnt(6)
	v_mfma_f32_16x16x32_bf16 v[116:119], v[252:255], v[180:183], v[116:119]
	v_mfma_f32_16x16x32_bf16 v[120:123], v[252:255], v[184:187], v[120:123]
	buffer_load_dwordx4 v[220:223], v8, s[40:43], s11 offen offset:3072 sc1
	ds_read_b128 v[252:255], v26 offset:9216
	s_waitcnt lgkmcnt(6)
	v_mfma_f32_16x16x32_bf16 v[124:127], v[228:231], v[180:183], v[124:127]
	v_mfma_f32_16x16x32_bf16 v[128:131], v[228:231], v[184:187], v[128:131]
	ds_read_b128 v[228:231], v26 offset:10240
	s_waitcnt lgkmcnt(6)
	v_mfma_f32_16x16x32_bf16 v[132:135], v[232:235], v[180:183], v[132:135]
	v_mfma_f32_16x16x32_bf16 v[136:139], v[232:235], v[184:187], v[136:139]
	ds_read_b128 v[232:235], v26 offset:11264
	s_waitcnt lgkmcnt(6)
	v_mfma_f32_16x16x32_bf16 v[140:143], v[236:239], v[180:183], v[140:143]
	v_mfma_f32_16x16x32_bf16 v[144:147], v[236:239], v[184:187], v[144:147]
	ds_read_b128 v[236:239], v26 offset:12288
	s_waitcnt lgkmcnt(6)
	v_mfma_f32_16x16x32_bf16 v[148:151], v[240:243], v[180:183], v[148:151]
	v_mfma_f32_16x16x32_bf16 v[152:155], v[240:243], v[184:187], v[152:155]
	buffer_load_dwordx4 v[224:227], v10, s[40:43], s11 offen offset:3072 sc1
	s_add_u32 s11, s11, 4096
	ds_read_b128 v[240:243], v26 offset:13312
	s_waitcnt lgkmcnt(6)
	v_mfma_f32_16x16x32_bf16 v[156:159], v[244:247], v[180:183], v[156:159]
	v_mfma_f32_16x16x32_bf16 v[160:163], v[244:247], v[184:187], v[160:163]
	ds_read_b128 v[244:247], v26 offset:14336
	s_waitcnt lgkmcnt(6)
	v_mfma_f32_16x16x32_bf16 v[164:167], v[248:251], v[180:183], v[164:167]
	v_mfma_f32_16x16x32_bf16 v[168:171], v[248:251], v[184:187], v[168:171]
	ds_read_b128 v[248:251], v26 offset:15360
	s_waitcnt lgkmcnt(6)
	v_mfma_f32_16x16x32_bf16 v[172:175], v[252:255], v[180:183], v[172:175]
	v_mfma_f32_16x16x32_bf16 v[176:179], v[252:255], v[184:187], v[176:179]
	ds_read_b128 v[252:255], v26 offset:16384
	s_waitcnt vmcnt(8) lgkmcnt(6)
	v_mfma_f32_16x16x32_bf16 v[100:103], v[228:231], v[188:191], v[100:103]
	v_mfma_f32_16x16x32_bf16 v[104:107], v[228:231], v[192:195], v[104:107]
	ds_read_b128 v[228:231], v26 offset:17408
	s_waitcnt lgkmcnt(6)
	v_mfma_f32_16x16x32_bf16 v[108:111], v[232:235], v[188:191], v[108:111]
	v_mfma_f32_16x16x32_bf16 v[112:115], v[232:235], v[192:195], v[112:115]
	ds_read_b128 v[232:235], v26 offset:18432
	s_waitcnt lgkmcnt(6)
	v_mfma_f32_16x16x32_bf16 v[116:119], v[236:239], v[188:191], v[116:119]
	v_mfma_f32_16x16x32_bf16 v[120:123], v[236:239], v[192:195], v[120:123]
	buffer_load_dwordx4 v[180:183], v8, s[40:43], s11 offen sc1
	ds_read_b128 v[236:239], v26 offset:19456
	s_waitcnt lgkmcnt(6)
	v_mfma_f32_16x16x32_bf16 v[124:127], v[240:243], v[188:191], v[124:127]
	v_mfma_f32_16x16x32_bf16 v[128:131], v[240:243], v[192:195], v[128:131]
	s_waitcnt lgkmcnt(0)
	s_barrier
	ds_read_b128 v[240:243], v26 offset:20480
	v_mfma_f32_16x16x32_bf16 v[132:135], v[244:247], v[188:191], v[132:135]
	v_mfma_f32_16x16x32_bf16 v[136:139], v[244:247], v[192:195], v[136:139]
	ds_read_b128 v[244:247], v26 offset:21504
	v_mfma_f32_16x16x32_bf16 v[140:143], v[248:251], v[188:191], v[140:143]
	v_mfma_f32_16x16x32_bf16 v[144:147], v[248:251], v[192:195], v[144:147]
	ds_read_b128 v[248:251], v26 offset:22528
	v_mfma_f32_16x16x32_bf16 v[148:151], v[252:255], v[188:191], v[148:151]
	v_mfma_f32_16x16x32_bf16 v[152:155], v[252:255], v[192:195], v[152:155]
	buffer_load_dwordx4 v[184:187], v10, s[40:43], s11 offen sc1
	ds_read_b128 v[252:255], v26 offset:23552
	v_mfma_f32_16x16x32_bf16 v[156:159], v[228:231], v[188:191], v[156:159]
	v_mfma_f32_16x16x32_bf16 v[160:163], v[228:231], v[192:195], v[160:163]
	ds_read_b128 v[228:231], v26 offset:24576
	v_mfma_f32_16x16x32_bf16 v[164:167], v[232:235], v[188:191], v[164:167]
	v_mfma_f32_16x16x32_bf16 v[168:171], v[232:235], v[192:195], v[168:171]
	ds_read_b128 v[232:235], v26 offset:25600
	v_mfma_f32_16x16x32_bf16 v[172:175], v[236:239], v[188:191], v[172:175]
	v_mfma_f32_16x16x32_bf16 v[176:179], v[236:239], v[192:195], v[176:179]
	ds_read_b128 v[236:239], v26 offset:26624
	s_waitcnt vmcnt(8) lgkmcnt(6)
	v_mfma_f32_16x16x32_bf16 v[100:103], v[240:243], v[196:199], v[100:103]
	v_mfma_f32_16x16x32_bf16 v[104:107], v[240:243], v[200:203], v[104:107]
	ds_read_b128 v[240:243], v26 offset:27648
	s_waitcnt lgkmcnt(6)
	v_mfma_f32_16x16x32_bf16 v[108:111], v[244:247], v[196:199], v[108:111]
	v_mfma_f32_16x16x32_bf16 v[112:115], v[244:247], v[200:203], v[112:115]
	ds_read_b128 v[244:247], v26 offset:28672
	s_waitcnt lgkmcnt(6)
	v_mfma_f32_16x16x32_bf16 v[116:119], v[248:251], v[196:199], v[116:119]
	v_mfma_f32_16x16x32_bf16 v[120:123], v[248:251], v[200:203], v[120:123]
	buffer_load_dwordx4 v[188:191], v8, s[40:43], s11 offen offset:1024 sc1
	ds_read_b128 v[248:251], v26 offset:29696
	s_waitcnt lgkmcnt(6)
	v_mfma_f32_16x16x32_bf16 v[124:127], v[252:255], v[196:199], v[124:127]
	v_mfma_f32_16x16x32_bf16 v[128:131], v[252:255], v[200:203], v[128:131]
	ds_read_b128 v[252:255], v26 offset:30720
	s_waitcnt lgkmcnt(6)
	v_mfma_f32_16x16x32_bf16 v[132:135], v[228:231], v[196:199], v[132:135]
	v_mfma_f32_16x16x32_bf16 v[136:139], v[228:231], v[200:203], v[136:139]
	ds_read_b128 v[228:231], v26 offset:31744
	s_waitcnt lgkmcnt(6)
	v_mfma_f32_16x16x32_bf16 v[140:143], v[232:235], v[196:199], v[140:143]
	v_mfma_f32_16x16x32_bf16 v[144:147], v[232:235], v[200:203], v[144:147]
	ds_read_b128 v[232:235], v26 offset:32768
	s_waitcnt lgkmcnt(6)
	v_mfma_f32_16x16x32_bf16 v[148:151], v[236:239], v[196:199], v[148:151]
	v_mfma_f32_16x16x32_bf16 v[152:155], v[236:239], v[200:203], v[152:155]
	buffer_load_dwordx4 v[192:195], v10, s[40:43], s11 offen offset:1024 sc1
	ds_read_b128 v[236:239], v26 offset:33792
	s_waitcnt lgkmcnt(6)
	v_mfma_f32_16x16x32_bf16 v[156:159], v[240:243], v[196:199], v[156:159]
	v_mfma_f32_16x16x32_bf16 v[160:163], v[240:243], v[200:203], v[160:163]
	ds_read_b128 v[240:243], v26 offset:34816
	s_waitcnt lgkmcnt(6)
	v_mfma_f32_16x16x32_bf16 v[164:167], v[244:247], v[196:199], v[164:167]
	v_mfma_f32_16x16x32_bf16 v[168:171], v[244:247], v[200:203], v[168:171]
	ds_read_b128 v[244:247], v26 offset:35840
	s_waitcnt lgkmcnt(6)
	v_mfma_f32_16x16x32_bf16 v[172:175], v[248:251], v[196:199], v[172:175]
	v_mfma_f32_16x16x32_bf16 v[176:179], v[248:251], v[200:203], v[176:179]
	ds_read_b128 v[248:251], v26 offset:36864
	s_waitcnt vmcnt(8) lgkmcnt(6)
	v_mfma_f32_16x16x32_bf16 v[100:103], v[252:255], v[204:207], v[100:103]
	v_mfma_f32_16x16x32_bf16 v[104:107], v[252:255], v[208:211], v[104:107]
	ds_read_b128 v[252:255], v26 offset:37888
	s_waitcnt lgkmcnt(6)
	v_mfma_f32_16x16x32_bf16 v[108:111], v[228:231], v[204:207], v[108:111]
	v_mfma_f32_16x16x32_bf16 v[112:115], v[228:231], v[208:211], v[112:115]
	ds_read_b128 v[228:231], v26 offset:38912
	s_waitcnt lgkmcnt(6)
	v_mfma_f32_16x16x32_bf16 v[116:119], v[232:235], v[204:207], v[116:119]
	v_mfma_f32_16x16x32_bf16 v[120:123], v[232:235], v[208:211], v[120:123]
	buffer_load_dwordx4 v[196:199], v8, s[40:43], s11 offen offset:2048 sc1
	ds_read_b128 v[232:235], v26 offset:39936
	s_waitcnt lgkmcnt(6)
	v_mfma_f32_16x16x32_bf16 v[124:127], v[236:239], v[204:207], v[124:127]
	v_mfma_f32_16x16x32_bf16 v[128:131], v[236:239], v[208:211], v[128:131]
	s_waitcnt lgkmcnt(0)
	s_barrier
	ds_read_b128 v[236:239], v26 offset:40960
	v_mfma_f32_16x16x32_bf16 v[132:135], v[240:243], v[204:207], v[132:135]
	v_mfma_f32_16x16x32_bf16 v[136:139], v[240:243], v[208:211], v[136:139]
	ds_read_b128 v[240:243], v26 offset:41984
	v_mfma_f32_16x16x32_bf16 v[140:143], v[244:247], v[204:207], v[140:143]
	v_mfma_f32_16x16x32_bf16 v[144:147], v[244:247], v[208:211], v[144:147]
	ds_read_b128 v[244:247], v26 offset:43008
	v_mfma_f32_16x16x32_bf16 v[148:151], v[248:251], v[204:207], v[148:151]
	v_mfma_f32_16x16x32_bf16 v[152:155], v[248:251], v[208:211], v[152:155]
	buffer_load_dwordx4 v[200:203], v10, s[40:43], s11 offen offset:2048 sc1
	ds_read_b128 v[248:251], v26 offset:44032
	v_mfma_f32_16x16x32_bf16 v[156:159], v[252:255], v[204:207], v[156:159]
	v_mfma_f32_16x16x32_bf16 v[160:163], v[252:255], v[208:211], v[160:163]
	ds_read_b128 v[252:255], v26 offset:45056
	v_mfma_f32_16x16x32_bf16 v[164:167], v[228:231], v[204:207], v[164:167]
	v_mfma_f32_16x16x32_bf16 v[168:171], v[228:231], v[208:211], v[168:171]
	ds_read_b128 v[228:231], v26 offset:46080
	v_mfma_f32_16x16x32_bf16 v[172:175], v[232:235], v[204:207], v[172:175]
	v_mfma_f32_16x16x32_bf16 v[176:179], v[232:235], v[208:211], v[176:179]
	ds_read_b128 v[232:235], v26 offset:47104
	s_waitcnt vmcnt(8) lgkmcnt(6)
	v_mfma_f32_16x16x32_bf16 v[100:103], v[236:239], v[212:215], v[100:103]
	v_mfma_f32_16x16x32_bf16 v[104:107], v[236:239], v[216:219], v[104:107]
	ds_read_b128 v[236:239], v26 offset:48128
	s_waitcnt lgkmcnt(6)
	v_mfma_f32_16x16x32_bf16 v[108:111], v[240:243], v[212:215], v[108:111]
	v_mfma_f32_16x16x32_bf16 v[112:115], v[240:243], v[216:219], v[112:115]
	ds_read_b128 v[240:243], v26 offset:49152
	s_waitcnt lgkmcnt(6)
	v_mfma_f32_16x16x32_bf16 v[116:119], v[244:247], v[212:215], v[116:119]
	v_mfma_f32_16x16x32_bf16 v[120:123], v[244:247], v[216:219], v[120:123]
	buffer_load_dwordx4 v[204:207], v8, s[40:43], s11 offen offset:3072 sc1
	ds_read_b128 v[244:247], v26 offset:50176
	s_waitcnt lgkmcnt(6)
	v_mfma_f32_16x16x32_bf16 v[124:127], v[248:251], v[212:215], v[124:127]
	v_mfma_f32_16x16x32_bf16 v[128:131], v[248:251], v[216:219], v[128:131]
	ds_read_b128 v[248:251], v26 offset:51200
	s_waitcnt lgkmcnt(6)
	v_mfma_f32_16x16x32_bf16 v[132:135], v[252:255], v[212:215], v[132:135]
	v_mfma_f32_16x16x32_bf16 v[136:139], v[252:255], v[216:219], v[136:139]
	ds_read_b128 v[252:255], v26 offset:52224
	s_waitcnt lgkmcnt(6)
	v_mfma_f32_16x16x32_bf16 v[140:143], v[228:231], v[212:215], v[140:143]
	v_mfma_f32_16x16x32_bf16 v[144:147], v[228:231], v[216:219], v[144:147]
	ds_read_b128 v[228:231], v26 offset:53248
	s_waitcnt lgkmcnt(6)
	v_mfma_f32_16x16x32_bf16 v[148:151], v[232:235], v[212:215], v[148:151]
	v_mfma_f32_16x16x32_bf16 v[152:155], v[232:235], v[216:219], v[152:155]
	buffer_load_dwordx4 v[208:211], v10, s[40:43], s11 offen offset:3072 sc1
	s_add_u32 s11, s11, 4096
	ds_read_b128 v[232:235], v26 offset:54272
	s_waitcnt lgkmcnt(6)
	v_mfma_f32_16x16x32_bf16 v[156:159], v[236:239], v[212:215], v[156:159]
	v_mfma_f32_16x16x32_bf16 v[160:163], v[236:239], v[216:219], v[160:163]
	ds_read_b128 v[236:239], v26 offset:55296
	s_waitcnt lgkmcnt(6)
	v_mfma_f32_16x16x32_bf16 v[164:167], v[240:243], v[212:215], v[164:167]
	v_mfma_f32_16x16x32_bf16 v[168:171], v[240:243], v[216:219], v[168:171]
	ds_read_b128 v[240:243], v26 offset:56320
	s_waitcnt lgkmcnt(6)
	v_mfma_f32_16x16x32_bf16 v[172:175], v[244:247], v[212:215], v[172:175]
	v_mfma_f32_16x16x32_bf16 v[176:179], v[244:247], v[216:219], v[176:179]
	ds_read_b128 v[244:247], v26 offset:57344
	s_waitcnt vmcnt(8) lgkmcnt(6)
	v_mfma_f32_16x16x32_bf16 v[100:103], v[248:251], v[220:223], v[100:103]
	v_mfma_f32_16x16x32_bf16 v[104:107], v[248:251], v[224:227], v[104:107]
	ds_read_b128 v[248:251], v26 offset:58368
	s_waitcnt lgkmcnt(6)
	v_mfma_f32_16x16x32_bf16 v[108:111], v[252:255], v[220:223], v[108:111]
	v_mfma_f32_16x16x32_bf16 v[112:115], v[252:255], v[224:227], v[112:115]
	ds_read_b128 v[252:255], v26 offset:59392
	s_waitcnt lgkmcnt(6)
	v_mfma_f32_16x16x32_bf16 v[116:119], v[228:231], v[220:223], v[116:119]
	v_mfma_f32_16x16x32_bf16 v[120:123], v[228:231], v[224:227], v[120:123]
	buffer_load_dwordx4 v[212:215], v8, s[40:43], s11 offen sc1
	ds_read_b128 v[228:231], v26 offset:60416
	s_waitcnt lgkmcnt(6)
	v_mfma_f32_16x16x32_bf16 v[124:127], v[232:235], v[220:223], v[124:127]
	v_mfma_f32_16x16x32_bf16 v[128:131], v[232:235], v[224:227], v[128:131]
	s_waitcnt lgkmcnt(0)
	s_barrier
	ds_read_b128 v[232:235], v26 offset:0
	v_mfma_f32_16x16x32_bf16 v[132:135], v[236:239], v[220:223], v[132:135]
	v_mfma_f32_16x16x32_bf16 v[136:139], v[236:239], v[224:227], v[136:139]
	ds_read_b128 v[236:239], v26 offset:1024
	v_mfma_f32_16x16x32_bf16 v[140:143], v[240:243], v[220:223], v[140:143]
	v_mfma_f32_16x16x32_bf16 v[144:147], v[240:243], v[224:227], v[144:147]
	ds_read_b128 v[240:243], v26 offset:2048
	v_mfma_f32_16x16x32_bf16 v[148:151], v[244:247], v[220:223], v[148:151]
	v_mfma_f32_16x16x32_bf16 v[152:155], v[244:247], v[224:227], v[152:155]
	buffer_load_dwordx4 v[216:219], v10, s[40:43], s11 offen sc1
	ds_read_b128 v[244:247], v26 offset:3072
	v_mfma_f32_16x16x32_bf16 v[156:159], v[248:251], v[220:223], v[156:159]
	v_mfma_f32_16x16x32_bf16 v[160:163], v[248:251], v[224:227], v[160:163]
	ds_read_b128 v[248:251], v26 offset:4096
	v_mfma_f32_16x16x32_bf16 v[164:167], v[252:255], v[220:223], v[164:167]
	v_mfma_f32_16x16x32_bf16 v[168:171], v[252:255], v[224:227], v[168:171]
	ds_read_b128 v[252:255], v26 offset:5120
	v_mfma_f32_16x16x32_bf16 v[172:175], v[228:231], v[220:223], v[172:175]
	v_mfma_f32_16x16x32_bf16 v[176:179], v[228:231], v[224:227], v[176:179]
	ds_read_b128 v[228:231], v26 offset:6144
	s_waitcnt vmcnt(8) lgkmcnt(6)
	v_mfma_f32_16x16x32_bf16 v[100:103], v[232:235], v[180:183], v[100:103]
	v_mfma_f32_16x16x32_bf16 v[104:107], v[232:235], v[184:187], v[104:107]
	ds_read_b128 v[232:235], v26 offset:7168
	s_waitcnt lgkmcnt(6)
	v_mfma_f32_16x16x32_bf16 v[108:111], v[236:239], v[180:183], v[108:111]
	v_mfma_f32_16x16x32_bf16 v[112:115], v[236:239], v[184:187], v[112:115]
	ds_read_b128 v[236:239], v26 offset:8192
	s_waitcnt lgkmcnt(6)
	v_mfma_f32_16x16x32_bf16 v[116:119], v[240:243], v[180:183], v[116:119]
	v_mfma_f32_16x16x32_bf16 v[120:123], v[240:243], v[184:187], v[120:123]
	buffer_load_dwordx4 v[220:223], v8, s[40:43], s11 offen offset:1024 sc1
	ds_read_b128 v[240:243], v26 offset:9216
	s_waitcnt lgkmcnt(6)
	v_mfma_f32_16x16x32_bf16 v[124:127], v[244:247], v[180:183], v[124:127]
	v_mfma_f32_16x16x32_bf16 v[128:131], v[244:247], v[184:187], v[128:131]
	ds_read_b128 v[244:247], v26 offset:10240
	s_waitcnt lgkmcnt(6)
	v_mfma_f32_16x16x32_bf16 v[132:135], v[248:251], v[180:183], v[132:135]
	v_mfma_f32_16x16x32_bf16 v[136:139], v[248:251], v[184:187], v[136:139]
	ds_read_b128 v[248:251], v26 offset:11264
	s_waitcnt lgkmcnt(6)
	v_mfma_f32_16x16x32_bf16 v[140:143], v[252:255], v[180:183], v[140:143]
	v_mfma_f32_16x16x32_bf16 v[144:147], v[252:255], v[184:187], v[144:147]
	ds_read_b128 v[252:255], v26 offset:12288
	s_waitcnt lgkmcnt(6)
	v_mfma_f32_16x16x32_bf16 v[148:151], v[228:231], v[180:183], v[148:151]
	v_mfma_f32_16x16x32_bf16 v[152:155], v[228:231], v[184:187], v[152:155]
	buffer_load_dwordx4 v[224:227], v10, s[40:43], s11 offen offset:1024 sc1
	ds_read_b128 v[228:231], v26 offset:13312
	s_waitcnt lgkmcnt(6)
	v_mfma_f32_16x16x32_bf16 v[156:159], v[232:235], v[180:183], v[156:159]
	v_mfma_f32_16x16x32_bf16 v[160:163], v[232:235], v[184:187], v[160:163]
	ds_read_b128 v[232:235], v26 offset:14336
	s_waitcnt lgkmcnt(6)
	v_mfma_f32_16x16x32_bf16 v[164:167], v[236:239], v[180:183], v[164:167]
	v_mfma_f32_16x16x32_bf16 v[168:171], v[236:239], v[184:187], v[168:171]
	ds_read_b128 v[236:239], v26 offset:15360
	s_waitcnt lgkmcnt(6)
	v_mfma_f32_16x16x32_bf16 v[172:175], v[240:243], v[180:183], v[172:175]
	v_mfma_f32_16x16x32_bf16 v[176:179], v[240:243], v[184:187], v[176:179]
	ds_read_b128 v[240:243], v26 offset:16384
	s_waitcnt vmcnt(8) lgkmcnt(6)
	v_mfma_f32_16x16x32_bf16 v[100:103], v[244:247], v[188:191], v[100:103]
	v_mfma_f32_16x16x32_bf16 v[104:107], v[244:247], v[192:195], v[104:107]
	ds_read_b128 v[244:247], v26 offset:17408
	s_waitcnt lgkmcnt(6)
	v_mfma_f32_16x16x32_bf16 v[108:111], v[248:251], v[188:191], v[108:111]
	v_mfma_f32_16x16x32_bf16 v[112:115], v[248:251], v[192:195], v[112:115]
	ds_read_b128 v[248:251], v26 offset:18432
	s_waitcnt lgkmcnt(6)
	v_mfma_f32_16x16x32_bf16 v[116:119], v[252:255], v[188:191], v[116:119]
	v_mfma_f32_16x16x32_bf16 v[120:123], v[252:255], v[192:195], v[120:123]
	buffer_load_dwordx4 v[180:183], v8, s[40:43], s11 offen offset:2048 sc1
	ds_read_b128 v[252:255], v26 offset:19456
	s_waitcnt lgkmcnt(6)
	v_mfma_f32_16x16x32_bf16 v[124:127], v[228:231], v[188:191], v[124:127]
	v_mfma_f32_16x16x32_bf16 v[128:131], v[228:231], v[192:195], v[128:131]
	s_waitcnt lgkmcnt(0)
	s_barrier
	ds_read_b128 v[228:231], v26 offset:20480
	v_mfma_f32_16x16x32_bf16 v[132:135], v[232:235], v[188:191], v[132:135]
	v_mfma_f32_16x16x32_bf16 v[136:139], v[232:235], v[192:195], v[136:139]
	ds_read_b128 v[232:235], v26 offset:21504
	v_mfma_f32_16x16x32_bf16 v[140:143], v[236:239], v[188:191], v[140:143]
	v_mfma_f32_16x16x32_bf16 v[144:147], v[236:239], v[192:195], v[144:147]
	ds_read_b128 v[236:239], v26 offset:22528
	v_mfma_f32_16x16x32_bf16 v[148:151], v[240:243], v[188:191], v[148:151]
	v_mfma_f32_16x16x32_bf16 v[152:155], v[240:243], v[192:195], v[152:155]
	buffer_load_dwordx4 v[184:187], v10, s[40:43], s11 offen offset:2048 sc1
	ds_read_b128 v[240:243], v26 offset:23552
	v_mfma_f32_16x16x32_bf16 v[156:159], v[244:247], v[188:191], v[156:159]
	v_mfma_f32_16x16x32_bf16 v[160:163], v[244:247], v[192:195], v[160:163]
	ds_read_b128 v[244:247], v26 offset:24576
	v_mfma_f32_16x16x32_bf16 v[164:167], v[248:251], v[188:191], v[164:167]
	v_mfma_f32_16x16x32_bf16 v[168:171], v[248:251], v[192:195], v[168:171]
	ds_read_b128 v[248:251], v26 offset:25600
	v_mfma_f32_16x16x32_bf16 v[172:175], v[252:255], v[188:191], v[172:175]
	v_mfma_f32_16x16x32_bf16 v[176:179], v[252:255], v[192:195], v[176:179]
	ds_read_b128 v[252:255], v26 offset:26624
	s_waitcnt vmcnt(8) lgkmcnt(6)
	v_mfma_f32_16x16x32_bf16 v[100:103], v[228:231], v[196:199], v[100:103]
	v_mfma_f32_16x16x32_bf16 v[104:107], v[228:231], v[200:203], v[104:107]
	ds_read_b128 v[228:231], v26 offset:27648
	s_waitcnt lgkmcnt(6)
	v_mfma_f32_16x16x32_bf16 v[108:111], v[232:235], v[196:199], v[108:111]
	v_mfma_f32_16x16x32_bf16 v[112:115], v[232:235], v[200:203], v[112:115]
	ds_read_b128 v[232:235], v26 offset:28672
	s_waitcnt lgkmcnt(6)
	v_mfma_f32_16x16x32_bf16 v[116:119], v[236:239], v[196:199], v[116:119]
	v_mfma_f32_16x16x32_bf16 v[120:123], v[236:239], v[200:203], v[120:123]
	buffer_load_dwordx4 v[188:191], v8, s[40:43], s11 offen offset:3072 sc1
	ds_read_b128 v[236:239], v26 offset:29696
	s_waitcnt lgkmcnt(6)
	v_mfma_f32_16x16x32_bf16 v[124:127], v[240:243], v[196:199], v[124:127]
	v_mfma_f32_16x16x32_bf16 v[128:131], v[240:243], v[200:203], v[128:131]
	ds_read_b128 v[240:243], v26 offset:30720
	s_waitcnt lgkmcnt(6)
	v_mfma_f32_16x16x32_bf16 v[132:135], v[244:247], v[196:199], v[132:135]
	v_mfma_f32_16x16x32_bf16 v[136:139], v[244:247], v[200:203], v[136:139]
	ds_read_b128 v[244:247], v26 offset:31744
	s_waitcnt lgkmcnt(6)
	v_mfma_f32_16x16x32_bf16 v[140:143], v[248:251], v[196:199], v[140:143]
	v_mfma_f32_16x16x32_bf16 v[144:147], v[248:251], v[200:203], v[144:147]
	ds_read_b128 v[248:251], v26 offset:32768
	s_waitcnt lgkmcnt(6)
	v_mfma_f32_16x16x32_bf16 v[148:151], v[252:255], v[196:199], v[148:151]
	v_mfma_f32_16x16x32_bf16 v[152:155], v[252:255], v[200:203], v[152:155]
	buffer_load_dwordx4 v[192:195], v10, s[40:43], s11 offen offset:3072 sc1
	s_add_u32 s11, s11, 4096
	ds_read_b128 v[252:255], v26 offset:33792
	s_waitcnt lgkmcnt(6)
	v_mfma_f32_16x16x32_bf16 v[156:159], v[228:231], v[196:199], v[156:159]
	v_mfma_f32_16x16x32_bf16 v[160:163], v[228:231], v[200:203], v[160:163]
	ds_read_b128 v[228:231], v26 offset:34816
	s_waitcnt lgkmcnt(6)
	v_mfma_f32_16x16x32_bf16 v[164:167], v[232:235], v[196:199], v[164:167]
	v_mfma_f32_16x16x32_bf16 v[168:171], v[232:235], v[200:203], v[168:171]
	ds_read_b128 v[232:235], v26 offset:35840
	s_waitcnt lgkmcnt(6)
	v_mfma_f32_16x16x32_bf16 v[172:175], v[236:239], v[196:199], v[172:175]
	v_mfma_f32_16x16x32_bf16 v[176:179], v[236:239], v[200:203], v[176:179]
	ds_read_b128 v[236:239], v26 offset:36864
	s_waitcnt vmcnt(8) lgkmcnt(6)
	v_mfma_f32_16x16x32_bf16 v[100:103], v[240:243], v[204:207], v[100:103]
	v_mfma_f32_16x16x32_bf16 v[104:107], v[240:243], v[208:211], v[104:107]
	ds_read_b128 v[240:243], v26 offset:37888
	s_waitcnt lgkmcnt(6)
	v_mfma_f32_16x16x32_bf16 v[108:111], v[244:247], v[204:207], v[108:111]
	v_mfma_f32_16x16x32_bf16 v[112:115], v[244:247], v[208:211], v[112:115]
	ds_read_b128 v[244:247], v26 offset:38912
	s_waitcnt lgkmcnt(6)
	v_mfma_f32_16x16x32_bf16 v[116:119], v[248:251], v[204:207], v[116:119]
	v_mfma_f32_16x16x32_bf16 v[120:123], v[248:251], v[208:211], v[120:123]
	ds_read_b128 v[248:251], v26 offset:39936
	s_waitcnt lgkmcnt(6)
	v_mfma_f32_16x16x32_bf16 v[124:127], v[252:255], v[204:207], v[124:127]
	v_mfma_f32_16x16x32_bf16 v[128:131], v[252:255], v[208:211], v[128:131]
	s_waitcnt lgkmcnt(0)
	s_barrier
	ds_read_b128 v[252:255], v26 offset:40960
	v_mfma_f32_16x16x32_bf16 v[132:135], v[228:231], v[204:207], v[132:135]
	v_mfma_f32_16x16x32_bf16 v[136:139], v[228:231], v[208:211], v[136:139]
	ds_read_b128 v[228:231], v26 offset:41984
	v_mfma_f32_16x16x32_bf16 v[140:143], v[232:235], v[204:207], v[140:143]
	v_mfma_f32_16x16x32_bf16 v[144:147], v[232:235], v[208:211], v[144:147]
	ds_read_b128 v[232:235], v26 offset:43008
	v_mfma_f32_16x16x32_bf16 v[148:151], v[236:239], v[204:207], v[148:151]
	v_mfma_f32_16x16x32_bf16 v[152:155], v[236:239], v[208:211], v[152:155]
	ds_read_b128 v[236:239], v26 offset:44032
	v_mfma_f32_16x16x32_bf16 v[156:159], v[240:243], v[204:207], v[156:159]
	v_mfma_f32_16x16x32_bf16 v[160:163], v[240:243], v[208:211], v[160:163]
	ds_read_b128 v[240:243], v26 offset:45056
	v_mfma_f32_16x16x32_bf16 v[164:167], v[244:247], v[204:207], v[164:167]
	v_mfma_f32_16x16x32_bf16 v[168:171], v[244:247], v[208:211], v[168:171]
	ds_read_b128 v[244:247], v26 offset:46080
	v_mfma_f32_16x16x32_bf16 v[172:175], v[248:251], v[204:207], v[172:175]
	v_mfma_f32_16x16x32_bf16 v[176:179], v[248:251], v[208:211], v[176:179]
	ds_read_b128 v[248:251], v26 offset:47104
	s_waitcnt vmcnt(6) lgkmcnt(6)
	v_mfma_f32_16x16x32_bf16 v[100:103], v[252:255], v[212:215], v[100:103]
	v_mfma_f32_16x16x32_bf16 v[104:107], v[252:255], v[216:219], v[104:107]
	ds_read_b128 v[252:255], v26 offset:48128
	s_waitcnt lgkmcnt(6)
	v_mfma_f32_16x16x32_bf16 v[108:111], v[228:231], v[212:215], v[108:111]
	v_mfma_f32_16x16x32_bf16 v[112:115], v[228:231], v[216:219], v[112:115]
	ds_read_b128 v[228:231], v26 offset:49152
	s_waitcnt lgkmcnt(6)
	v_mfma_f32_16x16x32_bf16 v[116:119], v[232:235], v[212:215], v[116:119]
	v_mfma_f32_16x16x32_bf16 v[120:123], v[232:235], v[216:219], v[120:123]
	ds_read_b128 v[232:235], v26 offset:50176
	s_waitcnt lgkmcnt(6)
	v_mfma_f32_16x16x32_bf16 v[124:127], v[236:239], v[212:215], v[124:127]
	v_mfma_f32_16x16x32_bf16 v[128:131], v[236:239], v[216:219], v[128:131]
	ds_read_b128 v[236:239], v26 offset:51200
	s_waitcnt lgkmcnt(6)
	v_mfma_f32_16x16x32_bf16 v[132:135], v[240:243], v[212:215], v[132:135]
	v_mfma_f32_16x16x32_bf16 v[136:139], v[240:243], v[216:219], v[136:139]
	ds_read_b128 v[240:243], v26 offset:52224
	s_waitcnt lgkmcnt(6)
	v_mfma_f32_16x16x32_bf16 v[140:143], v[244:247], v[212:215], v[140:143]
	v_mfma_f32_16x16x32_bf16 v[144:147], v[244:247], v[216:219], v[144:147]
	ds_read_b128 v[244:247], v26 offset:53248
	s_waitcnt lgkmcnt(6)
	v_mfma_f32_16x16x32_bf16 v[148:151], v[248:251], v[212:215], v[148:151]
	v_mfma_f32_16x16x32_bf16 v[152:155], v[248:251], v[216:219], v[152:155]
	ds_read_b128 v[248:251], v26 offset:54272
	s_waitcnt lgkmcnt(6)
	v_mfma_f32_16x16x32_bf16 v[156:159], v[252:255], v[212:215], v[156:159]
	v_mfma_f32_16x16x32_bf16 v[160:163], v[252:255], v[216:219], v[160:163]
	ds_read_b128 v[252:255], v26 offset:55296
	s_waitcnt lgkmcnt(6)
	v_mfma_f32_16x16x32_bf16 v[164:167], v[228:231], v[212:215], v[164:167]
	v_mfma_f32_16x16x32_bf16 v[168:171], v[228:231], v[216:219], v[168:171]
	ds_read_b128 v[228:231], v26 offset:56320
	s_waitcnt lgkmcnt(6)
	v_mfma_f32_16x16x32_bf16 v[172:175], v[232:235], v[212:215], v[172:175]
	v_mfma_f32_16x16x32_bf16 v[176:179], v[232:235], v[216:219], v[176:179]
	ds_read_b128 v[232:235], v26 offset:57344
	s_waitcnt vmcnt(4) lgkmcnt(6)
	v_mfma_f32_16x16x32_bf16 v[100:103], v[236:239], v[220:223], v[100:103]
	v_mfma_f32_16x16x32_bf16 v[104:107], v[236:239], v[224:227], v[104:107]
	ds_read_b128 v[236:239], v26 offset:58368
	s_waitcnt lgkmcnt(6)
	v_mfma_f32_16x16x32_bf16 v[108:111], v[240:243], v[220:223], v[108:111]
	v_mfma_f32_16x16x32_bf16 v[112:115], v[240:243], v[224:227], v[112:115]
	ds_read_b128 v[240:243], v26 offset:59392
	s_waitcnt lgkmcnt(6)
	v_mfma_f32_16x16x32_bf16 v[116:119], v[244:247], v[220:223], v[116:119]
	v_mfma_f32_16x16x32_bf16 v[120:123], v[244:247], v[224:227], v[120:123]
	ds_read_b128 v[244:247], v26 offset:60416
	s_waitcnt lgkmcnt(6)
	v_mfma_f32_16x16x32_bf16 v[124:127], v[248:251], v[220:223], v[124:127]
	v_mfma_f32_16x16x32_bf16 v[128:131], v[248:251], v[224:227], v[128:131]
	s_waitcnt lgkmcnt(0)
	s_barrier
	ds_read_b128 v[248:251], v26 offset:0
	v_mfma_f32_16x16x32_bf16 v[132:135], v[252:255], v[220:223], v[132:135]
	v_mfma_f32_16x16x32_bf16 v[136:139], v[252:255], v[224:227], v[136:139]
	ds_read_b128 v[252:255], v26 offset:1024
	v_mfma_f32_16x16x32_bf16 v[140:143], v[228:231], v[220:223], v[140:143]
	v_mfma_f32_16x16x32_bf16 v[144:147], v[228:231], v[224:227], v[144:147]
	ds_read_b128 v[228:231], v26 offset:2048
	v_mfma_f32_16x16x32_bf16 v[148:151], v[232:235], v[220:223], v[148:151]
	v_mfma_f32_16x16x32_bf16 v[152:155], v[232:235], v[224:227], v[152:155]
	ds_read_b128 v[232:235], v26 offset:3072
	v_mfma_f32_16x16x32_bf16 v[156:159], v[236:239], v[220:223], v[156:159]
	v_mfma_f32_16x16x32_bf16 v[160:163], v[236:239], v[224:227], v[160:163]
	ds_read_b128 v[236:239], v26 offset:4096
	v_mfma_f32_16x16x32_bf16 v[164:167], v[240:243], v[220:223], v[164:167]
	v_mfma_f32_16x16x32_bf16 v[168:171], v[240:243], v[224:227], v[168:171]
	ds_read_b128 v[240:243], v26 offset:5120
	v_mfma_f32_16x16x32_bf16 v[172:175], v[244:247], v[220:223], v[172:175]
	v_mfma_f32_16x16x32_bf16 v[176:179], v[244:247], v[224:227], v[176:179]
	ds_read_b128 v[244:247], v26 offset:6144
	s_waitcnt vmcnt(2) lgkmcnt(6)
	v_mfma_f32_16x16x32_bf16 v[100:103], v[248:251], v[180:183], v[100:103]
	v_mfma_f32_16x16x32_bf16 v[104:107], v[248:251], v[184:187], v[104:107]
	ds_read_b128 v[248:251], v26 offset:7168
	s_waitcnt lgkmcnt(6)
	v_mfma_f32_16x16x32_bf16 v[108:111], v[252:255], v[180:183], v[108:111]
	v_mfma_f32_16x16x32_bf16 v[112:115], v[252:255], v[184:187], v[112:115]
	ds_read_b128 v[252:255], v26 offset:8192
	s_waitcnt lgkmcnt(6)
	v_mfma_f32_16x16x32_bf16 v[116:119], v[228:231], v[180:183], v[116:119]
	v_mfma_f32_16x16x32_bf16 v[120:123], v[228:231], v[184:187], v[120:123]
	ds_read_b128 v[228:231], v26 offset:9216
	s_waitcnt lgkmcnt(6)
	v_mfma_f32_16x16x32_bf16 v[124:127], v[232:235], v[180:183], v[124:127]
	v_mfma_f32_16x16x32_bf16 v[128:131], v[232:235], v[184:187], v[128:131]
	ds_read_b128 v[232:235], v26 offset:10240
	s_waitcnt lgkmcnt(6)
	v_mfma_f32_16x16x32_bf16 v[132:135], v[236:239], v[180:183], v[132:135]
	v_mfma_f32_16x16x32_bf16 v[136:139], v[236:239], v[184:187], v[136:139]
	ds_read_b128 v[236:239], v26 offset:11264
	s_waitcnt lgkmcnt(6)
	v_mfma_f32_16x16x32_bf16 v[140:143], v[240:243], v[180:183], v[140:143]
	v_mfma_f32_16x16x32_bf16 v[144:147], v[240:243], v[184:187], v[144:147]
	ds_read_b128 v[240:243], v26 offset:12288
	s_waitcnt lgkmcnt(6)
	v_mfma_f32_16x16x32_bf16 v[148:151], v[244:247], v[180:183], v[148:151]
	v_mfma_f32_16x16x32_bf16 v[152:155], v[244:247], v[184:187], v[152:155]
	ds_read_b128 v[244:247], v26 offset:13312
	s_waitcnt lgkmcnt(6)
	v_mfma_f32_16x16x32_bf16 v[156:159], v[248:251], v[180:183], v[156:159]
	v_mfma_f32_16x16x32_bf16 v[160:163], v[248:251], v[184:187], v[160:163]
	ds_read_b128 v[248:251], v26 offset:14336
	s_waitcnt lgkmcnt(6)
	v_mfma_f32_16x16x32_bf16 v[164:167], v[252:255], v[180:183], v[164:167]
	v_mfma_f32_16x16x32_bf16 v[168:171], v[252:255], v[184:187], v[168:171]
	ds_read_b128 v[252:255], v26 offset:15360
	s_waitcnt lgkmcnt(6)
	v_mfma_f32_16x16x32_bf16 v[172:175], v[228:231], v[180:183], v[172:175]
	v_mfma_f32_16x16x32_bf16 v[176:179], v[228:231], v[184:187], v[176:179]
	ds_read_b128 v[228:231], v26 offset:16384
	s_waitcnt vmcnt(0) lgkmcnt(6)
	v_mfma_f32_16x16x32_bf16 v[100:103], v[232:235], v[188:191], v[100:103]
	v_mfma_f32_16x16x32_bf16 v[104:107], v[232:235], v[192:195], v[104:107]
	ds_read_b128 v[232:235], v26 offset:17408
	s_waitcnt lgkmcnt(6)
	v_mfma_f32_16x16x32_bf16 v[108:111], v[236:239], v[188:191], v[108:111]
	v_mfma_f32_16x16x32_bf16 v[112:115], v[236:239], v[192:195], v[112:115]
	ds_read_b128 v[236:239], v26 offset:18432
	s_waitcnt lgkmcnt(6)
	v_mfma_f32_16x16x32_bf16 v[116:119], v[240:243], v[188:191], v[116:119]
	v_mfma_f32_16x16x32_bf16 v[120:123], v[240:243], v[192:195], v[120:123]
	ds_read_b128 v[240:243], v26 offset:19456
	s_waitcnt lgkmcnt(6)
	v_mfma_f32_16x16x32_bf16 v[124:127], v[244:247], v[188:191], v[124:127]
	v_mfma_f32_16x16x32_bf16 v[128:131], v[244:247], v[192:195], v[128:131]
	s_waitcnt lgkmcnt(5)
	v_mfma_f32_16x16x32_bf16 v[132:135], v[248:251], v[188:191], v[132:135]
	v_mfma_f32_16x16x32_bf16 v[136:139], v[248:251], v[192:195], v[136:139]
	s_waitcnt lgkmcnt(4)
	v_mfma_f32_16x16x32_bf16 v[140:143], v[252:255], v[188:191], v[140:143]
	v_mfma_f32_16x16x32_bf16 v[144:147], v[252:255], v[192:195], v[144:147]
	s_waitcnt lgkmcnt(3)
	v_mfma_f32_16x16x32_bf16 v[148:151], v[228:231], v[188:191], v[148:151]
	v_mfma_f32_16x16x32_bf16 v[152:155], v[228:231], v[192:195], v[152:155]
	s_waitcnt lgkmcnt(2)
	v_mfma_f32_16x16x32_bf16 v[156:159], v[232:235], v[188:191], v[156:159]
	v_mfma_f32_16x16x32_bf16 v[160:163], v[232:235], v[192:195], v[160:163]
	s_waitcnt lgkmcnt(1)
	v_mfma_f32_16x16x32_bf16 v[164:167], v[236:239], v[188:191], v[164:167]
	v_mfma_f32_16x16x32_bf16 v[168:171], v[236:239], v[192:195], v[168:171]
	s_waitcnt lgkmcnt(0)
	v_mfma_f32_16x16x32_bf16 v[172:175], v[240:243], v[188:191], v[172:175]
	v_mfma_f32_16x16x32_bf16 v[176:179], v[240:243], v[192:195], v[176:179]
	s_barrier
	s_lshl_b32 s4, s3, 5
	v_lshl_add_u32 v8, v2, 7, v3
	v_add_u32 v8, s4, v8
	v_mul_u32_u24 v8, 120, v8
	v_add_u32 v8, 102400, v8
	v_cvt_pk_bf16_f32 v140, v140, v141
	v_cvt_pk_bf16_f32 v141, v142, v143
	ds_write_b64 v8, v[140:141] offset:80
	v_cvt_pk_bf16_f32 v148, v148, v149
	v_cvt_pk_bf16_f32 v149, v150, v151
	ds_write_b64 v8, v[148:149] offset:88
	v_cvt_pk_bf16_f32 v156, v156, v157
	v_cvt_pk_bf16_f32 v157, v158, v159
	ds_write_b64 v8, v[156:157] offset:96
	v_cvt_pk_bf16_f32 v164, v164, v165
	v_cvt_pk_bf16_f32 v165, v166, v167
	ds_write_b64 v8, v[164:165] offset:104
	v_cvt_pk_bf16_f32 v172, v172, v173
	v_cvt_pk_bf16_f32 v173, v174, v175
	ds_write_b64 v8, v[172:173] offset:112
	v_cvt_pk_bf16_f32 v144, v144, v145
	v_cvt_pk_bf16_f32 v145, v146, v147
	ds_write_b64 v8, v[144:145] offset:2000
	v_cvt_pk_bf16_f32 v152, v152, v153
	v_cvt_pk_bf16_f32 v153, v154, v155
	ds_write_b64 v8, v[152:153] offset:2008
	v_cvt_pk_bf16_f32 v160, v160, v161
	v_cvt_pk_bf16_f32 v161, v162, v163
	ds_write_b64 v8, v[160:161] offset:2016
	v_cvt_pk_bf16_f32 v168, v168, v169
	v_cvt_pk_bf16_f32 v169, v170, v171
	ds_write_b64 v8, v[168:169] offset:2024
	v_cvt_pk_bf16_f32 v176, v176, v177
	v_cvt_pk_bf16_f32 v177, v178, v179
	ds_write_b64 v8, v[176:177] offset:2032
	v_cvt_pk_bf16_f32 v180, v100, v101
	v_cvt_pk_bf16_f32 v181, v102, v103
	v_cvt_pk_bf16_f32 v182, v108, v109
	v_cvt_pk_bf16_f32 v183, v110, v111
	v_cvt_pk_bf16_f32 v184, v116, v117
	v_cvt_pk_bf16_f32 v185, v118, v119
	v_cvt_pk_bf16_f32 v186, v124, v125
	v_cvt_pk_bf16_f32 v187, v126, v127
	v_cvt_pk_bf16_f32 v188, v132, v133
	v_cvt_pk_bf16_f32 v189, v134, v135
	v_mfma_f32_16x16x32_bf16 v[212:215], v[48:51], v[180:183], 0
	v_mfma_f32_16x16x32_bf16 v[216:219], v[56:59], v[180:183], 0
	v_mfma_f32_16x16x32_bf16 v[220:223], v[64:67], v[180:183], 0
	v_mfma_f32_16x16x32_bf16 v[224:227], v[72:75], v[180:183], 0
	v_mfma_f32_16x16x32_bf16 v[228:231], v[80:83], v[180:183], 0
	v_mfma_f32_16x16x32_bf16 v[212:215], v[52:55], v[184:187], v[212:215]
	v_mfma_f32_16x16x32_bf16 v[216:219], v[60:63], v[184:187], v[216:219]
	v_mfma_f32_16x16x32_bf16 v[220:223], v[68:71], v[184:187], v[220:223]
	v_mfma_f32_16x16x32_bf16 v[224:227], v[76:79], v[184:187], v[224:227]
	v_mfma_f32_16x16x32_bf16 v[228:231], v[84:87], v[184:187], v[228:231]
	v_mfma_f32_16x16x16_bf16 v[212:215], v[88:89], v[188:189], v[212:215]
	v_mfma_f32_16x16x16_bf16 v[216:219], v[90:91], v[188:189], v[216:219]
	v_mfma_f32_16x16x16_bf16 v[220:223], v[92:93], v[188:189], v[220:223]
	v_mfma_f32_16x16x16_bf16 v[224:227], v[94:95], v[188:189], v[224:227]
	v_mfma_f32_16x16x16_bf16 v[228:231], v[96:97], v[188:189], v[228:231]
	s_nop 3
	v_max3_f32 v32, v212, v213, v214
	v_min3_f32 v34, v212, v213, v214
	v_max3_f32 v32, v32, v215, v216
	v_min3_f32 v34, v34, v215, v216
	v_max3_f32 v32, v32, v217, v218
	v_min3_f32 v34, v34, v217, v218
	v_max3_f32 v32, v32, v219, v220
	v_min3_f32 v34, v34, v219, v220
	v_max3_f32 v32, v32, v221, v222
	v_min3_f32 v34, v34, v221, v222
	v_max3_f32 v32, v32, v223, v224
	v_min3_f32 v34, v34, v223, v224
	v_max3_f32 v32, v32, v225, v226
	v_min3_f32 v34, v34, v225, v226
	v_max3_f32 v32, v32, v227, v228
	v_min3_f32 v34, v34, v227, v228
	v_max3_f32 v32, v32, v229, v230
	v_min3_f32 v34, v34, v229, v230
	v_max_f32 v32, v32, v231
	v_min_f32 v34, v34, v231
	v_mul_f32 v32, s78, v32
	v_mul_f32 v34, s76, v34
	v_pk_fma_f32 v[100:101], v[212:213], s[76:77], v[32:33] op_sel_hi:[1,0,0]
	v_pk_fma_f32 v[192:193], v[212:213], s[78:79], v[34:35] op_sel_hi:[1,0,0]
	v_pk_fma_f32 v[102:103], v[214:215], s[76:77], v[32:33] op_sel_hi:[1,0,0]
	v_pk_fma_f32 v[194:195], v[214:215], s[78:79], v[34:35] op_sel_hi:[1,0,0]
	v_pk_fma_f32 v[108:109], v[216:217], s[76:77], v[32:33] op_sel_hi:[1,0,0]
	v_pk_fma_f32 v[196:197], v[216:217], s[78:79], v[34:35] op_sel_hi:[1,0,0]
	v_pk_fma_f32 v[110:111], v[218:219], s[76:77], v[32:33] op_sel_hi:[1,0,0]
	v_pk_fma_f32 v[198:199], v[218:219], s[78:79], v[34:35] op_sel_hi:[1,0,0]
	v_pk_fma_f32 v[116:117], v[220:221], s[76:77], v[32:33] op_sel_hi:[1,0,0]
	v_pk_fma_f32 v[200:201], v[220:221], s[78:79], v[34:35] op_sel_hi:[1,0,0]
	v_pk_fma_f32 v[118:119], v[222:223], s[76:77], v[32:33] op_sel_hi:[1,0,0]
	v_pk_fma_f32 v[202:203], v[222:223], s[78:79], v[34:35] op_sel_hi:[1,0,0]
	v_pk_fma_f32 v[124:125], v[224:225], s[76:77], v[32:33] op_sel_hi:[1,0,0]
	v_pk_fma_f32 v[204:205], v[224:225], s[78:79], v[34:35] op_sel_hi:[1,0,0]
	v_pk_fma_f32 v[126:127], v[226:227], s[76:77], v[32:33] op_sel_hi:[1,0,0]
	v_pk_fma_f32 v[206:207], v[226:227], s[78:79], v[34:35] op_sel_hi:[1,0,0]
	v_pk_fma_f32 v[132:133], v[228:229], s[76:77], v[32:33] op_sel_hi:[1,0,0]
	v_pk_fma_f32 v[208:209], v[228:229], s[78:79], v[34:35] op_sel_hi:[1,0,0]
	v_pk_fma_f32 v[134:135], v[230:231], s[76:77], v[32:33] op_sel_hi:[1,0,0]
	v_pk_fma_f32 v[210:211], v[230:231], s[78:79], v[34:35] op_sel_hi:[1,0,0]
	v_exp_f32 v100, v100
	v_exp_f32 v192, v192
	v_exp_f32 v101, v101
	v_exp_f32 v193, v193
	v_exp_f32 v102, v102
	v_exp_f32 v194, v194
	v_exp_f32 v103, v103
	v_exp_f32 v195, v195
	v_exp_f32 v108, v108
	v_exp_f32 v196, v196
	v_exp_f32 v109, v109
	v_exp_f32 v197, v197
	v_exp_f32 v110, v110
	v_exp_f32 v198, v198
	v_exp_f32 v111, v111
	v_exp_f32 v199, v199
	v_exp_f32 v116, v116
	v_exp_f32 v200, v200
	v_exp_f32 v117, v117
	v_exp_f32 v201, v201
	v_exp_f32 v118, v118
	v_exp_f32 v202, v202
	v_exp_f32 v119, v119
	v_exp_f32 v203, v203
	v_exp_f32 v124, v124
	v_exp_f32 v204, v204
	v_exp_f32 v125, v125
	v_exp_f32 v205, v205
	v_exp_f32 v126, v126
	v_exp_f32 v206, v206
	v_exp_f32 v127, v127
	v_exp_f32 v207, v207
	v_exp_f32 v132, v132
	v_exp_f32 v208, v208
	v_exp_f32 v133, v133
	v_exp_f32 v209, v209
	v_exp_f32 v134, v134
	v_exp_f32 v210, v210
	v_exp_f32 v135, v135
	v_exp_f32 v211, v211
	v_pk_add_f32 v[36:37], v[100:101], v[102:103]
	v_pk_add_f32 v[38:39], v[192:193], v[194:195]
	v_pk_add_f32 v[36:37], v[36:37], v[108:109]
	v_pk_add_f32 v[38:39], v[38:39], v[196:197]
	v_pk_add_f32 v[36:37], v[36:37], v[110:111]
	v_pk_add_f32 v[38:39], v[38:39], v[198:199]
	v_pk_add_f32 v[36:37], v[36:37], v[116:117]
	v_pk_add_f32 v[38:39], v[38:39], v[200:201]
	v_pk_add_f32 v[36:37], v[36:37], v[118:119]
	v_pk_add_f32 v[38:39], v[38:39], v[202:203]
	v_pk_add_f32 v[36:37], v[36:37], v[124:125]
	v_pk_add_f32 v[38:39], v[38:39], v[204:205]
	v_pk_add_f32 v[36:37], v[36:37], v[126:127]
	v_pk_add_f32 v[38:39], v[38:39], v[206:207]
	v_pk_add_f32 v[36:37], v[36:37], v[132:133]
	v_pk_add_f32 v[38:39], v[38:39], v[208:209]
	v_pk_add_f32 v[36:37], v[36:37], v[134:135]
	v_pk_add_f32 v[38:39], v[38:39], v[210:211]
	v_add_f32 v36, v36, v37
	v_add_f32 v38, v38, v39
	v_rcp_f32 v36, v36
	v_rcp_f32 v38, v38
	v_pk_mul_f32 v[100:101], v[100:101], v[36:37] op_sel_hi:[1,0]
	v_pk_mul_f32 v[192:193], v[192:193], v[38:39] op_sel_hi:[1,0]
	v_pk_mul_f32 v[102:103], v[102:103], v[36:37] op_sel_hi:[1,0]
	v_pk_mul_f32 v[194:195], v[194:195], v[38:39] op_sel_hi:[1,0]
	v_pk_mul_f32 v[108:109], v[108:109], v[36:37] op_sel_hi:[1,0]
	v_pk_mul_f32 v[196:197], v[196:197], v[38:39] op_sel_hi:[1,0]
	v_pk_mul_f32 v[110:111], v[110:111], v[36:37] op_sel_hi:[1,0]
	v_pk_mul_f32 v[198:199], v[198:199], v[38:39] op_sel_hi:[1,0]
	v_pk_mul_f32 v[116:117], v[116:117], v[36:37] op_sel_hi:[1,0]
	v_pk_mul_f32 v[200:201], v[200:201], v[38:39] op_sel_hi:[1,0]
	v_pk_mul_f32 v[118:119], v[118:119], v[36:37] op_sel_hi:[1,0]
	v_pk_mul_f32 v[202:203], v[202:203], v[38:39] op_sel_hi:[1,0]
	v_pk_mul_f32 v[124:125], v[124:125], v[36:37] op_sel_hi:[1,0]
	v_pk_mul_f32 v[204:205], v[204:205], v[38:39] op_sel_hi:[1,0]
	v_pk_mul_f32 v[126:127], v[126:127], v[36:37] op_sel_hi:[1,0]
	v_pk_mul_f32 v[206:207], v[206:207], v[38:39] op_sel_hi:[1,0]
	v_pk_mul_f32 v[132:133], v[132:133], v[36:37] op_sel_hi:[1,0]
	v_pk_mul_f32 v[208:209], v[208:209], v[38:39] op_sel_hi:[1,0]
	v_pk_mul_f32 v[134:135], v[134:135], v[36:37] op_sel_hi:[1,0]
	v_pk_mul_f32 v[210:211], v[210:211], v[38:39] op_sel_hi:[1,0]
	v_cvt_pk_bf16_f32 v212, v100, v101
	v_cvt_pk_bf16_f32 v213, v102, v103
	v_cvt_pk_bf16_f32 v214, v108, v109
	v_cvt_pk_bf16_f32 v215, v110, v111
	v_cvt_pk_bf16_f32 v216, v116, v117
	v_cvt_pk_bf16_f32 v217, v118, v119
	v_cvt_pk_bf16_f32 v218, v124, v125
	v_cvt_pk_bf16_f32 v219, v126, v127
	v_cvt_pk_bf16_f32 v220, v132, v133
	v_cvt_pk_bf16_f32 v221, v134, v135
	v_cvt_pk_bf16_f32 v222, v192, v193
	v_cvt_pk_bf16_f32 v223, v194, v195
	v_cvt_pk_bf16_f32 v224, v196, v197
	v_cvt_pk_bf16_f32 v225, v198, v199
	v_cvt_pk_bf16_f32 v226, v200, v201
	v_cvt_pk_bf16_f32 v227, v202, v203
	v_cvt_pk_bf16_f32 v228, v204, v205
	v_cvt_pk_bf16_f32 v229, v206, v207
	v_cvt_pk_bf16_f32 v230, v208, v209
	v_cvt_pk_bf16_f32 v231, v210, v211
	ds_write_b64 v8, v[212:213] offset:0
	ds_write_b64 v8, v[214:215] offset:8
	ds_write_b64 v8, v[216:217] offset:16
	ds_write_b64 v8, v[218:219] offset:24
	ds_write_b64 v8, v[220:221] offset:32
	ds_write_b64 v8, v[222:223] offset:40
	ds_write_b64 v8, v[224:225] offset:48
	ds_write_b64 v8, v[226:227] offset:56
	ds_write_b64 v8, v[228:229] offset:64
	ds_write_b64 v8, v[230:231] offset:72
	v_cvt_pk_bf16_f32 v180, v104, v105
	v_cvt_pk_bf16_f32 v181, v106, v107
	v_cvt_pk_bf16_f32 v182, v112, v113
	v_cvt_pk_bf16_f32 v183, v114, v115
	v_cvt_pk_bf16_f32 v184, v120, v121
	v_cvt_pk_bf16_f32 v185, v122, v123
	v_cvt_pk_bf16_f32 v186, v128, v129
	v_cvt_pk_bf16_f32 v187, v130, v131
	v_cvt_pk_bf16_f32 v188, v136, v137
	v_cvt_pk_bf16_f32 v189, v138, v139
	v_mfma_f32_16x16x32_bf16 v[232:235], v[48:51], v[180:183], 0
	v_mfma_f32_16x16x32_bf16 v[236:239], v[56:59], v[180:183], 0
	v_mfma_f32_16x16x32_bf16 v[240:243], v[64:67], v[180:183], 0
	v_mfma_f32_16x16x32_bf16 v[244:247], v[72:75], v[180:183], 0
	v_mfma_f32_16x16x32_bf16 v[248:251], v[80:83], v[180:183], 0
	v_mfma_f32_16x16x32_bf16 v[232:235], v[52:55], v[184:187], v[232:235]
	v_mfma_f32_16x16x32_bf16 v[236:239], v[60:63], v[184:187], v[236:239]
	v_mfma_f32_16x16x32_bf16 v[240:243], v[68:71], v[184:187], v[240:243]
	v_mfma_f32_16x16x32_bf16 v[244:247], v[76:79], v[184:187], v[244:247]
	v_mfma_f32_16x16x32_bf16 v[248:251], v[84:87], v[184:187], v[248:251]
	v_mfma_f32_16x16x16_bf16 v[232:235], v[88:89], v[188:189], v[232:235]
	v_mfma_f32_16x16x16_bf16 v[236:239], v[90:91], v[188:189], v[236:239]
	v_mfma_f32_16x16x16_bf16 v[240:243], v[92:93], v[188:189], v[240:243]
	v_mfma_f32_16x16x16_bf16 v[244:247], v[94:95], v[188:189], v[244:247]
	v_mfma_f32_16x16x16_bf16 v[248:251], v[96:97], v[188:189], v[248:251]
	s_nop 3
	v_max3_f32 v32, v232, v233, v234
	v_min3_f32 v34, v232, v233, v234
	v_max3_f32 v32, v32, v235, v236
	v_min3_f32 v34, v34, v235, v236
	v_max3_f32 v32, v32, v237, v238
	v_min3_f32 v34, v34, v237, v238
	v_max3_f32 v32, v32, v239, v240
	v_min3_f32 v34, v34, v239, v240
	v_max3_f32 v32, v32, v241, v242
	v_min3_f32 v34, v34, v241, v242
	v_max3_f32 v32, v32, v243, v244
	v_min3_f32 v34, v34, v243, v244
	v_max3_f32 v32, v32, v245, v246
	v_min3_f32 v34, v34, v245, v246
	v_max3_f32 v32, v32, v247, v248
	v_min3_f32 v34, v34, v247, v248
	v_max3_f32 v32, v32, v249, v250
	v_min3_f32 v34, v34, v249, v250
	v_max_f32 v32, v32, v251
	v_min_f32 v34, v34, v251
	v_mul_f32 v32, s78, v32
	v_mul_f32 v34, s76, v34
	v_pk_fma_f32 v[104:105], v[232:233], s[76:77], v[32:33] op_sel_hi:[1,0,0]
	v_pk_fma_f32 v[192:193], v[232:233], s[78:79], v[34:35] op_sel_hi:[1,0,0]
	v_pk_fma_f32 v[106:107], v[234:235], s[76:77], v[32:33] op_sel_hi:[1,0,0]
	v_pk_fma_f32 v[194:195], v[234:235], s[78:79], v[34:35] op_sel_hi:[1,0,0]
	v_pk_fma_f32 v[112:113], v[236:237], s[76:77], v[32:33] op_sel_hi:[1,0,0]
	v_pk_fma_f32 v[196:197], v[236:237], s[78:79], v[34:35] op_sel_hi:[1,0,0]
	v_pk_fma_f32 v[114:115], v[238:239], s[76:77], v[32:33] op_sel_hi:[1,0,0]
	v_pk_fma_f32 v[198:199], v[238:239], s[78:79], v[34:35] op_sel_hi:[1,0,0]
	v_pk_fma_f32 v[120:121], v[240:241], s[76:77], v[32:33] op_sel_hi:[1,0,0]
	v_pk_fma_f32 v[200:201], v[240:241], s[78:79], v[34:35] op_sel_hi:[1,0,0]
	v_pk_fma_f32 v[122:123], v[242:243], s[76:77], v[32:33] op_sel_hi:[1,0,0]
	v_pk_fma_f32 v[202:203], v[242:243], s[78:79], v[34:35] op_sel_hi:[1,0,0]
	v_pk_fma_f32 v[128:129], v[244:245], s[76:77], v[32:33] op_sel_hi:[1,0,0]
	v_pk_fma_f32 v[204:205], v[244:245], s[78:79], v[34:35] op_sel_hi:[1,0,0]
	v_pk_fma_f32 v[130:131], v[246:247], s[76:77], v[32:33] op_sel_hi:[1,0,0]
	v_pk_fma_f32 v[206:207], v[246:247], s[78:79], v[34:35] op_sel_hi:[1,0,0]
	v_pk_fma_f32 v[136:137], v[248:249], s[76:77], v[32:33] op_sel_hi:[1,0,0]
	v_pk_fma_f32 v[208:209], v[248:249], s[78:79], v[34:35] op_sel_hi:[1,0,0]
	v_pk_fma_f32 v[138:139], v[250:251], s[76:77], v[32:33] op_sel_hi:[1,0,0]
	v_pk_fma_f32 v[210:211], v[250:251], s[78:79], v[34:35] op_sel_hi:[1,0,0]
	v_exp_f32 v104, v104
	v_exp_f32 v192, v192
	v_exp_f32 v105, v105
	v_exp_f32 v193, v193
	v_exp_f32 v106, v106
	v_exp_f32 v194, v194
	v_exp_f32 v107, v107
	v_exp_f32 v195, v195
	v_exp_f32 v112, v112
	v_exp_f32 v196, v196
	v_exp_f32 v113, v113
	v_exp_f32 v197, v197
	v_exp_f32 v114, v114
	v_exp_f32 v198, v198
	v_exp_f32 v115, v115
	v_exp_f32 v199, v199
	v_exp_f32 v120, v120
	v_exp_f32 v200, v200
	v_exp_f32 v121, v121
	v_exp_f32 v201, v201
	v_exp_f32 v122, v122
	v_exp_f32 v202, v202
	v_exp_f32 v123, v123
	v_exp_f32 v203, v203
	v_exp_f32 v128, v128
	v_exp_f32 v204, v204
	v_exp_f32 v129, v129
	v_exp_f32 v205, v205
	v_exp_f32 v130, v130
	v_exp_f32 v206, v206
	v_exp_f32 v131, v131
	v_exp_f32 v207, v207
	v_exp_f32 v136, v136
	v_exp_f32 v208, v208
	v_exp_f32 v137, v137
	v_exp_f32 v209, v209
	v_exp_f32 v138, v138
	v_exp_f32 v210, v210
	v_exp_f32 v139, v139
	v_exp_f32 v211, v211
	v_pk_add_f32 v[36:37], v[104:105], v[106:107]
	v_pk_add_f32 v[38:39], v[192:193], v[194:195]
	v_pk_add_f32 v[36:37], v[36:37], v[112:113]
	v_pk_add_f32 v[38:39], v[38:39], v[196:197]
	v_pk_add_f32 v[36:37], v[36:37], v[114:115]
	v_pk_add_f32 v[38:39], v[38:39], v[198:199]
	v_pk_add_f32 v[36:37], v[36:37], v[120:121]
	v_pk_add_f32 v[38:39], v[38:39], v[200:201]
	v_pk_add_f32 v[36:37], v[36:37], v[122:123]
	v_pk_add_f32 v[38:39], v[38:39], v[202:203]
	v_pk_add_f32 v[36:37], v[36:37], v[128:129]
	v_pk_add_f32 v[38:39], v[38:39], v[204:205]
	v_pk_add_f32 v[36:37], v[36:37], v[130:131]
	v_pk_add_f32 v[38:39], v[38:39], v[206:207]
	v_pk_add_f32 v[36:37], v[36:37], v[136:137]
	v_pk_add_f32 v[38:39], v[38:39], v[208:209]
	v_pk_add_f32 v[36:37], v[36:37], v[138:139]
	v_pk_add_f32 v[38:39], v[38:39], v[210:211]
	v_add_f32 v36, v36, v37
	v_add_f32 v38, v38, v39
	v_rcp_f32 v36, v36
	v_rcp_f32 v38, v38
	v_pk_mul_f32 v[104:105], v[104:105], v[36:37] op_sel_hi:[1,0]
	v_pk_mul_f32 v[192:193], v[192:193], v[38:39] op_sel_hi:[1,0]
	v_pk_mul_f32 v[106:107], v[106:107], v[36:37] op_sel_hi:[1,0]
	v_pk_mul_f32 v[194:195], v[194:195], v[38:39] op_sel_hi:[1,0]
	v_pk_mul_f32 v[112:113], v[112:113], v[36:37] op_sel_hi:[1,0]
	v_pk_mul_f32 v[196:197], v[196:197], v[38:39] op_sel_hi:[1,0]
	v_pk_mul_f32 v[114:115], v[114:115], v[36:37] op_sel_hi:[1,0]
	v_pk_mul_f32 v[198:199], v[198:199], v[38:39] op_sel_hi:[1,0]
	v_pk_mul_f32 v[120:121], v[120:121], v[36:37] op_sel_hi:[1,0]
	v_pk_mul_f32 v[200:201], v[200:201], v[38:39] op_sel_hi:[1,0]
	v_pk_mul_f32 v[122:123], v[122:123], v[36:37] op_sel_hi:[1,0]
	v_pk_mul_f32 v[202:203], v[202:203], v[38:39] op_sel_hi:[1,0]
	v_pk_mul_f32 v[128:129], v[128:129], v[36:37] op_sel_hi:[1,0]
	v_pk_mul_f32 v[204:205], v[204:205], v[38:39] op_sel_hi:[1,0]
	v_pk_mul_f32 v[130:131], v[130:131], v[36:37] op_sel_hi:[1,0]
	v_pk_mul_f32 v[206:207], v[206:207], v[38:39] op_sel_hi:[1,0]
	v_pk_mul_f32 v[136:137], v[136:137], v[36:37] op_sel_hi:[1,0]
	v_pk_mul_f32 v[208:209], v[208:209], v[38:39] op_sel_hi:[1,0]
	v_pk_mul_f32 v[138:139], v[138:139], v[36:37] op_sel_hi:[1,0]
	v_pk_mul_f32 v[210:211], v[210:211], v[38:39] op_sel_hi:[1,0]
	v_cvt_pk_bf16_f32 v232, v104, v105
	v_cvt_pk_bf16_f32 v233, v106, v107
	v_cvt_pk_bf16_f32 v234, v112, v113
	v_cvt_pk_bf16_f32 v235, v114, v115
	v_cvt_pk_bf16_f32 v236, v120, v121
	v_cvt_pk_bf16_f32 v237, v122, v123
	v_cvt_pk_bf16_f32 v238, v128, v129
	v_cvt_pk_bf16_f32 v239, v130, v131
	v_cvt_pk_bf16_f32 v240, v136, v137
	v_cvt_pk_bf16_f32 v241, v138, v139
	v_cvt_pk_bf16_f32 v242, v192, v193
	v_cvt_pk_bf16_f32 v243, v194, v195
	v_cvt_pk_bf16_f32 v244, v196, v197
	v_cvt_pk_bf16_f32 v245, v198, v199
	v_cvt_pk_bf16_f32 v246, v200, v201
	v_cvt_pk_bf16_f32 v247, v202, v203
	v_cvt_pk_bf16_f32 v248, v204, v205
	v_cvt_pk_bf16_f32 v249, v206, v207
	v_cvt_pk_bf16_f32 v250, v208, v209
	v_cvt_pk_bf16_f32 v251, v210, v211
	ds_write_b64 v8, v[232:233] offset:1920
	ds_write_b64 v8, v[234:235] offset:1928
	ds_write_b64 v8, v[236:237] offset:1936
	ds_write_b64 v8, v[238:239] offset:1944
	ds_write_b64 v8, v[240:241] offset:1952
	ds_write_b64 v8, v[242:243] offset:1960
	ds_write_b64 v8, v[244:245] offset:1968
	ds_write_b64 v8, v[246:247] offset:1976
	ds_write_b64 v8, v[248:249] offset:1984
	ds_write_b64 v8, v[250:251] offset:1992
	s_mul_i32 s4, s3, 15360
	s_add_u32 s4, s4, 102400
	v_mul_u32_u24 v9, 120, v7
	v_lshl_add_u32 v9, v5, 3, v9
	v_add_u32 v9, s4, v9
	s_lshl_b32 s4, s68, 2
	s_add_u32 s4, s4, s3
	s_lshl_b32 s4, s4, 4
	s_add_u32 s13, s4, s69
	s_mul_i32 s4, s13, 6144
	s_add_u32 s4, s4, 13357056
	v_lshl_add_u32 v12, v1, 4, s4
	s_movk_i32 s12, 0x1000
	v_mov_b32 v11, 1073741824
	v_cmp_gt_u32 vcc, 8, v3
	s_nop 1
	v_cndmask_b32 v13, v11, v12, vcc
	v_cmp_gt_u32 vcc, 2, v2
	s_nop 1
	v_cndmask_b32 v14, v11, v12, vcc
	v_cndmask_b32 v15, v11, v13, vcc
	s_lshl_b32 s13, s13, 7
	s_add_u32 s10, s13, 19853312
	v_mov_b32 v11, 0x3f803f80
	v_cmp_eq_u32 vcc, 1, v4
	s_waitcnt lgkmcnt(0)
	s_barrier
	ds_read_b64_tr_b16 v[100:101], v9 offset:0
	ds_read_b64_tr_b16 v[102:103], v9 offset:1920
	ds_read_b64_tr_b16 v[104:105], v9 offset:32
	ds_read_b64_tr_b16 v[106:107], v9 offset:1952
	ds_read_b64_tr_b16 v[108:109], v9 offset:64
	ds_read_b64_tr_b16 v[110:111], v9 offset:1984
	ds_read_b64_tr_b16 v[112:113], v9 offset:80
	ds_read_b64_tr_b16 v[114:115], v9 offset:2000
	ds_read_b64_tr_b16 v[116:117], v9 offset:112
	ds_read_b64_tr_b16 v[118:119], v9 offset:2032
	ds_read_b64_tr_b16 v[120:121], v9 offset:3840
	ds_read_b64_tr_b16 v[122:123], v9 offset:5760
	ds_read_b64_tr_b16 v[124:125], v9 offset:3872
	ds_read_b64_tr_b16 v[126:127], v9 offset:5792
	ds_read_b64_tr_b16 v[128:129], v9 offset:3904
	ds_read_b64_tr_b16 v[130:131], v9 offset:5824
	ds_read_b64_tr_b16 v[132:133], v9 offset:3920
	ds_read_b64_tr_b16 v[134:135], v9 offset:5840
	ds_read_b64_tr_b16 v[136:137], v9 offset:3952
	ds_read_b64_tr_b16 v[138:139], v9 offset:5872
	s_waitcnt lgkmcnt(10)
	v_cndmask_b32 v116, v116, v11, vcc
	v_cndmask_b32 v117, v117, v11, vcc
	v_cndmask_b32 v118, v118, v11, vcc
	v_cndmask_b32 v119, v119, v11, vcc
	v_mfma_f32_16x16x32_bf16 v[48:51], v[112:115], v[100:103], 0
	v_mfma_f32_16x16x32_bf16 v[56:59], v[112:115], v[104:107], 0
	v_mfma_f32_16x16x32_bf16 v[64:67], v[112:115], v[108:111], 0
	v_mfma_f32_16x16x32_bf16 v[52:55], v[116:119], v[100:103], 0
	v_mfma_f32_16x16x32_bf16 v[60:63], v[116:119], v[104:107], 0
	v_mfma_f32_16x16x32_bf16 v[68:71], v[116:119], v[108:111], 0
	ds_read_b64_tr_b16 v[140:141], v9 offset:7680
	ds_read_b64_tr_b16 v[142:143], v9 offset:9600
	ds_read_b64_tr_b16 v[144:145], v9 offset:7712
	ds_read_b64_tr_b16 v[146:147], v9 offset:9632
	ds_read_b64_tr_b16 v[148:149], v9 offset:7744
	ds_read_b64_tr_b16 v[150:151], v9 offset:9664
	ds_read_b64_tr_b16 v[152:153], v9 offset:7760
	ds_read_b64_tr_b16 v[154:155], v9 offset:9680
	ds_read_b64_tr_b16 v[156:157], v9 offset:7792
	ds_read_b64_tr_b16 v[158:159], v9 offset:9712
	s_waitcnt lgkmcnt(10)
	v_cndmask_b32 v136, v136, v11, vcc
	v_cndmask_b32 v137, v137, v11, vcc
	v_cndmask_b32 v138, v138, v11, vcc
	v_cndmask_b32 v139, v139, v11, vcc
	v_mfma_f32_16x16x32_bf16 v[48:51], v[132:135], v[120:123], v[48:51]
	v_mfma_f32_16x16x32_bf16 v[56:59], v[132:135], v[124:127], v[56:59]
	v_mfma_f32_16x16x32_bf16 v[64:67], v[132:135], v[128:131], v[64:67]
	v_mfma_f32_16x16x32_bf16 v[52:55], v[136:139], v[120:123], v[52:55]
	v_mfma_f32_16x16x32_bf16 v[60:63], v[136:139], v[124:127], v[60:63]
	v_mfma_f32_16x16x32_bf16 v[68:71], v[136:139], v[128:131], v[68:71]
	ds_read_b64_tr_b16 v[160:161], v9 offset:11520
	ds_read_b64_tr_b16 v[162:163], v9 offset:13440
	ds_read_b64_tr_b16 v[164:165], v9 offset:11552
	ds_read_b64_tr_b16 v[166:167], v9 offset:13472
	ds_read_b64_tr_b16 v[168:169], v9 offset:11584
	ds_read_b64_tr_b16 v[170:171], v9 offset:13504
	ds_read_b64_tr_b16 v[172:173], v9 offset:11600
	ds_read_b64_tr_b16 v[174:175], v9 offset:13520
	ds_read_b64_tr_b16 v[176:177], v9 offset:11632
	ds_read_b64_tr_b16 v[178:179], v9 offset:13552
	s_waitcnt lgkmcnt(10)
	v_cndmask_b32 v156, v156, v11, vcc
	v_cndmask_b32 v157, v157, v11, vcc
	v_cndmask_b32 v158, v158, v11, vcc
	v_cndmask_b32 v159, v159, v11, vcc
	v_mfma_f32_16x16x32_bf16 v[48:51], v[152:155], v[140:143], v[48:51]
	v_mfma_f32_16x16x32_bf16 v[56:59], v[152:155], v[144:147], v[56:59]
	v_mfma_f32_16x16x32_bf16 v[64:67], v[152:155], v[148:151], v[64:67]
	v_mfma_f32_16x16x32_bf16 v[52:55], v[156:159], v[140:143], v[52:55]
	v_mfma_f32_16x16x32_bf16 v[60:63], v[156:159], v[144:147], v[60:63]
	v_mfma_f32_16x16x32_bf16 v[68:71], v[156:159], v[148:151], v[68:71]
	s_waitcnt lgkmcnt(0)
	v_cndmask_b32 v176, v176, v11, vcc
	v_cndmask_b32 v177, v177, v11, vcc
	v_cndmask_b32 v178, v178, v11, vcc
	v_cndmask_b32 v179, v179, v11, vcc
	v_mfma_f32_16x16x32_bf16 v[48:51], v[172:175], v[160:163], v[48:51]
	v_mfma_f32_16x16x32_bf16 v[56:59], v[172:175], v[164:167], v[56:59]
	v_mfma_f32_16x16x32_bf16 v[64:67], v[172:175], v[168:171], v[64:67]
	v_mfma_f32_16x16x32_bf16 v[52:55], v[176:179], v[160:163], v[52:55]
	v_mfma_f32_16x16x32_bf16 v[60:63], v[176:179], v[164:167], v[60:63]
	v_mfma_f32_16x16x32_bf16 v[68:71], v[176:179], v[168:171], v[68:71]
	s_nop 2
	buffer_store_dwordx4 v[48:51], v12, s[40:43], 0 offen offset:0 sc1
	s_nop 1
	buffer_store_dwordx4 v[52:55], v14, s[40:43], 0 offen offset:1024 sc1
	buffer_store_dwordx4 v[56:59], v12, s[40:43], 0 offen offset:2048 sc1
	buffer_store_dwordx4 v[60:63], v14, s[40:43], 0 offen offset:3072 sc1
	buffer_store_dwordx4 v[64:67], v13, s[40:43], s12 offen offset:0 sc1
	buffer_store_dwordx4 v[68:71], v15, s[40:43], s12 offen offset:1024 sc1
	s_waitcnt vmcnt(0)
	v_lshl_add_u32 v42, v1, 2, s10
	v_mov_b32 v43, s75
	s_mov_b64 exec, 0xffffffff
	buffer_store_dword v43, v42, s[40:43], 0 offen sc1
	s_mov_b64 exec, -1
	s_mov_b32 s10, 1073741824
	s_lshr_b32 s4, s70, 3
	s_lshl_b32 s4, s4, 2
	s_add_u32 s4, s4, s3
	s_mul_i32 s5, s4, 110592
	s_and_b32 s7, s70, 7
	s_lshl_b32 s7, s7, 9
	s_add_u32 s5, s5, s7
	v_lshrrev_b32 v24, 2, v1
	v_min_u32 v24, 13, v24
	v_lshlrev_b32 v24, 12, v24
	v_lshl_add_u32 v24, v5, 7, v24
	v_add_u32 v24, s5, v24
	buffer_load_dword v37, v24, s[56:59], 0 offen
	v_add_u32 v24, 53248, v24
	buffer_load_dword v37, v24, s[56:59], 0 offen
	s_barrier
	s_nop 0
	s_branch L_join
L_a_upper:
	s_add_u32 m0, s74, 102400
	s_nop 0
	buffer_load_dwordx4 v8, s[40:43], s10 offen sc1 lds
	buffer_load_dwordx4 v8, s[40:43], s10 offen offset:1024 sc1 lds
	buffer_load_dwordx4 v8, s[40:43], s10 offen offset:2048 sc1 lds
	buffer_load_dwordx4 v8, s[40:43], s10 offen offset:3072 sc1 lds
	s_add_u32 m0, s74, 106496
	s_nop 0
	buffer_load_dwordx4 v9, s[40:43], s10 offen sc1 lds
	s_add_u32 s10, s10, 20480
	s_add_u32 m0, s74, 122880
	s_nop 0
	buffer_load_dwordx4 v8, s[40:43], s10 offen sc1 lds
	buffer_load_dwordx4 v8, s[40:43], s10 offen offset:1024 sc1 lds
	buffer_load_dwordx4 v8, s[40:43], s10 offen offset:2048 sc1 lds
	buffer_load_dwordx4 v8, s[40:43], s10 offen offset:3072 sc1 lds
	s_add_u32 m0, s74, 126976
	s_nop 0
	buffer_load_dwordx4 v9, s[40:43], s10 offen sc1 lds
	s_add_u32 s10, s10, 20480
	s_add_u32 m0, s74, 143360
	s_nop 0
	buffer_load_dwordx4 v8, s[40:43], s10 offen sc1 lds
	buffer_load_dwordx4 v8, s[40:43], s10 offen offset:1024 sc1 lds
	buffer_load_dwordx4 v8, s[40:43], s10 offen offset:2048 sc1 lds
	buffer_load_dwordx4 v8, s[40:43], s10 offen offset:3072 sc1 lds
	s_add_u32 m0, s74, 147456
	s_nop 0
	buffer_load_dwordx4 v9, s[40:43], s10 offen sc1 lds
	s_add_u32 s10, s10, 20480
	s_waitcnt vmcnt(10)
	s_barrier
	s_add_u32 m0, s74, 0
	s_nop 0
	buffer_load_dwordx4 v8, s[40:43], s9 offen sc1 lds
	buffer_load_dwordx4 v8, s[40:43], s9 offen offset:1024 sc1 lds
	buffer_load_dwordx4 v8, s[40:43], s9 offen offset:2048 sc1 lds
	buffer_load_dwordx4 v8, s[40:43], s9 offen offset:3072 sc1 lds
	s_add_u32 m0, s74, 4096
	s_nop 0
	buffer_load_dwordx4 v9, s[40:43], s9 offen sc1 lds
	s_add_u32 s9, s9, 20480
	s_waitcnt vmcnt(10)
	s_barrier
	s_add_u32 m0, s74, 102400
	s_nop 0
	buffer_load_dwordx4 v8, s[40:43], s10 offen sc1 lds
	buffer_load_dwordx4 v8, s[40:43], s10 offen offset:1024 sc1 lds
	buffer_load_dwordx4 v8, s[40:43], s10 offen offset:2048 sc1 lds
	buffer_load_dwordx4 v8, s[40:43], s10 offen offset:3072 sc1 lds
	s_add_u32 m0, s74, 106496
	s_nop 0
	buffer_load_dwordx4 v9, s[40:43], s10 offen sc1 lds
	s_add_u32 s10, s10, 20480
	s_add_u32 m0, s74, 20480
	s_nop 0
	buffer_load_dwordx4 v8, s[40:43], s9 offen sc1 lds
	buffer_load_dwordx4 v8, s[40:43], s9 offen offset:1024 sc1 lds
	buffer_load_dwordx4 v8, s[40:43], s9 offen offset:2048 sc1 lds
	buffer_load_dwordx4 v8, s[40:43], s9 offen offset:3072 sc1 lds
	s_add_u32 m0, s74, 24576
	s_nop 0
	buffer_load_dwordx4 v9, s[40:43], s9 offen sc1 lds
	s_add_u32 s9, s9, 20480
	s_waitcnt vmcnt(15)
	s_barrier
	s_add_u32 m0, s74, 122880
	s_nop 0
	buffer_load_dwordx4 v8, s[40:43], s10 offen sc1 lds
	buffer_load_dwordx4 v8, s[40:43], s10 offen offset:1024 sc1 lds
	buffer_load_dwordx4 v8, s[40:43], s10 offen offset:2048 sc1 lds
	buffer_load_dwordx4 v8, s[40:43], s10 offen offset:3072 sc1 lds
	s_add_u32 m0, s74, 126976
	s_nop 0
	buffer_load_dwordx4 v9, s[40:43], s10 offen sc1 lds
	s_add_u32 s10, s10, 20480
	s_add_u32 m0, s74, 40960
	s_nop 0
	buffer_load_dwordx4 v8, s[40:43], s9 offen sc1 lds
	buffer_load_dwordx4 v8, s[40:43], s9 offen offset:1024 sc1 lds
	buffer_load_dwordx4 v8, s[40:43], s9 offen offset:2048 sc1 lds
	buffer_load_dwordx4 v8, s[40:43], s9 offen offset:3072 sc1 lds
	s_add_u32 m0, s74, 45056
	s_nop 0
	buffer_load_dwordx4 v9, s[40:43], s9 offen sc1 lds
	s_add_u32 s9, s9, 20480
	s_waitcnt vmcnt(15)
	s_barrier
	s_add_u32 m0, s74, 143360
	s_nop 0
	buffer_load_dwordx4 v8, s[40:43], s10 offen sc1 lds
	buffer_load_dwordx4 v8, s[40:43], s10 offen offset:1024 sc1 lds
	buffer_load_dwordx4 v8, s[40:43], s10 offen offset:2048 sc1 lds
	buffer_load_dwordx4 v8, s[40:43], s10 offen offset:3072 sc1 lds
	s_add_u32 m0, s74, 147456
	s_nop 0
	buffer_load_dwordx4 v9, s[40:43], s10 offen sc1 lds
	s_add_u32 s10, s10, 20480
	s_add_u32 m0, s74, 61440
	s_nop 0
	buffer_load_dwordx4 v8, s[40:43], s9 offen sc1 lds
	buffer_load_dwordx4 v8, s[40:43], s9 offen offset:1024 sc1 lds
	buffer_load_dwordx4 v8, s[40:43], s9 offen offset:2048 sc1 lds
	buffer_load_dwordx4 v8, s[40:43], s9 offen offset:3072 sc1 lds
	s_add_u32 m0, s74, 65536
	s_nop 0
	buffer_load_dwordx4 v9, s[40:43], s9 offen sc1 lds
	s_add_u32 s9, s9, 20480
	s_waitcnt vmcnt(15)
	s_barrier
	s_add_u32 m0, s74, 102400
	s_nop 0
	buffer_load_dwordx4 v8, s[40:43], s10 offen sc1 lds
	buffer_load_dwordx4 v8, s[40:43], s10 offen offset:1024 sc1 lds
	buffer_load_dwordx4 v8, s[40:43], s10 offen offset:2048 sc1 lds
	buffer_load_dwordx4 v8, s[40:43], s10 offen offset:3072 sc1 lds
	s_add_u32 m0, s74, 106496
	s_nop 0
	buffer_load_dwordx4 v9, s[40:43], s10 offen sc1 lds
	s_add_u32 s10, s10, 20480
	s_add_u32 m0, s74, 81920
	s_nop 0
	buffer_load_dwordx4 v8, s[40:43], s9 offen sc1 lds
	buffer_load_dwordx4 v8, s[40:43], s9 offen offset:1024 sc1 lds
	buffer_load_dwordx4 v8, s[40:43], s9 offen offset:2048 sc1 lds
	buffer_load_dwordx4 v8, s[40:43], s9 offen offset:3072 sc1 lds
	s_add_u32 m0, s74, 86016
	s_nop 0
	buffer_load_dwordx4 v9, s[40:43], s9 offen sc1 lds
	s_add_u32 s9, s9, 20480
	buffer_load_dwordx4 v[100:103], v8, s[40:43], s11 offen sc1
	buffer_load_dwordx4 v[104:107], v10, s[40:43], s11 offen sc1
	buffer_load_dwordx4 v[108:111], v8, s[40:43], s11 offen offset:1024 sc1
	buffer_load_dwordx4 v[112:115], v10, s[40:43], s11 offen offset:1024 sc1
	s_waitcnt vmcnt(19)
	s_barrier
	s_add_u32 m0, s74, 122880
	s_nop 0
	buffer_load_dwordx4 v8, s[40:43], s10 offen sc1 lds
	buffer_load_dwordx4 v8, s[40:43], s10 offen offset:1024 sc1 lds
	buffer_load_dwordx4 v8, s[40:43], s10 offen offset:2048 sc1 lds
	buffer_load_dwordx4 v8, s[40:43], s10 offen offset:3072 sc1 lds
	s_add_u32 m0, s74, 126976
	s_nop 0
	buffer_load_dwordx4 v9, s[40:43], s10 offen sc1 lds
	s_add_u32 s10, s10, 20480
	buffer_load_dwordx4 v[116:119], v8, s[40:43], s11 offen offset:2048 sc1
	buffer_load_dwordx4 v[120:123], v10, s[40:43], s11 offen offset:2048 sc1
	buffer_load_dwordx4 v[124:127], v8, s[40:43], s11 offen offset:3072 sc1
	buffer_load_dwordx4 v[128:131], v10, s[40:43], s11 offen offset:3072 sc1
	s_add_u32 s11, s11, 4096
	s_waitcnt vmcnt(18)
	s_barrier
	s_add_u32 m0, s74, 143360
	s_nop 0
	buffer_load_dwordx4 v8, s[40:43], s10 offen sc1 lds
	buffer_load_dwordx4 v8, s[40:43], s10 offen offset:1024 sc1 lds
	buffer_load_dwordx4 v8, s[40:43], s10 offen offset:2048 sc1 lds
	buffer_load_dwordx4 v8, s[40:43], s10 offen offset:3072 sc1 lds
	s_add_u32 m0, s74, 147456
	s_nop 0
	buffer_load_dwordx4 v9, s[40:43], s10 offen sc1 lds
	s_add_u32 s10, s10, 20480
	buffer_load_dwordx4 v[132:135], v8, s[40:43], s11 offen sc1
	buffer_load_dwordx4 v[136:139], v10, s[40:43], s11 offen sc1
	buffer_load_dwordx4 v[140:143], v8, s[40:43], s11 offen offset:1024 sc1
	buffer_load_dwordx4 v[144:147], v10, s[40:43], s11 offen offset:1024 sc1
	s_waitcnt vmcnt(13)
	s_barrier
	s_add_u32 m0, s74, 102400
	s_nop 0
	buffer_load_dwordx4 v8, s[40:43], s10 offen sc1 lds
	buffer_load_dwordx4 v8, s[40:43], s10 offen offset:1024 sc1 lds
	buffer_load_dwordx4 v8, s[40:43], s10 offen offset:2048 sc1 lds
	buffer_load_dwordx4 v8, s[40:43], s10 offen offset:3072 sc1 lds
	s_add_u32 m0, s74, 106496
	s_nop 0
	buffer_load_dwordx4 v9, s[40:43], s10 offen sc1 lds
	s_add_u32 s10, s10, 20480
	buffer_load_dwordx4 v[148:151], v8, s[40:43], s11 offen offset:2048 sc1
	buffer_load_dwordx4 v[152:155], v10, s[40:43], s11 offen offset:2048 sc1
	buffer_load_dwordx4 v[156:159], v8, s[40:43], s11 offen offset:3072 sc1
	buffer_load_dwordx4 v[160:163], v10, s[40:43], s11 offen offset:3072 sc1
	s_add_u32 s11, s11, 4096
	s_waitcnt vmcnt(13)
	s_barrier
	buffer_load_dwordx4 v[164:167], v8, s[40:43], s11 offen sc1
	buffer_load_dwordx4 v[168:171], v10, s[40:43], s11 offen sc1
	buffer_load_dwordx4 v[172:175], v8, s[40:43], s11 offen offset:1024 sc1
	buffer_load_dwordx4 v[176:179], v10, s[40:43], s11 offen offset:1024 sc1
	s_waitcnt vmcnt(8)
	s_barrier
	buffer_load_dwordx4 v[180:183], v8, s[40:43], s11 offen offset:2048 sc1
	buffer_load_dwordx4 v[184:187], v10, s[40:43], s11 offen offset:2048 sc1
	buffer_load_dwordx4 v[188:191], v8, s[40:43], s11 offen offset:3072 sc1
	buffer_load_dwordx4 v[192:195], v10, s[40:43], s11 offen offset:3072 sc1
	s_add_u32 s11, s11, 4096
	s_barrier
	s_barrier
	ds_read_b128 v[236:239], v8 offset:0
	ds_read_b128 v[240:243], v8 offset:1024
	ds_read_b128 v[244:247], v8 offset:2048
	ds_read_b128 v[248:251], v8 offset:3072
	ds_read_b128 v[252:255], v8 offset:4096
	s_waitcnt lgkmcnt(4)
	v_mfma_f32_16x16x32_bf16 v[196:199], v[236:239], v[100:103], 0
	v_mfma_f32_16x16x32_bf16 v[200:203], v[236:239], v[104:107], 0
	ds_read_b128 v[236:239], v8 offset:5120
	s_waitcnt lgkmcnt(4)
	v_mfma_f32_16x16x32_bf16 v[204:207], v[240:243], v[100:103], 0
	v_mfma_f32_16x16x32_bf16 v[208:211], v[240:243], v[104:107], 0
	ds_read_b128 v[240:243], v8 offset:6144
	s_waitcnt lgkmcnt(4)
	v_mfma_f32_16x16x32_bf16 v[212:215], v[244:247], v[100:103], 0
	v_mfma_f32_16x16x32_bf16 v[216:219], v[244:247], v[104:107], 0
	ds_read_b128 v[244:247], v8 offset:7168
	s_waitcnt lgkmcnt(4)
	v_mfma_f32_16x16x32_bf16 v[220:223], v[248:251], v[100:103], 0
	v_mfma_f32_16x16x32_bf16 v[224:227], v[248:251], v[104:107], 0
	ds_read_b128 v[248:251], v8 offset:8192
	s_waitcnt lgkmcnt(4)
	v_mfma_f32_16x16x32_bf16 v[228:231], v[252:255], v[100:103], 0
	v_mfma_f32_16x16x32_bf16 v[232:235], v[252:255], v[104:107], 0
	ds_read_b128 v[252:255], v8 offset:9216
	s_waitcnt lgkmcnt(4)
	v_mfma_f32_16x16x32_bf16 v[196:199], v[236:239], v[108:111], v[196:199]
	v_mfma_f32_16x16x32_bf16 v[200:203], v[236:239], v[112:115], v[200:203]
	ds_read_b128 v[236:239], v8 offset:10240
	s_waitcnt lgkmcnt(4)
	v_mfma_f32_16x16x32_bf16 v[204:207], v[240:243], v[108:111], v[204:207]
	v_mfma_f32_16x16x32_bf16 v[208:211], v[240:243], v[112:115], v[208:211]
	buffer_load_dwordx4 v[100:103], v8, s[40:43], s11 offen sc1
	ds_read_b128 v[240:243], v8 offset:11264
	s_waitcnt lgkmcnt(4)
	v_mfma_f32_16x16x32_bf16 v[212:215], v[244:247], v[108:111], v[212:215]
	v_mfma_f32_16x16x32_bf16 v[216:219], v[244:247], v[112:115], v[216:219]
	ds_read_b128 v[244:247], v8 offset:12288
	s_waitcnt lgkmcnt(4)
	v_mfma_f32_16x16x32_bf16 v[220:223], v[248:251], v[108:111], v[220:223]
	v_mfma_f32_16x16x32_bf16 v[224:227], v[248:251], v[112:115], v[224:227]
	buffer_load_dwordx4 v[104:107], v10, s[40:43], s11 offen sc1
	ds_read_b128 v[248:251], v8 offset:13312
	s_waitcnt lgkmcnt(4)
	v_mfma_f32_16x16x32_bf16 v[228:231], v[252:255], v[108:111], v[228:231]
	v_mfma_f32_16x16x32_bf16 v[232:235], v[252:255], v[112:115], v[232:235]
	ds_read_b128 v[252:255], v8 offset:14336
	s_waitcnt lgkmcnt(4)
	v_mfma_f32_16x16x32_bf16 v[196:199], v[236:239], v[116:119], v[196:199]
	v_mfma_f32_16x16x32_bf16 v[200:203], v[236:239], v[120:123], v[200:203]
	ds_read_b128 v[236:239], v8 offset:15360
	s_waitcnt lgkmcnt(4)
	v_mfma_f32_16x16x32_bf16 v[204:207], v[240:243], v[116:119], v[204:207]
	v_mfma_f32_16x16x32_bf16 v[208:211], v[240:243], v[120:123], v[208:211]
	buffer_load_dwordx4 v[108:111], v8, s[40:43], s11 offen offset:1024 sc1
	ds_read_b128 v[240:243], v8 offset:16384
	s_waitcnt lgkmcnt(4)
	v_mfma_f32_16x16x32_bf16 v[212:215], v[244:247], v[116:119], v[212:215]
	v_mfma_f32_16x16x32_bf16 v[216:219], v[244:247], v[120:123], v[216:219]
	ds_read_b128 v[244:247], v8 offset:17408
	s_waitcnt lgkmcnt(4)
	v_mfma_f32_16x16x32_bf16 v[220:223], v[248:251], v[116:119], v[220:223]
	v_mfma_f32_16x16x32_bf16 v[224:227], v[248:251], v[120:123], v[224:227]
	buffer_load_dwordx4 v[112:115], v10, s[40:43], s11 offen offset:1024 sc1
	ds_read_b128 v[248:251], v8 offset:18432
	s_waitcnt lgkmcnt(4)
	v_mfma_f32_16x16x32_bf16 v[228:231], v[252:255], v[116:119], v[228:231]
	v_mfma_f32_16x16x32_bf16 v[232:235], v[252:255], v[120:123], v[232:235]
	ds_read_b128 v[252:255], v8 offset:19456
	s_waitcnt lgkmcnt(4)
	v_mfma_f32_16x16x32_bf16 v[196:199], v[236:239], v[124:127], v[196:199]
	v_mfma_f32_16x16x32_bf16 v[200:203], v[236:239], v[128:131], v[200:203]
	ds_read_b128 v[236:239], v8 offset:20480
	s_waitcnt lgkmcnt(4)
	v_mfma_f32_16x16x32_bf16 v[204:207], v[240:243], v[124:127], v[204:207]
	v_mfma_f32_16x16x32_bf16 v[208:211], v[240:243], v[128:131], v[208:211]
	buffer_load_dwordx4 v[116:119], v8, s[40:43], s11 offen offset:2048 sc1
	ds_read_b128 v[240:243], v8 offset:21504
	s_waitcnt lgkmcnt(4)
	v_mfma_f32_16x16x32_bf16 v[212:215], v[244:247], v[124:127], v[212:215]
	v_mfma_f32_16x16x32_bf16 v[216:219], v[244:247], v[128:131], v[216:219]
	ds_read_b128 v[244:247], v8 offset:22528
	s_waitcnt lgkmcnt(4)
	v_mfma_f32_16x16x32_bf16 v[220:223], v[248:251], v[124:127], v[220:223]
	v_mfma_f32_16x16x32_bf16 v[224:227], v[248:251], v[128:131], v[224:227]
	buffer_load_dwordx4 v[120:123], v10, s[40:43], s11 offen offset:2048 sc1
	ds_read_b128 v[248:251], v8 offset:23552
	s_waitcnt lgkmcnt(4)
	v_mfma_f32_16x16x32_bf16 v[228:231], v[252:255], v[124:127], v[228:231]
	v_mfma_f32_16x16x32_bf16 v[232:235], v[252:255], v[128:131], v[232:235]
	ds_read_b128 v[252:255], v8 offset:24576
	s_waitcnt lgkmcnt(4)
	v_mfma_f32_16x16x32_bf16 v[196:199], v[236:239], v[132:135], v[196:199]
	v_mfma_f32_16x16x32_bf16 v[200:203], v[236:239], v[136:139], v[200:203]
	ds_read_b128 v[236:239], v8 offset:25600
	s_waitcnt lgkmcnt(4)
	v_mfma_f32_16x16x32_bf16 v[204:207], v[240:243], v[132:135], v[204:207]
	v_mfma_f32_16x16x32_bf16 v[208:211], v[240:243], v[136:139], v[208:211]
	buffer_load_dwordx4 v[124:127], v8, s[40:43], s11 offen offset:3072 sc1
	ds_read_b128 v[240:243], v8 offset:26624
	s_waitcnt lgkmcnt(4)
	v_mfma_f32_16x16x32_bf16 v[212:215], v[244:247], v[132:135], v[212:215]
	v_mfma_f32_16x16x32_bf16 v[216:219], v[244:247], v[136:139], v[216:219]
	ds_read_b128 v[244:247], v8 offset:27648
	s_waitcnt lgkmcnt(4)
	v_mfma_f32_16x16x32_bf16 v[220:223], v[248:251], v[132:135], v[220:223]
	v_mfma_f32_16x16x32_bf16 v[224:227], v[248:251], v[136:139], v[224:227]
	buffer_load_dwordx4 v[128:131], v10, s[40:43], s11 offen offset:3072 sc1
	s_add_u32 s11, s11, 4096
	ds_read_b128 v[248:251], v8 offset:28672
	s_waitcnt lgkmcnt(4)
	v_mfma_f32_16x16x32_bf16 v[228:231], v[252:255], v[132:135], v[228:231]
	v_mfma_f32_16x16x32_bf16 v[232:235], v[252:255], v[136:139], v[232:235]
	ds_read_b128 v[252:255], v8 offset:29696
	s_waitcnt lgkmcnt(4)
	v_mfma_f32_16x16x32_bf16 v[196:199], v[236:239], v[140:143], v[196:199]
	v_mfma_f32_16x16x32_bf16 v[200:203], v[236:239], v[144:147], v[200:203]
	ds_read_b128 v[236:239], v8 offset:30720
	s_waitcnt lgkmcnt(4)
	v_mfma_f32_16x16x32_bf16 v[204:207], v[240:243], v[140:143], v[204:207]
	v_mfma_f32_16x16x32_bf16 v[208:211], v[240:243], v[144:147], v[208:211]
	buffer_load_dwordx4 v[132:135], v8, s[40:43], s11 offen sc1
	ds_read_b128 v[240:243], v8 offset:31744
	s_waitcnt lgkmcnt(4)
	v_mfma_f32_16x16x32_bf16 v[212:215], v[244:247], v[140:143], v[212:215]
	v_mfma_f32_16x16x32_bf16 v[216:219], v[244:247], v[144:147], v[216:219]
	ds_read_b128 v[244:247], v8 offset:32768
	s_waitcnt lgkmcnt(4)
	v_mfma_f32_16x16x32_bf16 v[220:223], v[248:251], v[140:143], v[220:223]
	v_mfma_f32_16x16x32_bf16 v[224:227], v[248:251], v[144:147], v[224:227]
	buffer_load_dwordx4 v[136:139], v10, s[40:43], s11 offen sc1
	ds_read_b128 v[248:251], v8 offset:33792
	s_waitcnt lgkmcnt(4)
	v_mfma_f32_16x16x32_bf16 v[228:231], v[252:255], v[140:143], v[228:231]
	v_mfma_f32_16x16x32_bf16 v[232:235], v[252:255], v[144:147], v[232:235]
	ds_read_b128 v[252:255], v8 offset:34816
	s_waitcnt vmcnt(20) lgkmcnt(4)
	v_mfma_f32_16x16x32_bf16 v[196:199], v[236:239], v[148:151], v[196:199]
	v_mfma_f32_16x16x32_bf16 v[200:203], v[236:239], v[152:155], v[200:203]
	ds_read_b128 v[236:239], v8 offset:35840
	s_waitcnt lgkmcnt(4)
	v_mfma_f32_16x16x32_bf16 v[204:207], v[240:243], v[148:151], v[204:207]
	v_mfma_f32_16x16x32_bf16 v[208:211], v[240:243], v[152:155], v[208:211]
	buffer_load_dwordx4 v[140:143], v8, s[40:43], s11 offen offset:1024 sc1
	ds_read_b128 v[240:243], v8 offset:36864
	s_waitcnt lgkmcnt(4)
	v_mfma_f32_16x16x32_bf16 v[212:215], v[244:247], v[148:151], v[212:215]
	v_mfma_f32_16x16x32_bf16 v[216:219], v[244:247], v[152:155], v[216:219]
	ds_read_b128 v[244:247], v8 offset:37888
	s_waitcnt lgkmcnt(4)
	v_mfma_f32_16x16x32_bf16 v[220:223], v[248:251], v[148:151], v[220:223]
	v_mfma_f32_16x16x32_bf16 v[224:227], v[248:251], v[152:155], v[224:227]
	buffer_load_dwordx4 v[144:147], v10, s[40:43], s11 offen offset:1024 sc1
	ds_read_b128 v[248:251], v8 offset:38912
	s_waitcnt lgkmcnt(4)
	v_mfma_f32_16x16x32_bf16 v[228:231], v[252:255], v[148:151], v[228:231]
	v_mfma_f32_16x16x32_bf16 v[232:235], v[252:255], v[152:155], v[232:235]
	ds_read_b128 v[252:255], v8 offset:39936
	s_waitcnt vmcnt(20) lgkmcnt(4)
	v_mfma_f32_16x16x32_bf16 v[196:199], v[236:239], v[156:159], v[196:199]
	v_mfma_f32_16x16x32_bf16 v[200:203], v[236:239], v[160:163], v[200:203]
	ds_read_b128 v[236:239], v8 offset:40960
	s_waitcnt lgkmcnt(4)
	v_mfma_f32_16x16x32_bf16 v[204:207], v[240:243], v[156:159], v[204:207]
	v_mfma_f32_16x16x32_bf16 v[208:211], v[240:243], v[160:163], v[208:211]
	buffer_load_dwordx4 v[148:151], v8, s[40:43], s11 offen offset:2048 sc1
	ds_read_b128 v[240:243], v8 offset:41984
	s_waitcnt lgkmcnt(4)
	v_mfma_f32_16x16x32_bf16 v[212:215], v[244:247], v[156:159], v[212:215]
	v_mfma_f32_16x16x32_bf16 v[216:219], v[244:247], v[160:163], v[216:219]
	ds_read_b128 v[244:247], v8 offset:43008
	s_waitcnt lgkmcnt(4)
	v_mfma_f32_16x16x32_bf16 v[220:223], v[248:251], v[156:159], v[220:223]
	v_mfma_f32_16x16x32_bf16 v[224:227], v[248:251], v[160:163], v[224:227]
	buffer_load_dwordx4 v[152:155], v10, s[40:43], s11 offen offset:2048 sc1
	ds_read_b128 v[248:251], v8 offset:44032
	s_waitcnt lgkmcnt(4)
	v_mfma_f32_16x16x32_bf16 v[228:231], v[252:255], v[156:159], v[228:231]
	v_mfma_f32_16x16x32_bf16 v[232:235], v[252:255], v[160:163], v[232:235]
	ds_read_b128 v[252:255], v8 offset:45056
	s_waitcnt vmcnt(20) lgkmcnt(4)
	v_mfma_f32_16x16x32_bf16 v[196:199], v[236:239], v[164:167], v[196:199]
	v_mfma_f32_16x16x32_bf16 v[200:203], v[236:239], v[168:171], v[200:203]
	ds_read_b128 v[236:239], v8 offset:46080
	s_waitcnt lgkmcnt(4)
	v_mfma_f32_16x16x32_bf16 v[204:207], v[240:243], v[164:167], v[204:207]
	v_mfma_f32_16x16x32_bf16 v[208:211], v[240:243], v[168:171], v[208:211]
	buffer_load_dwordx4 v[156:159], v8, s[40:43], s11 offen offset:3072 sc1
	ds_read_b128 v[240:243], v8 offset:47104
	s_waitcnt lgkmcnt(4)
	v_mfma_f32_16x16x32_bf16 v[212:215], v[244:247], v[164:167], v[212:215]
	v_mfma_f32_16x16x32_bf16 v[216:219], v[244:247], v[168:171], v[216:219]
	ds_read_b128 v[244:247], v8 offset:48128
	s_waitcnt lgkmcnt(4)
	v_mfma_f32_16x16x32_bf16 v[220:223], v[248:251], v[164:167], v[220:223]
	v_mfma_f32_16x16x32_bf16 v[224:227], v[248:251], v[168:171], v[224:227]
	buffer_load_dwordx4 v[160:163], v10, s[40:43], s11 offen offset:3072 sc1
	s_add_u32 s11, s11, 4096
	ds_read_b128 v[248:251], v8 offset:49152
	s_waitcnt lgkmcnt(4)
	v_mfma_f32_16x16x32_bf16 v[228:231], v[252:255], v[164:167], v[228:231]
	v_mfma_f32_16x16x32_bf16 v[232:235], v[252:255], v[168:171], v[232:235]
	ds_read_b128 v[252:255], v8 offset:50176
	s_waitcnt vmcnt(20) lgkmcnt(4)
	v_mfma_f32_16x16x32_bf16 v[196:199], v[236:239], v[172:175], v[196:199]
	v_mfma_f32_16x16x32_bf16 v[200:203], v[236:239], v[176:179], v[200:203]
	ds_read_b128 v[236:239], v8 offset:51200
	s_waitcnt lgkmcnt(4)
	v_mfma_f32_16x16x32_bf16 v[204:207], v[240:243], v[172:175], v[204:207]
	v_mfma_f32_16x16x32_bf16 v[208:211], v[240:243], v[176:179], v[208:211]
	ds_read_b128 v[240:243], v8 offset:52224
	s_waitcnt lgkmcnt(4)
	v_mfma_f32_16x16x32_bf16 v[212:215], v[244:247], v[172:175], v[212:215]
	v_mfma_f32_16x16x32_bf16 v[216:219], v[244:247], v[176:179], v[216:219]
	ds_read_b128 v[244:247], v8 offset:53248
	s_waitcnt lgkmcnt(4)
	v_mfma_f32_16x16x32_bf16 v[220:223], v[248:251], v[172:175], v[220:223]
	v_mfma_f32_16x16x32_bf16 v[224:227], v[248:251], v[176:179], v[224:227]
	ds_read_b128 v[248:251], v8 offset:54272
	s_waitcnt lgkmcnt(4)
	v_mfma_f32_16x16x32_bf16 v[228:231], v[252:255], v[172:175], v[228:231]
	v_mfma_f32_16x16x32_bf16 v[232:235], v[252:255], v[176:179], v[232:235]
	ds_read_b128 v[252:255], v8 offset:55296
	s_waitcnt vmcnt(18) lgkmcnt(4)
	v_mfma_f32_16x16x32_bf16 v[196:199], v[236:239], v[180:183], v[196:199]
	v_mfma_f32_16x16x32_bf16 v[200:203], v[236:239], v[184:187], v[200:203]
	ds_read_b128 v[236:239], v8 offset:56320
	s_waitcnt lgkmcnt(4)
	v_mfma_f32_16x16x32_bf16 v[204:207], v[240:243], v[180:183], v[204:207]
	v_mfma_f32_16x16x32_bf16 v[208:211], v[240:243], v[184:187], v[208:211]
	ds_read_b128 v[240:243], v8 offset:57344
	s_waitcnt lgkmcnt(4)
	v_mfma_f32_16x16x32_bf16 v[212:215], v[244:247], v[180:183], v[212:215]
	v_mfma_f32_16x16x32_bf16 v[216:219], v[244:247], v[184:187], v[216:219]
	ds_read_b128 v[244:247], v8 offset:58368
	s_waitcnt lgkmcnt(4)
	v_mfma_f32_16x16x32_bf16 v[220:223], v[248:251], v[180:183], v[220:223]
	v_mfma_f32_16x16x32_bf16 v[224:227], v[248:251], v[184:187], v[224:227]
	ds_read_b128 v[248:251], v8 offset:59392
	s_waitcnt lgkmcnt(4)
	v_mfma_f32_16x16x32_bf16 v[228:231], v[252:255], v[180:183], v[228:231]
	v_mfma_f32_16x16x32_bf16 v[232:235], v[252:255], v[184:187], v[232:235]
	ds_read_b128 v[252:255], v8 offset:60416
	s_waitcnt vmcnt(16) lgkmcnt(4)
	v_mfma_f32_16x16x32_bf16 v[196:199], v[236:239], v[188:191], v[196:199]
	v_mfma_f32_16x16x32_bf16 v[200:203], v[236:239], v[192:195], v[200:203]
	ds_read_b128 v[236:239], v27 offset:0
	s_waitcnt lgkmcnt(4)
	v_mfma_f32_16x16x32_bf16 v[204:207], v[240:243], v[188:191], v[204:207]
	v_mfma_f32_16x16x32_bf16 v[208:211], v[240:243], v[192:195], v[208:211]
	ds_read_b128 v[240:243], v27 offset:1024
	s_waitcnt lgkmcnt(4)
	v_mfma_f32_16x16x32_bf16 v[212:215], v[244:247], v[188:191], v[212:215]
	v_mfma_f32_16x16x32_bf16 v[216:219], v[244:247], v[192:195], v[216:219]
	ds_read_b128 v[244:247], v27 offset:2048
	s_waitcnt lgkmcnt(4)
	v_mfma_f32_16x16x32_bf16 v[220:223], v[248:251], v[188:191], v[220:223]
	v_mfma_f32_16x16x32_bf16 v[224:227], v[248:251], v[192:195], v[224:227]
	ds_read_b128 v[248:251], v27 offset:3072
	s_waitcnt lgkmcnt(4)
	v_mfma_f32_16x16x32_bf16 v[228:231], v[252:255], v[188:191], v[228:231]
	v_mfma_f32_16x16x32_bf16 v[232:235], v[252:255], v[192:195], v[232:235]
	ds_read_b128 v[252:255], v27 offset:4096
	s_waitcnt vmcnt(14) lgkmcnt(4)
	v_mfma_f32_16x16x32_bf16 v[196:199], v[236:239], v[100:103], v[196:199]
	v_mfma_f32_16x16x32_bf16 v[200:203], v[236:239], v[104:107], v[200:203]
	ds_read_b128 v[236:239], v27 offset:5120
	s_waitcnt lgkmcnt(4)
	v_mfma_f32_16x16x32_bf16 v[204:207], v[240:243], v[100:103], v[204:207]
	v_mfma_f32_16x16x32_bf16 v[208:211], v[240:243], v[104:107], v[208:211]
	ds_read_b128 v[240:243], v27 offset:6144
	s_waitcnt lgkmcnt(4)
	v_mfma_f32_16x16x32_bf16 v[212:215], v[244:247], v[100:103], v[212:215]
	v_mfma_f32_16x16x32_bf16 v[216:219], v[244:247], v[104:107], v[216:219]
	ds_read_b128 v[244:247], v27 offset:7168
	s_waitcnt lgkmcnt(4)
	v_mfma_f32_16x16x32_bf16 v[220:223], v[248:251], v[100:103], v[220:223]
	v_mfma_f32_16x16x32_bf16 v[224:227], v[248:251], v[104:107], v[224:227]
	ds_read_b128 v[248:251], v27 offset:8192
	s_waitcnt lgkmcnt(4)
	v_mfma_f32_16x16x32_bf16 v[228:231], v[252:255], v[100:103], v[228:231]
	v_mfma_f32_16x16x32_bf16 v[232:235], v[252:255], v[104:107], v[232:235]
	ds_read_b128 v[252:255], v27 offset:9216
	s_waitcnt vmcnt(12) lgkmcnt(4)
	v_mfma_f32_16x16x32_bf16 v[196:199], v[236:239], v[108:111], v[196:199]
	v_mfma_f32_16x16x32_bf16 v[200:203], v[236:239], v[112:115], v[200:203]
	ds_read_b128 v[236:239], v27 offset:10240
	s_waitcnt lgkmcnt(4)
	v_mfma_f32_16x16x32_bf16 v[204:207], v[240:243], v[108:111], v[204:207]
	v_mfma_f32_16x16x32_bf16 v[208:211], v[240:243], v[112:115], v[208:211]
	ds_read_b128 v[240:243], v27 offset:11264
	s_waitcnt lgkmcnt(4)
	v_mfma_f32_16x16x32_bf16 v[212:215], v[244:247], v[108:111], v[212:215]
	v_mfma_f32_16x16x32_bf16 v[216:219], v[244:247], v[112:115], v[216:219]
	ds_read_b128 v[244:247], v27 offset:12288
	s_waitcnt lgkmcnt(4)
	v_mfma_f32_16x16x32_bf16 v[220:223], v[248:251], v[108:111], v[220:223]
	v_mfma_f32_16x16x32_bf16 v[224:227], v[248:251], v[112:115], v[224:227]
	ds_read_b128 v[248:251], v27 offset:13312
	s_waitcnt lgkmcnt(4)
	v_mfma_f32_16x16x32_bf16 v[228:231], v[252:255], v[108:111], v[228:231]
	v_mfma_f32_16x16x32_bf16 v[232:235], v[252:255], v[112:115], v[232:235]
	ds_read_b128 v[252:255], v27 offset:14336
	s_waitcnt vmcnt(10) lgkmcnt(4)
	v_mfma_f32_16x16x32_bf16 v[196:199], v[236:239], v[116:119], v[196:199]
	v_mfma_f32_16x16x32_bf16 v[200:203], v[236:239], v[120:123], v[200:203]
	ds_read_b128 v[236:239], v27 offset:15360
	s_waitcnt lgkmcnt(4)
	v_mfma_f32_16x16x32_bf16 v[204:207], v[240:243], v[116:119], v[204:207]
	v_mfma_f32_16x16x32_bf16 v[208:211], v[240:243], v[120:123], v[208:211]
	ds_read_b128 v[240:243], v27 offset:16384
	s_waitcnt lgkmcnt(4)
	v_mfma_f32_16x16x32_bf16 v[212:215], v[244:247], v[116:119], v[212:215]
	v_mfma_f32_16x16x32_bf16 v[216:219], v[244:247], v[120:123], v[216:219]
	ds_read_b128 v[244:247], v27 offset:17408
	s_waitcnt lgkmcnt(4)
	v_mfma_f32_16x16x32_bf16 v[220:223], v[248:251], v[116:119], v[220:223]
	v_mfma_f32_16x16x32_bf16 v[224:227], v[248:251], v[120:123], v[224:227]
	ds_read_b128 v[248:251], v27 offset:18432
	s_waitcnt lgkmcnt(4)
	v_mfma_f32_16x16x32_bf16 v[228:231], v[252:255], v[116:119], v[228:231]
	v_mfma_f32_16x16x32_bf16 v[232:235], v[252:255], v[120:123], v[232:235]
	ds_read_b128 v[252:255], v27 offset:19456
	s_waitcnt vmcnt(8) lgkmcnt(4)
	v_mfma_f32_16x16x32_bf16 v[196:199], v[236:239], v[124:127], v[196:199]
	v_mfma_f32_16x16x32_bf16 v[200:203], v[236:239], v[128:131], v[200:203]
	ds_read_b128 v[236:239], v27 offset:20480
	s_waitcnt lgkmcnt(4)
	v_mfma_f32_16x16x32_bf16 v[204:207], v[240:243], v[124:127], v[204:207]
	v_mfma_f32_16x16x32_bf16 v[208:211], v[240:243], v[128:131], v[208:211]
	ds_read_b128 v[240:243], v27 offset:21504
	s_waitcnt lgkmcnt(4)
	v_mfma_f32_16x16x32_bf16 v[212:215], v[244:247], v[124:127], v[212:215]
	v_mfma_f32_16x16x32_bf16 v[216:219], v[244:247], v[128:131], v[216:219]
	ds_read_b128 v[244:247], v27 offset:22528
	s_waitcnt lgkmcnt(4)
	v_mfma_f32_16x16x32_bf16 v[220:223], v[248:251], v[124:127], v[220:223]
	v_mfma_f32_16x16x32_bf16 v[224:227], v[248:251], v[128:131], v[224:227]
	ds_read_b128 v[248:251], v27 offset:23552
	s_waitcnt lgkmcnt(4)
	v_mfma_f32_16x16x32_bf16 v[228:231], v[252:255], v[124:127], v[228:231]
	v_mfma_f32_16x16x32_bf16 v[232:235], v[252:255], v[128:131], v[232:235]
	ds_read_b128 v[252:255], v27 offset:24576
	s_waitcnt vmcnt(6) lgkmcnt(4)
	v_mfma_f32_16x16x32_bf16 v[196:199], v[236:239], v[132:135], v[196:199]
	v_mfma_f32_16x16x32_bf16 v[200:203], v[236:239], v[136:139], v[200:203]
	ds_read_b128 v[236:239], v27 offset:25600
	s_waitcnt lgkmcnt(4)
	v_mfma_f32_16x16x32_bf16 v[204:207], v[240:243], v[132:135], v[204:207]
	v_mfma_f32_16x16x32_bf16 v[208:211], v[240:243], v[136:139], v[208:211]
	ds_read_b128 v[240:243], v27 offset:26624
	s_waitcnt lgkmcnt(4)
	v_mfma_f32_16x16x32_bf16 v[212:215], v[244:247], v[132:135], v[212:215]
	v_mfma_f32_16x16x32_bf16 v[216:219], v[244:247], v[136:139], v[216:219]
	ds_read_b128 v[244:247], v27 offset:27648
	s_waitcnt lgkmcnt(4)
	v_mfma_f32_16x16x32_bf16 v[220:223], v[248:251], v[132:135], v[220:223]
	v_mfma_f32_16x16x32_bf16 v[224:227], v[248:251], v[136:139], v[224:227]
	ds_read_b128 v[248:251], v27 offset:28672
	s_waitcnt lgkmcnt(4)
	v_mfma_f32_16x16x32_bf16 v[228:231], v[252:255], v[132:135], v[228:231]
	v_mfma_f32_16x16x32_bf16 v[232:235], v[252:255], v[136:139], v[232:235]
	ds_read_b128 v[252:255], v27 offset:29696
	s_waitcnt vmcnt(4) lgkmcnt(4)
	v_mfma_f32_16x16x32_bf16 v[196:199], v[236:239], v[140:143], v[196:199]
	v_mfma_f32_16x16x32_bf16 v[200:203], v[236:239], v[144:147], v[200:203]
	ds_read_b128 v[236:239], v27 offset:30720
	s_waitcnt lgkmcnt(4)
	v_mfma_f32_16x16x32_bf16 v[204:207], v[240:243], v[140:143], v[204:207]
	v_mfma_f32_16x16x32_bf16 v[208:211], v[240:243], v[144:147], v[208:211]
	ds_read_b128 v[240:243], v27 offset:31744
	s_waitcnt lgkmcnt(4)
	v_mfma_f32_16x16x32_bf16 v[212:215], v[244:247], v[140:143], v[212:215]
	v_mfma_f32_16x16x32_bf16 v[216:219], v[244:247], v[144:147], v[216:219]
	ds_read_b128 v[244:247], v27 offset:32768
	s_waitcnt lgkmcnt(4)
	v_mfma_f32_16x16x32_bf16 v[220:223], v[248:251], v[140:143], v[220:223]
	v_mfma_f32_16x16x32_bf16 v[224:227], v[248:251], v[144:147], v[224:227]
	ds_read_b128 v[248:251], v27 offset:33792
	s_waitcnt lgkmcnt(4)
	v_mfma_f32_16x16x32_bf16 v[228:231], v[252:255], v[140:143], v[228:231]
	v_mfma_f32_16x16x32_bf16 v[232:235], v[252:255], v[144:147], v[232:235]
	ds_read_b128 v[252:255], v27 offset:34816
	s_waitcnt vmcnt(2) lgkmcnt(4)
	v_mfma_f32_16x16x32_bf16 v[196:199], v[236:239], v[148:151], v[196:199]
	v_mfma_f32_16x16x32_bf16 v[200:203], v[236:239], v[152:155], v[200:203]
	ds_read_b128 v[236:239], v27 offset:35840
	s_waitcnt lgkmcnt(4)
	v_mfma_f32_16x16x32_bf16 v[204:207], v[240:243], v[148:151], v[204:207]
	v_mfma_f32_16x16x32_bf16 v[208:211], v[240:243], v[152:155], v[208:211]
	ds_read_b128 v[240:243], v27 offset:36864
	s_waitcnt lgkmcnt(4)
	v_mfma_f32_16x16x32_bf16 v[212:215], v[244:247], v[148:151], v[212:215]
	v_mfma_f32_16x16x32_bf16 v[216:219], v[244:247], v[152:155], v[216:219]
	ds_read_b128 v[244:247], v27 offset:37888
	s_waitcnt lgkmcnt(4)
	v_mfma_f32_16x16x32_bf16 v[220:223], v[248:251], v[148:151], v[220:223]
	v_mfma_f32_16x16x32_bf16 v[224:227], v[248:251], v[152:155], v[224:227]
	ds_read_b128 v[248:251], v27 offset:38912
	s_waitcnt lgkmcnt(4)
	v_mfma_f32_16x16x32_bf16 v[228:231], v[252:255], v[148:151], v[228:231]
	v_mfma_f32_16x16x32_bf16 v[232:235], v[252:255], v[152:155], v[232:235]
	ds_read_b128 v[252:255], v27 offset:39936
	s_waitcnt vmcnt(0) lgkmcnt(4)
	v_mfma_f32_16x16x32_bf16 v[196:199], v[236:239], v[156:159], v[196:199]
	v_mfma_f32_16x16x32_bf16 v[200:203], v[236:239], v[160:163], v[200:203]
	s_waitcnt lgkmcnt(3)
	v_mfma_f32_16x16x32_bf16 v[204:207], v[240:243], v[156:159], v[204:207]
	v_mfma_f32_16x16x32_bf16 v[208:211], v[240:243], v[160:163], v[208:211]
	s_waitcnt lgkmcnt(2)
	v_mfma_f32_16x16x32_bf16 v[212:215], v[244:247], v[156:159], v[212:215]
	v_mfma_f32_16x16x32_bf16 v[216:219], v[244:247], v[160:163], v[216:219]
	s_waitcnt lgkmcnt(1)
	v_mfma_f32_16x16x32_bf16 v[220:223], v[248:251], v[156:159], v[220:223]
	v_mfma_f32_16x16x32_bf16 v[224:227], v[248:251], v[160:163], v[224:227]
	s_waitcnt lgkmcnt(0)
	v_mfma_f32_16x16x32_bf16 v[228:231], v[252:255], v[156:159], v[228:231]
	v_mfma_f32_16x16x32_bf16 v[232:235], v[252:255], v[160:163], v[232:235]
	s_barrier
	v_cvt_pk_bf16_f32 v100, v196, v197
	v_cvt_pk_bf16_f32 v101, v198, v199
	v_cvt_pk_bf16_f32 v102, v204, v205
	v_cvt_pk_bf16_f32 v103, v206, v207
	v_cvt_pk_bf16_f32 v104, v212, v213
	v_cvt_pk_bf16_f32 v105, v214, v215
	v_cvt_pk_bf16_f32 v106, v220, v221
	v_cvt_pk_bf16_f32 v107, v222, v223
	v_cvt_pk_bf16_f32 v108, v228, v229
	v_cvt_pk_bf16_f32 v109, v230, v231
	v_mfma_f32_16x16x32_bf16 v[132:135], v[48:51], v[100:103], 0
	v_mfma_f32_16x16x32_bf16 v[136:139], v[56:59], v[100:103], 0
	v_mfma_f32_16x16x32_bf16 v[140:143], v[64:67], v[100:103], 0
	v_mfma_f32_16x16x32_bf16 v[144:147], v[72:75], v[100:103], 0
	v_mfma_f32_16x16x32_bf16 v[148:151], v[80:83], v[100:103], 0
	v_mfma_f32_16x16x32_bf16 v[132:135], v[52:55], v[104:107], v[132:135]
	v_mfma_f32_16x16x32_bf16 v[136:139], v[60:63], v[104:107], v[136:139]
	v_mfma_f32_16x16x32_bf16 v[140:143], v[68:71], v[104:107], v[140:143]
	v_mfma_f32_16x16x32_bf16 v[144:147], v[76:79], v[104:107], v[144:147]
	v_mfma_f32_16x16x32_bf16 v[148:151], v[84:87], v[104:107], v[148:151]
	v_mfma_f32_16x16x16_bf16 v[132:135], v[88:89], v[108:109], v[132:135]
	v_mfma_f32_16x16x16_bf16 v[136:139], v[90:91], v[108:109], v[136:139]
	v_mfma_f32_16x16x16_bf16 v[140:143], v[92:93], v[108:109], v[140:143]
	v_mfma_f32_16x16x16_bf16 v[144:147], v[94:95], v[108:109], v[144:147]
	v_mfma_f32_16x16x16_bf16 v[148:151], v[96:97], v[108:109], v[148:151]
	s_nop 3
	v_max3_f32 v32, v132, v133, v134
	v_min3_f32 v34, v132, v133, v134
	v_max3_f32 v32, v32, v135, v136
	v_min3_f32 v34, v34, v135, v136
	v_max3_f32 v32, v32, v137, v138
	v_min3_f32 v34, v34, v137, v138
	v_max3_f32 v32, v32, v139, v140
	v_min3_f32 v34, v34, v139, v140
	v_max3_f32 v32, v32, v141, v142
	v_min3_f32 v34, v34, v141, v142
	v_max3_f32 v32, v32, v143, v144
	v_min3_f32 v34, v34, v143, v144
	v_max3_f32 v32, v32, v145, v146
	v_min3_f32 v34, v34, v145, v146
	v_max3_f32 v32, v32, v147, v148
	v_min3_f32 v34, v34, v147, v148
	v_max3_f32 v32, v32, v149, v150
	v_min3_f32 v34, v34, v149, v150
	v_max_f32 v32, v32, v151
	v_min_f32 v34, v34, v151
	v_mul_f32 v32, s78, v32
	v_mul_f32 v34, s76, v34
	v_pk_fma_f32 v[196:197], v[132:133], s[76:77], v[32:33] op_sel_hi:[1,0,0]
	v_pk_fma_f32 v[112:113], v[132:133], s[78:79], v[34:35] op_sel_hi:[1,0,0]
	v_pk_fma_f32 v[198:199], v[134:135], s[76:77], v[32:33] op_sel_hi:[1,0,0]
	v_pk_fma_f32 v[114:115], v[134:135], s[78:79], v[34:35] op_sel_hi:[1,0,0]
	v_pk_fma_f32 v[204:205], v[136:137], s[76:77], v[32:33] op_sel_hi:[1,0,0]
	v_pk_fma_f32 v[116:117], v[136:137], s[78:79], v[34:35] op_sel_hi:[1,0,0]
	v_pk_fma_f32 v[206:207], v[138:139], s[76:77], v[32:33] op_sel_hi:[1,0,0]
	v_pk_fma_f32 v[118:119], v[138:139], s[78:79], v[34:35] op_sel_hi:[1,0,0]
	v_pk_fma_f32 v[212:213], v[140:141], s[76:77], v[32:33] op_sel_hi:[1,0,0]
	v_pk_fma_f32 v[120:121], v[140:141], s[78:79], v[34:35] op_sel_hi:[1,0,0]
	v_pk_fma_f32 v[214:215], v[142:143], s[76:77], v[32:33] op_sel_hi:[1,0,0]
	v_pk_fma_f32 v[122:123], v[142:143], s[78:79], v[34:35] op_sel_hi:[1,0,0]
	v_pk_fma_f32 v[220:221], v[144:145], s[76:77], v[32:33] op_sel_hi:[1,0,0]
	v_pk_fma_f32 v[124:125], v[144:145], s[78:79], v[34:35] op_sel_hi:[1,0,0]
	v_pk_fma_f32 v[222:223], v[146:147], s[76:77], v[32:33] op_sel_hi:[1,0,0]
	v_pk_fma_f32 v[126:127], v[146:147], s[78:79], v[34:35] op_sel_hi:[1,0,0]
	v_pk_fma_f32 v[228:229], v[148:149], s[76:77], v[32:33] op_sel_hi:[1,0,0]
	v_pk_fma_f32 v[128:129], v[148:149], s[78:79], v[34:35] op_sel_hi:[1,0,0]
	v_pk_fma_f32 v[230:231], v[150:151], s[76:77], v[32:33] op_sel_hi:[1,0,0]
	v_pk_fma_f32 v[130:131], v[150:151], s[78:79], v[34:35] op_sel_hi:[1,0,0]
	v_exp_f32 v196, v196
	v_exp_f32 v112, v112
	v_exp_f32 v197, v197
	v_exp_f32 v113, v113
	v_exp_f32 v198, v198
	v_exp_f32 v114, v114
	v_exp_f32 v199, v199
	v_exp_f32 v115, v115
	v_exp_f32 v204, v204
	v_exp_f32 v116, v116
	v_exp_f32 v205, v205
	v_exp_f32 v117, v117
	v_exp_f32 v206, v206
	v_exp_f32 v118, v118
	v_exp_f32 v207, v207
	v_exp_f32 v119, v119
	v_exp_f32 v212, v212
	v_exp_f32 v120, v120
	v_exp_f32 v213, v213
	v_exp_f32 v121, v121
	v_exp_f32 v214, v214
	v_exp_f32 v122, v122
	v_exp_f32 v215, v215
	v_exp_f32 v123, v123
	v_exp_f32 v220, v220
	v_exp_f32 v124, v124
	v_exp_f32 v221, v221
	v_exp_f32 v125, v125
	v_exp_f32 v222, v222
	v_exp_f32 v126, v126
	v_exp_f32 v223, v223
	v_exp_f32 v127, v127
	v_exp_f32 v228, v228
	v_exp_f32 v128, v128
	v_exp_f32 v229, v229
	v_exp_f32 v129, v129
	v_exp_f32 v230, v230
	v_exp_f32 v130, v130
	v_exp_f32 v231, v231
	v_exp_f32 v131, v131
	v_pk_add_f32 v[36:37], v[196:197], v[198:199]
	v_pk_add_f32 v[38:39], v[112:113], v[114:115]
	v_pk_add_f32 v[36:37], v[36:37], v[204:205]
	v_pk_add_f32 v[38:39], v[38:39], v[116:117]
	v_pk_add_f32 v[36:37], v[36:37], v[206:207]
	v_pk_add_f32 v[38:39], v[38:39], v[118:119]
	v_pk_add_f32 v[36:37], v[36:37], v[212:213]
	v_pk_add_f32 v[38:39], v[38:39], v[120:121]
	v_pk_add_f32 v[36:37], v[36:37], v[214:215]
	v_pk_add_f32 v[38:39], v[38:39], v[122:123]
	v_pk_add_f32 v[36:37], v[36:37], v[220:221]
	v_pk_add_f32 v[38:39], v[38:39], v[124:125]
	v_pk_add_f32 v[36:37], v[36:37], v[222:223]
	v_pk_add_f32 v[38:39], v[38:39], v[126:127]
	v_pk_add_f32 v[36:37], v[36:37], v[228:229]
	v_pk_add_f32 v[38:39], v[38:39], v[128:129]
	v_pk_add_f32 v[36:37], v[36:37], v[230:231]
	v_pk_add_f32 v[38:39], v[38:39], v[130:131]
	v_add_f32 v36, v36, v37
	v_add_f32 v38, v38, v39
	v_rcp_f32 v36, v36
	v_rcp_f32 v38, v38
	v_pk_mul_f32 v[196:197], v[196:197], v[36:37] op_sel_hi:[1,0]
	v_pk_mul_f32 v[112:113], v[112:113], v[38:39] op_sel_hi:[1,0]
	v_pk_mul_f32 v[198:199], v[198:199], v[36:37] op_sel_hi:[1,0]
	v_pk_mul_f32 v[114:115], v[114:115], v[38:39] op_sel_hi:[1,0]
	v_pk_mul_f32 v[204:205], v[204:205], v[36:37] op_sel_hi:[1,0]
	v_pk_mul_f32 v[116:117], v[116:117], v[38:39] op_sel_hi:[1,0]
	v_pk_mul_f32 v[206:207], v[206:207], v[36:37] op_sel_hi:[1,0]
	v_pk_mul_f32 v[118:119], v[118:119], v[38:39] op_sel_hi:[1,0]
	v_pk_mul_f32 v[212:213], v[212:213], v[36:37] op_sel_hi:[1,0]
	v_pk_mul_f32 v[120:121], v[120:121], v[38:39] op_sel_hi:[1,0]
	v_pk_mul_f32 v[214:215], v[214:215], v[36:37] op_sel_hi:[1,0]
	v_pk_mul_f32 v[122:123], v[122:123], v[38:39] op_sel_hi:[1,0]
	v_pk_mul_f32 v[220:221], v[220:221], v[36:37] op_sel_hi:[1,0]
	v_pk_mul_f32 v[124:125], v[124:125], v[38:39] op_sel_hi:[1,0]
	v_pk_mul_f32 v[222:223], v[222:223], v[36:37] op_sel_hi:[1,0]
	v_pk_mul_f32 v[126:127], v[126:127], v[38:39] op_sel_hi:[1,0]
	v_pk_mul_f32 v[228:229], v[228:229], v[36:37] op_sel_hi:[1,0]
	v_pk_mul_f32 v[128:129], v[128:129], v[38:39] op_sel_hi:[1,0]
	v_pk_mul_f32 v[230:231], v[230:231], v[36:37] op_sel_hi:[1,0]
	v_pk_mul_f32 v[130:131], v[130:131], v[38:39] op_sel_hi:[1,0]
	v_cvt_pk_bf16_f32 v132, v196, v197
	v_cvt_pk_bf16_f32 v133, v198, v199
	v_cvt_pk_bf16_f32 v134, v204, v205
	v_cvt_pk_bf16_f32 v135, v206, v207
	v_cvt_pk_bf16_f32 v136, v212, v213
	v_cvt_pk_bf16_f32 v137, v214, v215
	v_cvt_pk_bf16_f32 v138, v220, v221
	v_cvt_pk_bf16_f32 v139, v222, v223
	v_cvt_pk_bf16_f32 v140, v228, v229
	v_cvt_pk_bf16_f32 v141, v230, v231
	v_cvt_pk_bf16_f32 v142, v112, v113
	v_cvt_pk_bf16_f32 v143, v114, v115
	v_cvt_pk_bf16_f32 v144, v116, v117
	v_cvt_pk_bf16_f32 v145, v118, v119
	v_cvt_pk_bf16_f32 v146, v120, v121
	v_cvt_pk_bf16_f32 v147, v122, v123
	v_cvt_pk_bf16_f32 v148, v124, v125
	v_cvt_pk_bf16_f32 v149, v126, v127
	v_cvt_pk_bf16_f32 v150, v128, v129
	v_cvt_pk_bf16_f32 v151, v130, v131
	v_cvt_pk_bf16_f32 v100, v200, v201
	v_cvt_pk_bf16_f32 v101, v202, v203
	v_cvt_pk_bf16_f32 v102, v208, v209
	v_cvt_pk_bf16_f32 v103, v210, v211
	v_cvt_pk_bf16_f32 v104, v216, v217
	v_cvt_pk_bf16_f32 v105, v218, v219
	v_cvt_pk_bf16_f32 v106, v224, v225
	v_cvt_pk_bf16_f32 v107, v226, v227
	v_cvt_pk_bf16_f32 v108, v232, v233
	v_cvt_pk_bf16_f32 v109, v234, v235
	v_mfma_f32_16x16x32_bf16 v[152:155], v[48:51], v[100:103], 0
	v_mfma_f32_16x16x32_bf16 v[156:159], v[56:59], v[100:103], 0
	v_mfma_f32_16x16x32_bf16 v[160:163], v[64:67], v[100:103], 0
	v_mfma_f32_16x16x32_bf16 v[164:167], v[72:75], v[100:103], 0
	v_mfma_f32_16x16x32_bf16 v[168:171], v[80:83], v[100:103], 0
	v_mfma_f32_16x16x32_bf16 v[152:155], v[52:55], v[104:107], v[152:155]
	v_mfma_f32_16x16x32_bf16 v[156:159], v[60:63], v[104:107], v[156:159]
	v_mfma_f32_16x16x32_bf16 v[160:163], v[68:71], v[104:107], v[160:163]
	v_mfma_f32_16x16x32_bf16 v[164:167], v[76:79], v[104:107], v[164:167]
	v_mfma_f32_16x16x32_bf16 v[168:171], v[84:87], v[104:107], v[168:171]
	v_mfma_f32_16x16x16_bf16 v[152:155], v[88:89], v[108:109], v[152:155]
	v_mfma_f32_16x16x16_bf16 v[156:159], v[90:91], v[108:109], v[156:159]
	v_mfma_f32_16x16x16_bf16 v[160:163], v[92:93], v[108:109], v[160:163]
	v_mfma_f32_16x16x16_bf16 v[164:167], v[94:95], v[108:109], v[164:167]
	v_mfma_f32_16x16x16_bf16 v[168:171], v[96:97], v[108:109], v[168:171]
	s_nop 3
	v_max3_f32 v32, v152, v153, v154
	v_min3_f32 v34, v152, v153, v154
	v_max3_f32 v32, v32, v155, v156
	v_min3_f32 v34, v34, v155, v156
	v_max3_f32 v32, v32, v157, v158
	v_min3_f32 v34, v34, v157, v158
	v_max3_f32 v32, v32, v159, v160
	v_min3_f32 v34, v34, v159, v160
	v_max3_f32 v32, v32, v161, v162
	v_min3_f32 v34, v34, v161, v162
	v_max3_f32 v32, v32, v163, v164
	v_min3_f32 v34, v34, v163, v164
	v_max3_f32 v32, v32, v165, v166
	v_min3_f32 v34, v34, v165, v166
	v_max3_f32 v32, v32, v167, v168
	v_min3_f32 v34, v34, v167, v168
	v_max3_f32 v32, v32, v169, v170
	v_min3_f32 v34, v34, v169, v170
	v_max_f32 v32, v32, v171
	v_min_f32 v34, v34, v171
	v_mul_f32 v32, s78, v32
	v_mul_f32 v34, s76, v34
	v_pk_fma_f32 v[200:201], v[152:153], s[76:77], v[32:33] op_sel_hi:[1,0,0]
	v_pk_fma_f32 v[112:113], v[152:153], s[78:79], v[34:35] op_sel_hi:[1,0,0]
	v_pk_fma_f32 v[202:203], v[154:155], s[76:77], v[32:33] op_sel_hi:[1,0,0]
	v_pk_fma_f32 v[114:115], v[154:155], s[78:79], v[34:35] op_sel_hi:[1,0,0]
	v_pk_fma_f32 v[208:209], v[156:157], s[76:77], v[32:33] op_sel_hi:[1,0,0]
	v_pk_fma_f32 v[116:117], v[156:157], s[78:79], v[34:35] op_sel_hi:[1,0,0]
	v_pk_fma_f32 v[210:211], v[158:159], s[76:77], v[32:33] op_sel_hi:[1,0,0]
	v_pk_fma_f32 v[118:119], v[158:159], s[78:79], v[34:35] op_sel_hi:[1,0,0]
	v_pk_fma_f32 v[216:217], v[160:161], s[76:77], v[32:33] op_sel_hi:[1,0,0]
	v_pk_fma_f32 v[120:121], v[160:161], s[78:79], v[34:35] op_sel_hi:[1,0,0]
	v_pk_fma_f32 v[218:219], v[162:163], s[76:77], v[32:33] op_sel_hi:[1,0,0]
	v_pk_fma_f32 v[122:123], v[162:163], s[78:79], v[34:35] op_sel_hi:[1,0,0]
	v_pk_fma_f32 v[224:225], v[164:165], s[76:77], v[32:33] op_sel_hi:[1,0,0]
	v_pk_fma_f32 v[124:125], v[164:165], s[78:79], v[34:35] op_sel_hi:[1,0,0]
	v_pk_fma_f32 v[226:227], v[166:167], s[76:77], v[32:33] op_sel_hi:[1,0,0]
	v_pk_fma_f32 v[126:127], v[166:167], s[78:79], v[34:35] op_sel_hi:[1,0,0]
	v_pk_fma_f32 v[232:233], v[168:169], s[76:77], v[32:33] op_sel_hi:[1,0,0]
	v_pk_fma_f32 v[128:129], v[168:169], s[78:79], v[34:35] op_sel_hi:[1,0,0]
	v_pk_fma_f32 v[234:235], v[170:171], s[76:77], v[32:33] op_sel_hi:[1,0,0]
	v_pk_fma_f32 v[130:131], v[170:171], s[78:79], v[34:35] op_sel_hi:[1,0,0]
	v_exp_f32 v200, v200
	v_exp_f32 v112, v112
	v_exp_f32 v201, v201
	v_exp_f32 v113, v113
	v_exp_f32 v202, v202
	v_exp_f32 v114, v114
	v_exp_f32 v203, v203
	v_exp_f32 v115, v115
	v_exp_f32 v208, v208
	v_exp_f32 v116, v116
	v_exp_f32 v209, v209
	v_exp_f32 v117, v117
	v_exp_f32 v210, v210
	v_exp_f32 v118, v118
	v_exp_f32 v211, v211
	v_exp_f32 v119, v119
	v_exp_f32 v216, v216
	v_exp_f32 v120, v120
	v_exp_f32 v217, v217
	v_exp_f32 v121, v121
	v_exp_f32 v218, v218
	v_exp_f32 v122, v122
	v_exp_f32 v219, v219
	v_exp_f32 v123, v123
	v_exp_f32 v224, v224
	v_exp_f32 v124, v124
	v_exp_f32 v225, v225
	v_exp_f32 v125, v125
	v_exp_f32 v226, v226
	v_exp_f32 v126, v126
	v_exp_f32 v227, v227
	v_exp_f32 v127, v127
	v_exp_f32 v232, v232
	v_exp_f32 v128, v128
	v_exp_f32 v233, v233
	v_exp_f32 v129, v129
	v_exp_f32 v234, v234
	v_exp_f32 v130, v130
	v_exp_f32 v235, v235
	v_exp_f32 v131, v131
	v_pk_add_f32 v[36:37], v[200:201], v[202:203]
	v_pk_add_f32 v[38:39], v[112:113], v[114:115]
	v_pk_add_f32 v[36:37], v[36:37], v[208:209]
	v_pk_add_f32 v[38:39], v[38:39], v[116:117]
	v_pk_add_f32 v[36:37], v[36:37], v[210:211]
	v_pk_add_f32 v[38:39], v[38:39], v[118:119]
	v_pk_add_f32 v[36:37], v[36:37], v[216:217]
	v_pk_add_f32 v[38:39], v[38:39], v[120:121]
	v_pk_add_f32 v[36:37], v[36:37], v[218:219]
	v_pk_add_f32 v[38:39], v[38:39], v[122:123]
	v_pk_add_f32 v[36:37], v[36:37], v[224:225]
	v_pk_add_f32 v[38:39], v[38:39], v[124:125]
	v_pk_add_f32 v[36:37], v[36:37], v[226:227]
	v_pk_add_f32 v[38:39], v[38:39], v[126:127]
	v_pk_add_f32 v[36:37], v[36:37], v[232:233]
	v_pk_add_f32 v[38:39], v[38:39], v[128:129]
	v_pk_add_f32 v[36:37], v[36:37], v[234:235]
	v_pk_add_f32 v[38:39], v[38:39], v[130:131]
	v_add_f32 v36, v36, v37
	v_add_f32 v38, v38, v39
	v_rcp_f32 v36, v36
	v_rcp_f32 v38, v38
	v_pk_mul_f32 v[200:201], v[200:201], v[36:37] op_sel_hi:[1,0]
	v_pk_mul_f32 v[112:113], v[112:113], v[38:39] op_sel_hi:[1,0]
	v_pk_mul_f32 v[202:203], v[202:203], v[36:37] op_sel_hi:[1,0]
	v_pk_mul_f32 v[114:115], v[114:115], v[38:39] op_sel_hi:[1,0]
	v_pk_mul_f32 v[208:209], v[208:209], v[36:37] op_sel_hi:[1,0]
	v_pk_mul_f32 v[116:117], v[116:117], v[38:39] op_sel_hi:[1,0]
	v_pk_mul_f32 v[210:211], v[210:211], v[36:37] op_sel_hi:[1,0]
	v_pk_mul_f32 v[118:119], v[118:119], v[38:39] op_sel_hi:[1,0]
	v_pk_mul_f32 v[216:217], v[216:217], v[36:37] op_sel_hi:[1,0]
	v_pk_mul_f32 v[120:121], v[120:121], v[38:39] op_sel_hi:[1,0]
	v_pk_mul_f32 v[218:219], v[218:219], v[36:37] op_sel_hi:[1,0]
	v_pk_mul_f32 v[122:123], v[122:123], v[38:39] op_sel_hi:[1,0]
	v_pk_mul_f32 v[224:225], v[224:225], v[36:37] op_sel_hi:[1,0]
	v_pk_mul_f32 v[124:125], v[124:125], v[38:39] op_sel_hi:[1,0]
	v_pk_mul_f32 v[226:227], v[226:227], v[36:37] op_sel_hi:[1,0]
	v_pk_mul_f32 v[126:127], v[126:127], v[38:39] op_sel_hi:[1,0]
	v_pk_mul_f32 v[232:233], v[232:233], v[36:37] op_sel_hi:[1,0]
	v_pk_mul_f32 v[128:129], v[128:129], v[38:39] op_sel_hi:[1,0]
	v_pk_mul_f32 v[234:235], v[234:235], v[36:37] op_sel_hi:[1,0]
	v_pk_mul_f32 v[130:131], v[130:131], v[38:39] op_sel_hi:[1,0]
	v_cvt_pk_bf16_f32 v152, v200, v201
	v_cvt_pk_bf16_f32 v153, v202, v203
	v_cvt_pk_bf16_f32 v154, v208, v209
	v_cvt_pk_bf16_f32 v155, v210, v211
	v_cvt_pk_bf16_f32 v156, v216, v217
	v_cvt_pk_bf16_f32 v157, v218, v219
	v_cvt_pk_bf16_f32 v158, v224, v225
	v_cvt_pk_bf16_f32 v159, v226, v227
	v_cvt_pk_bf16_f32 v160, v232, v233
	v_cvt_pk_bf16_f32 v161, v234, v235
	v_cvt_pk_bf16_f32 v162, v112, v113
	v_cvt_pk_bf16_f32 v163, v114, v115
	v_cvt_pk_bf16_f32 v164, v116, v117
	v_cvt_pk_bf16_f32 v165, v118, v119
	v_cvt_pk_bf16_f32 v166, v120, v121
	v_cvt_pk_bf16_f32 v167, v122, v123
	v_cvt_pk_bf16_f32 v168, v124, v125
	v_cvt_pk_bf16_f32 v169, v126, v127
	v_cvt_pk_bf16_f32 v170, v128, v129
	v_cvt_pk_bf16_f32 v171, v130, v131
	s_setprio 3
	s_mul_i32 s6, s3, 10240
	s_add_u32 s6, s6, 102400
	v_lshlrev_b32 v31, 11, v2
	v_lshl_add_u32 v31, v4, 3, v31
	v_mov_b32 v21, 8192
	v_cmp_eq_u32 vcc, v2, v5
	s_nop 1
	v_cndmask_b32 v31, v21, v31, vcc
	v_add_u32 v31, s6, v31
	v_mov_b32 v44, 0
	v_mov_b32 v45, 0
	v_mov_b32 v46, 0
	v_mov_b32 v47, 0
	v_add_u32 v21, s6, v8
	ds_write_b128 v21, v[44:47] offset:8192
	ds_write_b128 v21, v[44:47] offset:9216
	s_lshl_b32 s4, s68, 11
	s_add_u32 s4, s4, 19984384
	v_lshl_add_u32 v20, v3, 7, s4
	v_lshlrev_b32 v8, 4, v1
	v_add_u32 v9, 4096, v8
	v_lshlrev_b32 v10, 3, v1
	s_lshl_b32 s5, s68, 13
	s_add_u32 s5, s5, 19652608
	s_lshl_b32 s7, s69, 1
	s_lshr_b32 s8, s3, 1
	s_add_u32 s7, s7, s8
	s_and_b32 s8, s3, 1
	s_lshl_b32 s8, s8, 1
	s_lshr_b32 s12, s68, 1
	s_mul_i32 s12, s12, 5
	s_mul_i32 s13, s7, 20
	s_add_u32 s12, s12, s13
	s_lshl_b32 s12, s12, 2
	s_add_u32 s12, s12, s8
	s_lshl_b32 s12, s12, 10
	s_add_u32 s12, s12, 5652480
	s_and_b32 s13, s68, 1
	s_mul_i32 s14, s13, 12288
	s_add_u32 s14, s14, s12
	s_lshl_b32 s13, s13, 9
	s_add_u32 s12, s12, s13
	s_add_u32 s12, s12, 8192
	s_lshl_b32 s13, s7, 3
	s_add_u32 s13, s13, s68
	s_lshl_b32 s13, s13, 2
	s_add_u32 s13, s13, s8
	s_lshl_b32 s13, s13, 7
	s_add_u32 s13, s13, 20131840
	buffer_load_dword v21, v20, s[40:43], 0 offen sc1
	s_waitcnt vmcnt(0)
	v_cmp_ne_u32 vcc, s75, v21
	s_nop 4
	s_cbranch_vccz L_ok_3
	s_mov_b32 s84, 0
L_poll_4:
	s_sleep 8
	buffer_load_dword v21, v20, s[40:43], 0 offen sc1
	s_waitcnt vmcnt(0)
	v_cmp_ne_u32 vcc, s75, v21
	s_nop 4
	s_cbranch_vccz L_ok_3
	s_add_u32 s84, s84, 1
	s_cmp_lt_u32 s84, 0x8000
	s_cbranch_scc1 L_poll_4
L_ok_3:
	s_add_u32 m0, s6, 0
	s_nop 0
	buffer_load_dwordx4 v8, s[40:43], s5 offen sc1 lds
	buffer_load_dwordx4 v8, s[40:43], s5 offen offset:1024 sc1 lds
	buffer_load_dwordx4 v8, s[40:43], s5 offen offset:2048 sc1 lds
	buffer_load_dwordx4 v8, s[40:43], s5 offen offset:3072 sc1 lds
	s_add_u32 m0, s6, 4096
	s_nop 0
	buffer_load_dwordx4 v9, s[40:43], s5 offen sc1 lds
	buffer_load_dwordx4 v9, s[40:43], s5 offen offset:1024 sc1 lds
	buffer_load_dwordx4 v9, s[40:43], s5 offen offset:2048 sc1 lds
	buffer_load_dwordx4 v9, s[40:43], s5 offen offset:3072 sc1 lds
	s_waitcnt vmcnt(0) lgkmcnt(0)
	ds_read_b64_tr_b16 v[48:49], v31 offset:0
	ds_read_b64_tr_b16 v[50:51], v31 offset:32
	ds_read_b64_tr_b16 v[52:53], v31 offset:128
	ds_read_b64_tr_b16 v[54:55], v31 offset:160
	ds_read_b64_tr_b16 v[56:57], v31 offset:256
	ds_read_b64_tr_b16 v[58:59], v31 offset:288
	ds_read_b64_tr_b16 v[60:61], v31 offset:384
	ds_read_b64_tr_b16 v[62:63], v31 offset:416
	ds_read_b64_tr_b16 v[64:65], v31 offset:1024
	ds_read_b64_tr_b16 v[66:67], v31 offset:1056
	ds_read_b64_tr_b16 v[68:69], v31 offset:1152
	ds_read_b64_tr_b16 v[70:71], v31 offset:1184
	ds_read_b64_tr_b16 v[72:73], v31 offset:64
	ds_read_b64_tr_b16 v[74:75], v31 offset:96
	ds_read_b64_tr_b16 v[76:77], v31 offset:192
	ds_read_b64_tr_b16 v[78:79], v31 offset:224
	ds_read_b64_tr_b16 v[80:81], v31 offset:320
	ds_read_b64_tr_b16 v[82:83], v31 offset:352
	ds_read_b64_tr_b16 v[84:85], v31 offset:448
	ds_read_b64_tr_b16 v[86:87], v31 offset:480
	ds_read_b64_tr_b16 v[88:89], v31 offset:1088
	ds_read_b64_tr_b16 v[90:91], v31 offset:1120
	ds_read_b64_tr_b16 v[92:93], v31 offset:1216
	ds_read_b64_tr_b16 v[94:95], v31 offset:1248
	s_waitcnt lgkmcnt(12)
	v_mfma_f32_16x16x32_bf16 v[172:175], v[48:51], v[132:135], 0
	v_mfma_f32_16x16x32_bf16 v[176:179], v[52:55], v[132:135], 0
	v_mfma_f32_16x16x32_bf16 v[180:183], v[56:59], v[132:135], 0
	v_mfma_f32_16x16x32_bf16 v[184:187], v[60:63], v[132:135], 0
	v_mfma_f32_16x16x32_bf16 v[188:191], v[64:67], v[132:135], 0
	v_mfma_f32_16x16x32_bf16 v[192:195], v[68:71], v[132:135], 0
	v_mfma_f32_16x16x32_bf16 v[196:199], v[48:51], v[152:155], 0
	v_mfma_f32_16x16x32_bf16 v[200:203], v[52:55], v[152:155], 0
	v_mfma_f32_16x16x32_bf16 v[204:207], v[56:59], v[152:155], 0
	v_mfma_f32_16x16x32_bf16 v[208:211], v[60:63], v[152:155], 0
	v_mfma_f32_16x16x32_bf16 v[212:215], v[64:67], v[152:155], 0
	v_mfma_f32_16x16x32_bf16 v[216:219], v[68:71], v[152:155], 0
	ds_read_b64_tr_b16 v[48:49], v31 offset:512
	ds_read_b64_tr_b16 v[50:51], v31 offset:544
	ds_read_b64_tr_b16 v[52:53], v31 offset:640
	ds_read_b64_tr_b16 v[54:55], v31 offset:672
	ds_read_b64_tr_b16 v[56:57], v31 offset:768
	ds_read_b64_tr_b16 v[58:59], v31 offset:800
	ds_read_b64_tr_b16 v[60:61], v31 offset:896
	ds_read_b64_tr_b16 v[62:63], v31 offset:928
	ds_read_b64_tr_b16 v[64:65], v31 offset:1280
	ds_read_b64_tr_b16 v[66:67], v31 offset:1312
	ds_read_b64_tr_b16 v[68:69], v31 offset:1408
	ds_read_b64_tr_b16 v[70:71], v31 offset:1440
	s_waitcnt lgkmcnt(12)
	v_mfma_f32_16x16x32_bf16 v[172:175], v[72:75], v[136:139], v[172:175]
	v_mfma_f32_16x16x32_bf16 v[176:179], v[76:79], v[136:139], v[176:179]
	v_mfma_f32_16x16x32_bf16 v[180:183], v[80:83], v[136:139], v[180:183]
	v_mfma_f32_16x16x32_bf16 v[184:187], v[84:87], v[136:139], v[184:187]
	v_mfma_f32_16x16x32_bf16 v[188:191], v[88:91], v[136:139], v[188:191]
	v_mfma_f32_16x16x32_bf16 v[192:195], v[92:95], v[136:139], v[192:195]
	v_mfma_f32_16x16x32_bf16 v[196:199], v[72:75], v[156:159], v[196:199]
	v_mfma_f32_16x16x32_bf16 v[200:203], v[76:79], v[156:159], v[200:203]
	v_mfma_f32_16x16x32_bf16 v[204:207], v[80:83], v[156:159], v[204:207]
	v_mfma_f32_16x16x32_bf16 v[208:211], v[84:87], v[156:159], v[208:211]
	v_mfma_f32_16x16x32_bf16 v[212:215], v[88:91], v[156:159], v[212:215]
	v_mfma_f32_16x16x32_bf16 v[216:219], v[92:95], v[156:159], v[216:219]
	ds_read_b64_tr_b16 v[72:73], v31 offset:576
	ds_read_b64_tr_b16 v[74:75], v31 offset:608
	ds_read_b64_tr_b16 v[76:77], v31 offset:704
	ds_read_b64_tr_b16 v[78:79], v31 offset:736
	ds_read_b64_tr_b16 v[80:81], v31 offset:832
	ds_read_b64_tr_b16 v[82:83], v31 offset:864
	ds_read_b64_tr_b16 v[84:85], v31 offset:960
	ds_read_b64_tr_b16 v[86:87], v31 offset:992
	ds_read_b64_tr_b16 v[88:89], v31 offset:1344
	ds_read_b64_tr_b16 v[90:91], v31 offset:1376
	ds_read_b64_tr_b16 v[92:93], v31 offset:1472
	ds_read_b64_tr_b16 v[94:95], v31 offset:1504
	s_waitcnt lgkmcnt(12)
	v_mfma_f32_16x16x32_bf16 v[172:175], v[48:51], v[140:143], v[172:175]
	v_mfma_f32_16x16x32_bf16 v[176:179], v[52:55], v[140:143], v[176:179]
	v_mfma_f32_16x16x32_bf16 v[180:183], v[56:59], v[140:143], v[180:183]
	v_mfma_f32_16x16x32_bf16 v[184:187], v[60:63], v[140:143], v[184:187]
	v_mfma_f32_16x16x32_bf16 v[188:191], v[64:67], v[140:143], v[188:191]
	v_mfma_f32_16x16x32_bf16 v[192:195], v[68:71], v[140:143], v[192:195]
	v_mfma_f32_16x16x32_bf16 v[196:199], v[48:51], v[160:163], v[196:199]
	v_mfma_f32_16x16x32_bf16 v[200:203], v[52:55], v[160:163], v[200:203]
	v_mfma_f32_16x16x32_bf16 v[204:207], v[56:59], v[160:163], v[204:207]
	v_mfma_f32_16x16x32_bf16 v[208:211], v[60:63], v[160:163], v[208:211]
	v_mfma_f32_16x16x32_bf16 v[212:215], v[64:67], v[160:163], v[212:215]
	v_mfma_f32_16x16x32_bf16 v[216:219], v[68:71], v[160:163], v[216:219]
	ds_read_b64_tr_b16 v[48:49], v31 offset:1536
	ds_read_b64_tr_b16 v[50:51], v31 offset:1568
	ds_read_b64_tr_b16 v[52:53], v31 offset:1600
	ds_read_b64_tr_b16 v[54:55], v31 offset:1632
	ds_read_b64_tr_b16 v[56:57], v31 offset:1664
	ds_read_b64_tr_b16 v[58:59], v31 offset:1696
	ds_read_b64_tr_b16 v[60:61], v31 offset:1728
	ds_read_b64_tr_b16 v[62:63], v31 offset:1760
	ds_read_b64_tr_b16 v[64:65], v31 offset:1792
	ds_read_b64_tr_b16 v[66:67], v31 offset:1824
	ds_read_b64_tr_b16 v[68:69], v31 offset:1856
	ds_read_b64_tr_b16 v[70:71], v31 offset:1888
	s_waitcnt lgkmcnt(12)
	v_mfma_f32_16x16x32_bf16 v[172:175], v[72:75], v[144:147], v[172:175]
	v_mfma_f32_16x16x32_bf16 v[176:179], v[76:79], v[144:147], v[176:179]
	v_mfma_f32_16x16x32_bf16 v[180:183], v[80:83], v[144:147], v[180:183]
	v_mfma_f32_16x16x32_bf16 v[184:187], v[84:87], v[144:147], v[184:187]
	v_mfma_f32_16x16x32_bf16 v[188:191], v[88:91], v[144:147], v[188:191]
	v_mfma_f32_16x16x32_bf16 v[192:195], v[92:95], v[144:147], v[192:195]
	v_mfma_f32_16x16x32_bf16 v[196:199], v[72:75], v[164:167], v[196:199]
	v_mfma_f32_16x16x32_bf16 v[200:203], v[76:79], v[164:167], v[200:203]
	v_mfma_f32_16x16x32_bf16 v[204:207], v[80:83], v[164:167], v[204:207]
	v_mfma_f32_16x16x32_bf16 v[208:211], v[84:87], v[164:167], v[208:211]
	v_mfma_f32_16x16x32_bf16 v[212:215], v[88:91], v[164:167], v[212:215]
	v_mfma_f32_16x16x32_bf16 v[216:219], v[92:95], v[164:167], v[216:219]
	s_waitcnt lgkmcnt(0)
	v_mfma_f32_16x16x32_bf16 v[172:175], v[48:51], v[148:151], v[172:175]
	v_mfma_f32_16x16x32_bf16 v[176:179], v[52:55], v[148:151], v[176:179]
	v_mfma_f32_16x16x32_bf16 v[180:183], v[56:59], v[148:151], v[180:183]
	v_mfma_f32_16x16x32_bf16 v[184:187], v[60:63], v[148:151], v[184:187]
	v_mfma_f32_16x16x32_bf16 v[188:191], v[64:67], v[148:151], v[188:191]
	v_mfma_f32_16x16x32_bf16 v[192:195], v[68:71], v[148:151], v[192:195]
	v_mfma_f32_16x16x32_bf16 v[196:199], v[48:51], v[168:171], v[196:199]
	v_mfma_f32_16x16x32_bf16 v[200:203], v[52:55], v[168:171], v[200:203]
	v_mfma_f32_16x16x32_bf16 v[204:207], v[56:59], v[168:171], v[204:207]
	v_mfma_f32_16x16x32_bf16 v[208:211], v[60:63], v[168:171], v[208:211]
	v_mfma_f32_16x16x32_bf16 v[212:215], v[64:67], v[168:171], v[212:215]
	v_mfma_f32_16x16x32_bf16 v[216:219], v[68:71], v[168:171], v[216:219]
	s_nop 1
	v_add_f32 v192, 0x358637bd, v192
	v_rcp_f32 v192, v192
	s_nop 0
	v_pk_mul_f32 v[172:173], v[172:173], v[192:193] op_sel_hi:[1,0]
	v_pk_mul_f32 v[174:175], v[174:175], v[192:193] op_sel_hi:[1,0]
	v_pk_mul_f32 v[176:177], v[176:177], v[192:193] op_sel_hi:[1,0]
	v_pk_mul_f32 v[178:179], v[178:179], v[192:193] op_sel_hi:[1,0]
	v_pk_mul_f32 v[180:181], v[180:181], v[192:193] op_sel_hi:[1,0]
	v_pk_mul_f32 v[182:183], v[182:183], v[192:193] op_sel_hi:[1,0]
	v_pk_mul_f32 v[184:185], v[184:185], v[192:193] op_sel_hi:[1,0]
	v_pk_mul_f32 v[186:187], v[186:187], v[192:193] op_sel_hi:[1,0]
	v_pk_mul_f32 v[188:189], v[188:189], v[192:193] op_sel_hi:[1,0]
	v_pk_mul_f32 v[190:191], v[190:191], v[192:193] op_sel_hi:[1,0]
	v_cvt_pk_bf16_f32 v100, v172, v173
	v_cvt_pk_bf16_f32 v101, v174, v175
	v_cvt_pk_bf16_f32 v102, v176, v177
	v_cvt_pk_bf16_f32 v103, v178, v179
	v_cvt_pk_bf16_f32 v104, v180, v181
	v_cvt_pk_bf16_f32 v105, v182, v183
	v_cvt_pk_bf16_f32 v106, v184, v185
	v_cvt_pk_bf16_f32 v107, v186, v187
	v_cvt_pk_bf16_f32 v108, v188, v189
	v_cvt_pk_bf16_f32 v109, v190, v191
	buffer_store_dwordx4 v[100:103], v8, s[40:43], s14 offen sc1
	buffer_store_dwordx4 v[104:107], v9, s[40:43], s14 offen sc1
	buffer_store_dwordx2 v[108:109], v10, s[40:43], s12 offen sc1
	v_add_f32 v216, 0x358637bd, v216
	v_rcp_f32 v216, v216
	s_nop 0
	v_pk_mul_f32 v[196:197], v[196:197], v[216:217] op_sel_hi:[1,0]
	v_pk_mul_f32 v[198:199], v[198:199], v[216:217] op_sel_hi:[1,0]
	v_pk_mul_f32 v[200:201], v[200:201], v[216:217] op_sel_hi:[1,0]
	v_pk_mul_f32 v[202:203], v[202:203], v[216:217] op_sel_hi:[1,0]
	v_pk_mul_f32 v[204:205], v[204:205], v[216:217] op_sel_hi:[1,0]
	v_pk_mul_f32 v[206:207], v[206:207], v[216:217] op_sel_hi:[1,0]
	v_pk_mul_f32 v[208:209], v[208:209], v[216:217] op_sel_hi:[1,0]
	v_pk_mul_f32 v[210:211], v[210:211], v[216:217] op_sel_hi:[1,0]
	v_pk_mul_f32 v[212:213], v[212:213], v[216:217] op_sel_hi:[1,0]
	v_pk_mul_f32 v[214:215], v[214:215], v[216:217] op_sel_hi:[1,0]
	v_cvt_pk_bf16_f32 v112, v196, v197
	v_cvt_pk_bf16_f32 v113, v198, v199
	v_cvt_pk_bf16_f32 v114, v200, v201
	v_cvt_pk_bf16_f32 v115, v202, v203
	v_cvt_pk_bf16_f32 v116, v204, v205
	v_cvt_pk_bf16_f32 v117, v206, v207
	v_cvt_pk_bf16_f32 v118, v208, v209
	v_cvt_pk_bf16_f32 v119, v210, v211
	v_cvt_pk_bf16_f32 v120, v212, v213
	v_cvt_pk_bf16_f32 v121, v214, v215
	buffer_store_dwordx4 v[112:115], v8, s[40:43], s14 offen offset:1024 sc1
	buffer_store_dwordx4 v[116:119], v9, s[40:43], s14 offen offset:1024 sc1
	buffer_store_dwordx2 v[120:121], v10, s[40:43], s12 offen offset:1024 sc1
	s_waitcnt vmcnt(0)
	v_lshl_add_u32 v42, v1, 2, s13
	v_mov_b32 v43, s75
	s_mov_b64 exec, 0xffffffff
	buffer_store_dword v43, v42, s[40:43], 0 offen sc1
	s_mov_b64 exec, -1
	s_cmp_lg_u32 s70, 0
	s_cbranch_scc1 L_a_done
	s_cmp_lg_u32 s3, 3
	s_cbranch_scc1 L_a_done
	v_and_b32 v20, 31, v1
	v_min_u32 v20, 26, v20
	v_and_b32 v21, 32, v1
	v_add_u32 v20, v20, v21
	v_lshlrev_b32 v20, 9, v20
	v_add_u32 v22, 20000768, v20
	buffer_load_dword v21, v22, s[40:43], 0 offen sc1
	s_waitcnt vmcnt(0)
	v_cmp_ne_u32 vcc, s75, v21
	s_nop 4
	s_cbranch_vccz L_ok_5
	s_mov_b32 s84, 0
L_poll_6:
	s_sleep 12
	buffer_load_dword v21, v22, s[40:43], 0 offen sc1
	s_waitcnt vmcnt(0)
	v_cmp_ne_u32 vcc, s75, v21
	s_nop 4
	s_cbranch_vccz L_ok_5
	s_add_u32 s84, s84, 1
	s_cmp_lt_u32 s84, 0x8000
	s_cbranch_scc1 L_poll_6
L_ok_5:
	v_add_u32 v22, 20033536, v20
	buffer_load_dword v21, v22, s[40:43], 0 offen sc1
	s_waitcnt vmcnt(0)
	v_cmp_ne_u32 vcc, s75, v21
	s_nop 4
	s_cbranch_vccz L_ok_7
	s_mov_b32 s84, 0
L_poll_8:
	s_sleep 12
	buffer_load_dword v21, v22, s[40:43], 0 offen sc1
	s_waitcnt vmcnt(0)
	v_cmp_ne_u32 vcc, s75, v21
	s_nop 4
	s_cbranch_vccz L_ok_7
	s_add_u32 s84, s84, 1
	s_cmp_lt_u32 s84, 0x8000
	s_cbranch_scc1 L_poll_8
L_ok_7:
	v_add_u32 v22, 20066304, v20
	buffer_load_dword v21, v22, s[40:43], 0 offen sc1
	s_waitcnt vmcnt(0)
	v_cmp_ne_u32 vcc, s75, v21
	s_nop 4
	s_cbranch_vccz L_ok_9
	s_mov_b32 s84, 0
L_poll_10:
	s_sleep 12
	buffer_load_dword v21, v22, s[40:43], 0 offen sc1
	s_waitcnt vmcnt(0)
	v_cmp_ne_u32 vcc, s75, v21
	s_nop 4
	s_cbranch_vccz L_ok_9
	s_add_u32 s84, s84, 1
	s_cmp_lt_u32 s84, 0x8000
	s_cbranch_scc1 L_poll_10
L_ok_9:
	v_add_u32 v22, 20099072, v20
	buffer_load_dword v21, v22, s[40:43], 0 offen sc1
	s_waitcnt vmcnt(0)
	v_cmp_ne_u32 vcc, s75, v21
	s_nop 4
	s_cbranch_vccz L_ok_11
	s_mov_b32 s84, 0
L_poll_12:
	s_sleep 12
	buffer_load_dword v21, v22, s[40:43], 0 offen sc1
	s_waitcnt vmcnt(0)
	v_cmp_ne_u32 vcc, s75, v21
	s_nop 4
	s_cbranch_vccz L_ok_11
	s_add_u32 s84, s84, 1
	s_cmp_lt_u32 s84, 0x8000
	s_cbranch_scc1 L_poll_12
L_ok_11:
	v_lshlrev_b32 v20, 7, v1
	v_add_u32 v22, 19984384, v20
	buffer_load_dword v21, v22, s[40:43], 0 offen sc1
	s_waitcnt vmcnt(0)
	v_cmp_ne_u32 vcc, s75, v21
	s_nop 4
	s_cbranch_vccz L_ok_13
	s_mov_b32 s84, 0
L_poll_14:
	s_sleep 12
	buffer_load_dword v21, v22, s[40:43], 0 offen sc1
	s_waitcnt vmcnt(0)
	v_cmp_ne_u32 vcc, s75, v21
	s_nop 4
	s_cbranch_vccz L_ok_13
	s_add_u32 s84, s84, 1
	s_cmp_lt_u32 s84, 0x8000
	s_cbranch_scc1 L_poll_14
L_ok_13:
	v_add_u32 v22, 19992576, v20
	buffer_load_dword v21, v22, s[40:43], 0 offen sc1
	s_waitcnt vmcnt(0)
	v_cmp_ne_u32 vcc, s75, v21
	s_nop 4
	s_cbranch_vccz L_ok_15
	s_mov_b32 s84, 0
L_poll_16:
	s_sleep 12
	buffer_load_dword v21, v22, s[40:43], 0 offen sc1
	s_waitcnt vmcnt(0)
	v_cmp_ne_u32 vcc, s75, v21
	s_nop 4
	s_cbranch_vccz L_ok_15
	s_add_u32 s84, s84, 1
	s_cmp_lt_u32 s84, 0x8000
	s_cbranch_scc1 L_poll_16
L_ok_15:
	v_and_b32 v20, 31, v1
	v_lshlrev_b32 v20, 7, v20
	v_add_u32 v22, 20262912, v20
	buffer_load_dword v21, v22, s[40:43], 0 offen sc1
	s_waitcnt vmcnt(0)
	v_cmp_ne_u32 vcc, s75, v21
	s_nop 4
	s_cbranch_vccz L_ok_17
	s_mov_b32 s84, 0
L_poll_18:
	s_sleep 12
	buffer_load_dword v21, v22, s[40:43], 0 offen sc1
	s_waitcnt vmcnt(0)
	v_cmp_ne_u32 vcc, s75, v21
	s_nop 4
	s_cbranch_vccz L_ok_17
	s_add_u32 s84, s84, 1
	s_cmp_lt_u32 s84, 0x8000
	s_cbranch_scc1 L_poll_18
L_ok_17:
	s_mov_b32 s10, 20344832
	v_lshl_add_u32 v42, v1, 2, s10
	v_mov_b32 v43, s75
	s_mov_b64 exec, 0xffffffff
	buffer_store_dword v43, v42, s[40:43], 0 offen sc1
	s_mov_b64 exec, -1
L_a_done:
	s_endpgm
L_not_a:
	s_and_b32 s4, s70, 7
	s_lshr_b32 s5, s70, 3
	s_sub_u32 s5, s5, 16
	s_cmp_ge_u32 s5, 14
	s_cbranch_scc1 L_role_r
	s_and_b32 s7, s4, 1
	s_add_u32 s7, s7, 13
	s_cmp_ge_u32 s5, s7
	s_cbranch_scc1 L_role_wot
	s_mul_i32 s6, s4, 27
	s_lshr_b32 s6, s6, 1
	s_add_u32 s6, s6, s5
	s_lshr_b32 s81, s6, 2
	s_and_b32 s9, s6, 3
	s_lshl_b32 s6, s9, 1
	s_add_u32 s80, s6, s91
	s_mov_b32 s52, s26
	s_and_b32 s53, s27, 0xffff
	s_mov_b32 s54, 7077888
	s_mov_b32 s55, 0x20000
	v_lshlrev_b32 v12, 4, v1
	v_add_u32 v13, 4096, v12
	s_lshl_b32 s83, s3, 12
	v_bfe_u32 v25, v7, 1, 2
	v_xor_b32 v25, s3, v25
	v_lshlrev_b32 v26, 7, v7
	v_lshl_add_u32 v26, v5, 3, v26
	v_add_u32 v26, s83, v26
	v_xor_b32 v27, 0, v25
	v_lshl_add_u32 v14, v27, 5, v26
	v_xor_b32 v27, 1, v25
	v_lshl_add_u32 v15, v27, 5, v26
	v_xor_b32 v27, 2, v25
	v_lshl_add_u32 v16, v27, 5, v26
	v_xor_b32 v27, 3, v25
	v_lshl_add_u32 v17, v27, 5, v26
	v_lshrrev_b32 v24, 3, v1
	v_lshrrev_b32 v25, 2, v24
	v_and_b32 v24, 3, v24
	v_lshl_add_u32 v24, v25, 3, v24
	v_mul_u32_u24 v24, 3456, v24
	v_and_b32 v25, 7, v1
	v_lshlrev_b32 v26, 1, v2
	v_xor_b32 v25, v25, v26
	v_lshl_add_u32 v24, v25, 4, v24
	s_lshl_b32 s4, s81, 7
	s_mul_i32 s5, s3, 1769472
	s_add_u32 s5, s5, s4
	s_mul_i32 s6, s91, 13824
	s_add_u32 s5, s5, s6
	s_lshl_b32 s6, s91, 11
	s_add_u32 s74, s83, s6
	s_add_u32 s6, s5, 0
	v_add_u32 v8, s6, v24
	s_add_u32 s6, s5, 54272
	v_add_u32 v9, s6, v24
	s_mul_i32 s4, s80, 64
	s_mul_i32 s5, s3, 16
	s_add_u32 s4, s4, s5
	s_mul_i32 s4, s4, 5120
	s_add_u32 s82, s4, 0
	s_lshl_b32 s4, s3, 13
	s_add_u32 s4, s4, 19722240
	v_lshl_add_u32 v22, v1, 7, s4
	s_add_u32 m0, s74, 0
	s_nop 0
	buffer_load_dwordx4 v8, s[52:55], 0 offen lds
	v_add_u32 v8, 110592, v8
	buffer_load_dwordx4 v9, s[52:55], 0 offen offset:1024 lds
	v_add_u32 v9, 110592, v9
	s_add_u32 m0, s74, 16384
	s_nop 0
	buffer_load_dwordx4 v8, s[52:55], 0 offen lds
	v_add_u32 v8, 110592, v8
	buffer_load_dwordx4 v9, s[52:55], 0 offen offset:1024 lds
	v_add_u32 v9, 110592, v9
	s_add_u32 m0, s74, 32768
	s_nop 0
	buffer_load_dwordx4 v8, s[52:55], 0 offen lds
	v_add_u32 v8, 110592, v8
	buffer_load_dwordx4 v9, s[52:55], 0 offen offset:1024 lds
	v_add_u32 v9, 110592, v9
	s_add_u32 m0, s74, 49152
	s_nop 0
	buffer_load_dwordx4 v8, s[52:55], 0 offen lds
	v_add_u32 v8, 110592, v8
	buffer_load_dwordx4 v9, s[52:55], 0 offen offset:1024 lds
	v_add_u32 v9, 110592, v9
	s_add_u32 m0, s74, 65536
	s_nop 0
	buffer_load_dwordx4 v8, s[52:55], 0 offen lds
	v_add_u32 v8, 110592, v8
	buffer_load_dwordx4 v9, s[52:55], 0 offen offset:1024 lds
	v_add_u32 v9, 110592, v9
	s_add_u32 m0, s74, 81920
	s_nop 0
	buffer_load_dwordx4 v8, s[52:55], 0 offen lds
	v_add_u32 v8, 110592, v8
	buffer_load_dwordx4 v9, s[52:55], 0 offen offset:1024 lds
	v_add_u32 v9, 110592, v9
	s_add_u32 m0, s74, 98304
	s_nop 0
	buffer_load_dwordx4 v8, s[52:55], 0 offen lds
	v_add_u32 v8, 110592, v8
	buffer_load_dwordx4 v9, s[52:55], 0 offen offset:1024 lds
	v_add_u32 v9, 110592, v9
	s_add_u32 m0, s74, 114688
	s_nop 0
	buffer_load_dwordx4 v8, s[52:55], 0 offen lds
	v_add_u32 v8, 110592, v8
	buffer_load_dwordx4 v9, s[52:55], 0 offen offset:1024 lds
	v_add_u32 v9, 110592, v9
	s_add_u32 m0, s74, 131072
	s_nop 0
	buffer_load_dwordx4 v8, s[52:55], 0 offen lds
	v_add_u32 v8, 110592, v8
	buffer_load_dwordx4 v9, s[52:55], 0 offen offset:1024 lds
	v_add_u32 v9, 110592, v9
	s_add_u32 m0, s74, 147456
	s_nop 0
	buffer_load_dwordx4 v8, s[52:55], 0 offen lds
	v_add_u32 v8, 110592, v8
	buffer_load_dwordx4 v9, s[52:55], 0 offen offset:1024 lds
	v_add_u32 v9, 110592, v9
	s_lshl_b32 s4, s9, 1
	s_add_u32 s4, s4, s91
	s_mul_i32 s4, s4, 24
	s_lshl_b32 s5, s3, 9
	s_add_u32 s4, s4, s5
	s_add_u32 s4, s4, 320
	s_mul_i32 s4, s4, 3456
	s_lshl_b32 s5, s81, 7
	s_add_u32 s4, s4, s5
	v_min_u32 v24, 23, v1
	v_mul_u32_u24 v24, 3456, v24
	v_add_u32 v24, s4, v24
	buffer_load_dword v37, v24, s[52:55], 0 offen
	s_mov_b32 s60, s28
	s_and_b32 s61, s29, 0xffff
	s_mov_b32 s62, 3456
	s_mov_b32 s63, 0x20000
	s_lshl_b32 s4, s81, 7
	s_lshl_b32 s5, s3, 5
	s_add_u32 s4, s4, s5
	v_lshl_add_u32 v24, v2, 3, s4
	buffer_load_dwordx2 v[38:39], v24, s[60:63], 0 offen
	s_waitcnt lgkmcnt(0)
	s_add_u32 s75, s75, 1
	s_barrier
	s_cmp_lg_u32 s91, 0
	s_cbranch_scc1 L_b_go
	buffer_load_dword v23, v22, s[40:43], 0 offen sc1
	s_waitcnt vmcnt(0)
	v_cmp_ne_u32 vcc, s75, v23
	s_nop 4
	s_cbranch_vccz L_ok_19
	s_mov_b32 s84, 0
L_poll_20:
	s_sleep 3
	buffer_load_dword v23, v22, s[40:43], 0 offen sc1
	s_waitcnt vmcnt(0)
	v_cmp_ne_u32 vcc, s75, v23
	s_nop 4
	s_cbranch_vccz L_ok_19
	s_add_u32 s84, s84, 1
	s_cmp_lt_u32 s84, 0x8000
	s_cbranch_scc1 L_poll_20
L_ok_19:
L_b_go:
	s_waitcnt vmcnt(0)
	s_barrier
	buffer_load_dwordx4 v[156:159], v12, s[40:43], s82 offen sc1
	buffer_load_dwordx4 v[160:163], v12, s[40:43], s82 offen offset:1024 sc1
	buffer_load_dwordx4 v[164:167], v12, s[40:43], s82 offen offset:2048 sc1
	buffer_load_dwordx4 v[168:171], v12, s[40:43], s82 offen offset:3072 sc1
	buffer_load_dwordx4 v[172:175], v13, s[40:43], s82 offen sc1
	s_add_u32 s82, s82, 5120
	buffer_load_dwordx4 v[176:179], v12, s[40:43], s82 offen sc1
	buffer_load_dwordx4 v[180:183], v12, s[40:43], s82 offen offset:1024 sc1
	buffer_load_dwordx4 v[184:187], v12, s[40:43], s82 offen offset:2048 sc1
	buffer_load_dwordx4 v[188:191], v12, s[40:43], s82 offen offset:3072 sc1
	buffer_load_dwordx4 v[192:195], v13, s[40:43], s82 offen sc1
	s_add_u32 s82, s82, 5120
	buffer_load_dwordx4 v[196:199], v12, s[40:43], s82 offen sc1
	buffer_load_dwordx4 v[200:203], v12, s[40:43], s82 offen offset:1024 sc1
	buffer_load_dwordx4 v[204:207], v12, s[40:43], s82 offen offset:2048 sc1
	buffer_load_dwordx4 v[208:211], v12, s[40:43], s82 offen offset:3072 sc1
	buffer_load_dwordx4 v[212:215], v13, s[40:43], s82 offen sc1
	s_add_u32 s82, s82, 5120
	buffer_load_dwordx4 v[216:219], v12, s[40:43], s82 offen sc1
	buffer_load_dwordx4 v[220:223], v12, s[40:43], s82 offen offset:1024 sc1
	buffer_load_dwordx4 v[224:227], v12, s[40:43], s82 offen offset:2048 sc1
	buffer_load_dwordx4 v[228:231], v12, s[40:43], s82 offen offset:3072 sc1
	buffer_load_dwordx4 v[232:235], v13, s[40:43], s82 offen sc1
	s_add_u32 s82, s82, 5120
	buffer_load_dwordx4 v[236:239], v12, s[40:43], s82 offen sc1
	buffer_load_dwordx4 v[240:243], v12, s[40:43], s82 offen offset:1024 sc1
	buffer_load_dwordx4 v[244:247], v12, s[40:43], s82 offen offset:2048 sc1
	buffer_load_dwordx4 v[248:251], v12, s[40:43], s82 offen offset:3072 sc1
	buffer_load_dwordx4 v[252:255], v13, s[40:43], s82 offen sc1
	s_add_u32 s82, s82, 5120
	v_lshlrev_b32 v44, 16, v38
	v_and_b32 v45, 0xffff0000, v38
	v_lshlrev_b32 v46, 16, v39
	v_and_b32 v47, 0xffff0000, v39
	v_lshlrev_b32 v48, 16, v38
	v_and_b32 v49, 0xffff0000, v38
	v_lshlrev_b32 v50, 16, v39
	v_and_b32 v51, 0xffff0000, v39
	v_lshlrev_b32 v52, 16, v38
	v_and_b32 v53, 0xffff0000, v38
	v_lshlrev_b32 v54, 16, v39
	v_and_b32 v55, 0xffff0000, v39
	v_lshlrev_b32 v56, 16, v38
	v_and_b32 v57, 0xffff0000, v38
	v_lshlrev_b32 v58, 16, v39
	v_and_b32 v59, 0xffff0000, v39
	v_lshlrev_b32 v60, 16, v38
	v_and_b32 v61, 0xffff0000, v38
	v_lshlrev_b32 v62, 16, v39
	v_and_b32 v63, 0xffff0000, v39
	ds_read_b64_tr_b16 v[124:125], v14 offset:0
	ds_read_b64_tr_b16 v[126:127], v14 offset:2048
	ds_read_b64_tr_b16 v[128:129], v15 offset:0
	ds_read_b64_tr_b16 v[130:131], v15 offset:2048
	ds_read_b64_tr_b16 v[132:133], v16 offset:0
	ds_read_b64_tr_b16 v[134:135], v16 offset:2048
	ds_read_b64_tr_b16 v[136:137], v17 offset:0
	ds_read_b64_tr_b16 v[138:139], v17 offset:2048
	s_waitcnt vmcnt(20) lgkmcnt(0)
	s_barrier
	v_mfma_f32_16x16x32_bf16 v[64:67], v[128:131], v[156:159], 0
	ds_read_b64_tr_b16 v[140:141], v14 offset:16384
	ds_read_b64_tr_b16 v[142:143], v14 offset:18432
	v_mfma_f32_16x16x32_bf16 v[68:71], v[128:131], v[160:163], 0
	ds_read_b64_tr_b16 v[144:145], v15 offset:16384
	ds_read_b64_tr_b16 v[146:147], v15 offset:18432
	v_mfma_f32_16x16x32_bf16 v[72:75], v[128:131], v[164:167], 0
	ds_read_b64_tr_b16 v[148:149], v16 offset:16384
	ds_read_b64_tr_b16 v[150:151], v16 offset:18432
	v_mfma_f32_16x16x32_bf16 v[76:79], v[128:131], v[168:171], 0
	v_mfma_f32_16x16x32_bf16 v[80:83], v[128:131], v[172:175], 0
	ds_read_b64_tr_b16 v[152:153], v17 offset:16384
	ds_read_b64_tr_b16 v[154:155], v17 offset:18432
	v_mfma_f32_16x16x32_bf16 v[84:87], v[132:135], v[156:159], 0
	s_add_u32 m0, s74, 0
	s_nop 0
	buffer_load_dwordx4 v8, s[52:55], 0 offen lds
	v_add_u32 v8, 110592, v8
	v_mfma_f32_16x16x32_bf16 v[88:91], v[132:135], v[160:163], 0
	buffer_load_dwordx4 v9, s[52:55], 0 offen offset:1024 lds
	v_add_u32 v9, 110592, v9
	v_mfma_f32_16x16x32_bf16 v[92:95], v[132:135], v[164:167], 0
	v_mfma_f32_16x16x32_bf16 v[96:99], v[132:135], v[168:171], 0
	v_mfma_f32_16x16x32_bf16 v[100:103], v[132:135], v[172:175], 0
	v_mfma_f32_16x16x32_bf16 v[104:107], v[136:139], v[156:159], 0
	v_mfma_f32_16x16x32_bf16 v[108:111], v[136:139], v[160:163], 0
	v_mfma_f32_16x16x32_bf16 v[112:115], v[136:139], v[164:167], 0
	v_mfma_f32_16x16x32_bf16 v[116:119], v[136:139], v[168:171], 0
	v_mfma_f32_16x16x32_bf16 v[120:123], v[136:139], v[172:175], 0
	v_mfma_f32_16x16x32_bf16 v[44:47], v[124:127], v[156:159], v[44:47]
	v_mfma_f32_16x16x32_bf16 v[48:51], v[124:127], v[160:163], v[48:51]
	v_mfma_f32_16x16x32_bf16 v[52:55], v[124:127], v[164:167], v[52:55]
	v_mfma_f32_16x16x32_bf16 v[56:59], v[124:127], v[168:171], v[56:59]
	v_mfma_f32_16x16x32_bf16 v[60:63], v[124:127], v[172:175], v[60:63]
	s_waitcnt vmcnt(17) lgkmcnt(0)
	s_barrier
	v_mfma_f32_16x16x32_bf16 v[64:67], v[144:147], v[176:179], v[64:67]
	ds_read_b64_tr_b16 v[124:125], v14 offset:32768
	ds_read_b64_tr_b16 v[126:127], v14 offset:34816
	v_mfma_f32_16x16x32_bf16 v[68:71], v[144:147], v[180:183], v[68:71]
	ds_read_b64_tr_b16 v[128:129], v15 offset:32768
	ds_read_b64_tr_b16 v[130:131], v15 offset:34816
	v_mfma_f32_16x16x32_bf16 v[72:75], v[144:147], v[184:187], v[72:75]
	ds_read_b64_tr_b16 v[132:133], v16 offset:32768
	ds_read_b64_tr_b16 v[134:135], v16 offset:34816
	v_mfma_f32_16x16x32_bf16 v[76:79], v[144:147], v[188:191], v[76:79]
	v_mfma_f32_16x16x32_bf16 v[80:83], v[144:147], v[192:195], v[80:83]
	ds_read_b64_tr_b16 v[136:137], v17 offset:32768
	ds_read_b64_tr_b16 v[138:139], v17 offset:34816
	v_mfma_f32_16x16x32_bf16 v[84:87], v[148:151], v[176:179], v[84:87]
	s_add_u32 m0, s74, 16384
	s_nop 0
	buffer_load_dwordx4 v8, s[52:55], 0 offen lds
	v_add_u32 v8, 110592, v8
	v_mfma_f32_16x16x32_bf16 v[88:91], v[148:151], v[180:183], v[88:91]
	buffer_load_dwordx4 v9, s[52:55], 0 offen offset:1024 lds
	v_add_u32 v9, 110592, v9
	v_mfma_f32_16x16x32_bf16 v[92:95], v[148:151], v[184:187], v[92:95]
	v_mfma_f32_16x16x32_bf16 v[96:99], v[148:151], v[188:191], v[96:99]
	buffer_load_dwordx4 v[156:159], v12, s[40:43], s82 offen sc1
	v_mfma_f32_16x16x32_bf16 v[100:103], v[148:151], v[192:195], v[100:103]
	buffer_load_dwordx4 v[160:163], v12, s[40:43], s82 offen offset:1024 sc1
	v_mfma_f32_16x16x32_bf16 v[104:107], v[152:155], v[176:179], v[104:107]
	buffer_load_dwordx4 v[164:167], v12, s[40:43], s82 offen offset:2048 sc1
	v_mfma_f32_16x16x32_bf16 v[108:111], v[152:155], v[180:183], v[108:111]
	v_mfma_f32_16x16x32_bf16 v[112:115], v[152:155], v[184:187], v[112:115]
	buffer_load_dwordx4 v[168:171], v12, s[40:43], s82 offen offset:3072 sc1
	v_mfma_f32_16x16x32_bf16 v[116:119], v[152:155], v[188:191], v[116:119]
	buffer_load_dwordx4 v[172:175], v13, s[40:43], s82 offen sc1
	s_add_u32 s82, s82, 5120
	v_mfma_f32_16x16x32_bf16 v[120:123], v[152:155], v[192:195], v[120:123]
	v_mfma_f32_16x16x32_bf16 v[44:47], v[140:143], v[176:179], v[44:47]
	v_mfma_f32_16x16x32_bf16 v[48:51], v[140:143], v[180:183], v[48:51]
	v_mfma_f32_16x16x32_bf16 v[52:55], v[140:143], v[184:187], v[52:55]
	v_mfma_f32_16x16x32_bf16 v[56:59], v[140:143], v[188:191], v[56:59]
	v_mfma_f32_16x16x32_bf16 v[60:63], v[140:143], v[192:195], v[60:63]
	s_waitcnt vmcnt(19) lgkmcnt(0)
	s_barrier
	v_mfma_f32_16x16x32_bf16 v[64:67], v[128:131], v[196:199], v[64:67]
	ds_read_b64_tr_b16 v[140:141], v14 offset:49152
	ds_read_b64_tr_b16 v[142:143], v14 offset:51200
	v_mfma_f32_16x16x32_bf16 v[68:71], v[128:131], v[200:203], v[68:71]
	ds_read_b64_tr_b16 v[144:145], v15 offset:49152
	ds_read_b64_tr_b16 v[146:147], v15 offset:51200
	v_mfma_f32_16x16x32_bf16 v[72:75], v[128:131], v[204:207], v[72:75]
	ds_read_b64_tr_b16 v[148:149], v16 offset:49152
	ds_read_b64_tr_b16 v[150:151], v16 offset:51200
	v_mfma_f32_16x16x32_bf16 v[76:79], v[128:131], v[208:211], v[76:79]
	v_mfma_f32_16x16x32_bf16 v[80:83], v[128:131], v[212:215], v[80:83]
	ds_read_b64_tr_b16 v[152:153], v17 offset:49152
	ds_read_b64_tr_b16 v[154:155], v17 offset:51200
	v_mfma_f32_16x16x32_bf16 v[84:87], v[132:135], v[196:199], v[84:87]
	s_add_u32 m0, s74, 32768
	s_nop 0
	buffer_load_dwordx4 v8, s[52:55], 0 offen lds
	v_add_u32 v8, 110592, v8
	v_mfma_f32_16x16x32_bf16 v[88:91], v[132:135], v[200:203], v[88:91]
	buffer_load_dwordx4 v9, s[52:55], 0 offen offset:1024 lds
	v_add_u32 v9, 110592, v9
	v_mfma_f32_16x16x32_bf16 v[92:95], v[132:135], v[204:207], v[92:95]
	v_mfma_f32_16x16x32_bf16 v[96:99], v[132:135], v[208:211], v[96:99]
	buffer_load_dwordx4 v[176:179], v12, s[40:43], s82 offen sc1
	v_mfma_f32_16x16x32_bf16 v[100:103], v[132:135], v[212:215], v[100:103]
	buffer_load_dwordx4 v[180:183], v12, s[40:43], s82 offen offset:1024 sc1
	v_mfma_f32_16x16x32_bf16 v[104:107], v[136:139], v[196:199], v[104:107]
	buffer_load_dwordx4 v[184:187], v12, s[40:43], s82 offen offset:2048 sc1
	v_mfma_f32_16x16x32_bf16 v[108:111], v[136:139], v[200:203], v[108:111]
	v_mfma_f32_16x16x32_bf16 v[112:115], v[136:139], v[204:207], v[112:115]
	buffer_load_dwordx4 v[188:191], v12, s[40:43], s82 offen offset:3072 sc1
	v_mfma_f32_16x16x32_bf16 v[116:119], v[136:139], v[208:211], v[116:119]
	buffer_load_dwordx4 v[192:195], v13, s[40:43], s82 offen sc1
	s_add_u32 s82, s82, 5120
	v_mfma_f32_16x16x32_bf16 v[120:123], v[136:139], v[212:215], v[120:123]
	v_mfma_f32_16x16x32_bf16 v[44:47], v[124:127], v[196:199], v[44:47]
	v_mfma_f32_16x16x32_bf16 v[48:51], v[124:127], v[200:203], v[48:51]
	v_mfma_f32_16x16x32_bf16 v[52:55], v[124:127], v[204:207], v[52:55]
	v_mfma_f32_16x16x32_bf16 v[56:59], v[124:127], v[208:211], v[56:59]
	v_mfma_f32_16x16x32_bf16 v[60:63], v[124:127], v[212:215], v[60:63]
	s_waitcnt vmcnt(21) lgkmcnt(0)
	s_barrier
	v_mfma_f32_16x16x32_bf16 v[64:67], v[144:147], v[216:219], v[64:67]
	v_add_u32 v18, 65536, v14
	ds_read_b64_tr_b16 v[124:125], v18 offset:0
	ds_read_b64_tr_b16 v[126:127], v18 offset:2048
	v_mfma_f32_16x16x32_bf16 v[68:71], v[144:147], v[220:223], v[68:71]
	v_add_u32 v19, 65536, v15
	ds_read_b64_tr_b16 v[128:129], v19 offset:0
	ds_read_b64_tr_b16 v[130:131], v19 offset:2048
	v_mfma_f32_16x16x32_bf16 v[72:75], v[144:147], v[224:227], v[72:75]
	v_add_u32 v20, 65536, v16
	ds_read_b64_tr_b16 v[132:133], v20 offset:0
	ds_read_b64_tr_b16 v[134:135], v20 offset:2048
	v_mfma_f32_16x16x32_bf16 v[76:79], v[144:147], v[228:231], v[76:79]
	v_mfma_f32_16x16x32_bf16 v[80:83], v[144:147], v[232:235], v[80:83]
	v_add_u32 v21, 65536, v17
	ds_read_b64_tr_b16 v[136:137], v21 offset:0
	ds_read_b64_tr_b16 v[138:139], v21 offset:2048
	v_mfma_f32_16x16x32_bf16 v[84:87], v[148:151], v[216:219], v[84:87]
	s_add_u32 m0, s74, 49152
	s_nop 0
	buffer_load_dwordx4 v8, s[52:55], 0 offen lds
	v_add_u32 v8, 110592, v8
	v_mfma_f32_16x16x32_bf16 v[88:91], v[148:151], v[220:223], v[88:91]
	buffer_load_dwordx4 v9, s[52:55], 0 offen offset:1024 lds
	v_add_u32 v9, 110592, v9
	v_mfma_f32_16x16x32_bf16 v[92:95], v[148:151], v[224:227], v[92:95]
	v_mfma_f32_16x16x32_bf16 v[96:99], v[148:151], v[228:231], v[96:99]
	buffer_load_dwordx4 v[196:199], v12, s[40:43], s82 offen sc1
	v_mfma_f32_16x16x32_bf16 v[100:103], v[148:151], v[232:235], v[100:103]
	buffer_load_dwordx4 v[200:203], v12, s[40:43], s82 offen offset:1024 sc1
	v_mfma_f32_16x16x32_bf16 v[104:107], v[152:155], v[216:219], v[104:107]
	buffer_load_dwordx4 v[204:207], v12, s[40:43], s82 offen offset:2048 sc1
	v_mfma_f32_16x16x32_bf16 v[108:111], v[152:155], v[220:223], v[108:111]
	v_mfma_f32_16x16x32_bf16 v[112:115], v[152:155], v[224:227], v[112:115]
	buffer_load_dwordx4 v[208:211], v12, s[40:43], s82 offen offset:3072 sc1
	v_mfma_f32_16x16x32_bf16 v[116:119], v[152:155], v[228:231], v[116:119]
	buffer_load_dwordx4 v[212:215], v13, s[40:43], s82 offen sc1
	s_add_u32 s82, s82, 5120
	v_mfma_f32_16x16x32_bf16 v[120:123], v[152:155], v[232:235], v[120:123]
	v_mfma_f32_16x16x32_bf16 v[44:47], v[140:143], v[216:219], v[44:47]
	v_mfma_f32_16x16x32_bf16 v[48:51], v[140:143], v[220:223], v[48:51]
	v_mfma_f32_16x16x32_bf16 v[52:55], v[140:143], v[224:227], v[52:55]
	v_mfma_f32_16x16x32_bf16 v[56:59], v[140:143], v[228:231], v[56:59]
	v_mfma_f32_16x16x32_bf16 v[60:63], v[140:143], v[232:235], v[60:63]
	s_waitcnt vmcnt(23) lgkmcnt(0)
	s_barrier
	v_mfma_f32_16x16x32_bf16 v[64:67], v[128:131], v[236:239], v[64:67]
	ds_read_b64_tr_b16 v[140:141], v18 offset:16384
	ds_read_b64_tr_b16 v[142:143], v18 offset:18432
	v_mfma_f32_16x16x32_bf16 v[68:71], v[128:131], v[240:243], v[68:71]
	ds_read_b64_tr_b16 v[144:145], v19 offset:16384
	ds_read_b64_tr_b16 v[146:147], v19 offset:18432
	v_mfma_f32_16x16x32_bf16 v[72:75], v[128:131], v[244:247], v[72:75]
	ds_read_b64_tr_b16 v[148:149], v20 offset:16384
	ds_read_b64_tr_b16 v[150:151], v20 offset:18432
	v_mfma_f32_16x16x32_bf16 v[76:79], v[128:131], v[248:251], v[76:79]
	v_mfma_f32_16x16x32_bf16 v[80:83], v[128:131], v[252:255], v[80:83]
	ds_read_b64_tr_b16 v[152:153], v21 offset:16384
	ds_read_b64_tr_b16 v[154:155], v21 offset:18432
	v_mfma_f32_16x16x32_bf16 v[84:87], v[132:135], v[236:239], v[84:87]
	s_add_u32 m0, s74, 65536
	s_nop 0
	buffer_load_dwordx4 v8, s[52:55], 0 offen lds
	v_add_u32 v8, 110592, v8
	v_mfma_f32_16x16x32_bf16 v[88:91], v[132:135], v[240:243], v[88:91]
	buffer_load_dwordx4 v9, s[52:55], 0 offen offset:1024 lds
	v_add_u32 v9, 110592, v9
	v_mfma_f32_16x16x32_bf16 v[92:95], v[132:135], v[244:247], v[92:95]
	v_mfma_f32_16x16x32_bf16 v[96:99], v[132:135], v[248:251], v[96:99]
	buffer_load_dwordx4 v[216:219], v12, s[40:43], s82 offen sc1
	v_mfma_f32_16x16x32_bf16 v[100:103], v[132:135], v[252:255], v[100:103]
	buffer_load_dwordx4 v[220:223], v12, s[40:43], s82 offen offset:1024 sc1
	v_mfma_f32_16x16x32_bf16 v[104:107], v[136:139], v[236:239], v[104:107]
	buffer_load_dwordx4 v[224:227], v12, s[40:43], s82 offen offset:2048 sc1
	v_mfma_f32_16x16x32_bf16 v[108:111], v[136:139], v[240:243], v[108:111]
	v_mfma_f32_16x16x32_bf16 v[112:115], v[136:139], v[244:247], v[112:115]
	buffer_load_dwordx4 v[228:231], v12, s[40:43], s82 offen offset:3072 sc1
	v_mfma_f32_16x16x32_bf16 v[116:119], v[136:139], v[248:251], v[116:119]
	buffer_load_dwordx4 v[232:235], v13, s[40:43], s82 offen sc1
	s_add_u32 s82, s82, 5120
	v_mfma_f32_16x16x32_bf16 v[120:123], v[136:139], v[252:255], v[120:123]
	v_mfma_f32_16x16x32_bf16 v[44:47], v[124:127], v[236:239], v[44:47]
	v_mfma_f32_16x16x32_bf16 v[48:51], v[124:127], v[240:243], v[48:51]
	v_mfma_f32_16x16x32_bf16 v[52:55], v[124:127], v[244:247], v[52:55]
	v_mfma_f32_16x16x32_bf16 v[56:59], v[124:127], v[248:251], v[56:59]
	v_mfma_f32_16x16x32_bf16 v[60:63], v[124:127], v[252:255], v[60:63]
	s_waitcnt vmcnt(21) lgkmcnt(0)
	s_barrier
	v_mfma_f32_16x16x32_bf16 v[64:67], v[144:147], v[156:159], v[64:67]
	ds_read_b64_tr_b16 v[124:125], v18 offset:32768
	ds_read_b64_tr_b16 v[126:127], v18 offset:34816
	v_mfma_f32_16x16x32_bf16 v[68:71], v[144:147], v[160:163], v[68:71]
	ds_read_b64_tr_b16 v[128:129], v19 offset:32768
	ds_read_b64_tr_b16 v[130:131], v19 offset:34816
	v_mfma_f32_16x16x32_bf16 v[72:75], v[144:147], v[164:167], v[72:75]
	ds_read_b64_tr_b16 v[132:133], v20 offset:32768
	ds_read_b64_tr_b16 v[134:135], v20 offset:34816
	v_mfma_f32_16x16x32_bf16 v[76:79], v[144:147], v[168:171], v[76:79]
	v_mfma_f32_16x16x32_bf16 v[80:83], v[144:147], v[172:175], v[80:83]
	ds_read_b64_tr_b16 v[136:137], v21 offset:32768
	ds_read_b64_tr_b16 v[138:139], v21 offset:34816
	v_mfma_f32_16x16x32_bf16 v[84:87], v[148:151], v[156:159], v[84:87]
	s_add_u32 m0, s74, 81920
	s_nop 0
	buffer_load_dwordx4 v8, s[52:55], 0 offen lds
	v_add_u32 v8, 110592, v8
	v_mfma_f32_16x16x32_bf16 v[88:91], v[148:151], v[160:163], v[88:91]
	buffer_load_dwordx4 v9, s[52:55], 0 offen offset:1024 lds
	v_add_u32 v9, 110592, v9
	v_mfma_f32_16x16x32_bf16 v[92:95], v[148:151], v[164:167], v[92:95]
	v_mfma_f32_16x16x32_bf16 v[96:99], v[148:151], v[168:171], v[96:99]
	buffer_load_dwordx4 v[236:239], v12, s[40:43], s82 offen sc1
	v_mfma_f32_16x16x32_bf16 v[100:103], v[148:151], v[172:175], v[100:103]
	buffer_load_dwordx4 v[240:243], v12, s[40:43], s82 offen offset:1024 sc1
	v_mfma_f32_16x16x32_bf16 v[104:107], v[152:155], v[156:159], v[104:107]
	buffer_load_dwordx4 v[244:247], v12, s[40:43], s82 offen offset:2048 sc1
	v_mfma_f32_16x16x32_bf16 v[108:111], v[152:155], v[160:163], v[108:111]
	v_mfma_f32_16x16x32_bf16 v[112:115], v[152:155], v[164:167], v[112:115]
	buffer_load_dwordx4 v[248:251], v12, s[40:43], s82 offen offset:3072 sc1
	v_mfma_f32_16x16x32_bf16 v[116:119], v[152:155], v[168:171], v[116:119]
	buffer_load_dwordx4 v[252:255], v13, s[40:43], s82 offen sc1
	s_add_u32 s82, s82, 5120
	v_mfma_f32_16x16x32_bf16 v[120:123], v[152:155], v[172:175], v[120:123]
	v_mfma_f32_16x16x32_bf16 v[44:47], v[140:143], v[156:159], v[44:47]
	v_mfma_f32_16x16x32_bf16 v[48:51], v[140:143], v[160:163], v[48:51]
	v_mfma_f32_16x16x32_bf16 v[52:55], v[140:143], v[164:167], v[52:55]
	v_mfma_f32_16x16x32_bf16 v[56:59], v[140:143], v[168:171], v[56:59]
	v_mfma_f32_16x16x32_bf16 v[60:63], v[140:143], v[172:175], v[60:63]
	s_waitcnt vmcnt(21) lgkmcnt(0)
	v_mfma_f32_16x16x32_bf16 v[64:67], v[128:131], v[176:179], v[64:67]
	ds_read_b64_tr_b16 v[140:141], v18 offset:49152
	ds_read_b64_tr_b16 v[142:143], v18 offset:51200
	v_mfma_f32_16x16x32_bf16 v[68:71], v[128:131], v[180:183], v[68:71]
	ds_read_b64_tr_b16 v[144:145], v19 offset:49152
	ds_read_b64_tr_b16 v[146:147], v19 offset:51200
	v_mfma_f32_16x16x32_bf16 v[72:75], v[128:131], v[184:187], v[72:75]
	ds_read_b64_tr_b16 v[148:149], v20 offset:49152
	ds_read_b64_tr_b16 v[150:151], v20 offset:51200
	v_mfma_f32_16x16x32_bf16 v[76:79], v[128:131], v[188:191], v[76:79]
	v_mfma_f32_16x16x32_bf16 v[80:83], v[128:131], v[192:195], v[80:83]
	ds_read_b64_tr_b16 v[152:153], v21 offset:49152
	ds_read_b64_tr_b16 v[154:155], v21 offset:51200
	v_mfma_f32_16x16x32_bf16 v[84:87], v[132:135], v[176:179], v[84:87]
	buffer_load_dwordx4 v[156:159], v12, s[40:43], s82 offen sc1
	v_mfma_f32_16x16x32_bf16 v[88:91], v[132:135], v[180:183], v[88:91]
	buffer_load_dwordx4 v[160:163], v12, s[40:43], s82 offen offset:1024 sc1
	v_mfma_f32_16x16x32_bf16 v[92:95], v[132:135], v[184:187], v[92:95]
	v_mfma_f32_16x16x32_bf16 v[96:99], v[132:135], v[188:191], v[96:99]
	buffer_load_dwordx4 v[164:167], v12, s[40:43], s82 offen offset:2048 sc1
	v_mfma_f32_16x16x32_bf16 v[100:103], v[132:135], v[192:195], v[100:103]
	buffer_load_dwordx4 v[168:171], v12, s[40:43], s82 offen offset:3072 sc1
	v_mfma_f32_16x16x32_bf16 v[104:107], v[136:139], v[176:179], v[104:107]
	buffer_load_dwordx4 v[172:175], v13, s[40:43], s82 offen sc1
	s_add_u32 s82, s82, 5120
	v_mfma_f32_16x16x32_bf16 v[108:111], v[136:139], v[180:183], v[108:111]
	v_mfma_f32_16x16x32_bf16 v[112:115], v[136:139], v[184:187], v[112:115]
	v_mfma_f32_16x16x32_bf16 v[116:119], v[136:139], v[188:191], v[116:119]
	v_mfma_f32_16x16x32_bf16 v[120:123], v[136:139], v[192:195], v[120:123]
	v_mfma_f32_16x16x32_bf16 v[44:47], v[124:127], v[176:179], v[44:47]
	v_mfma_f32_16x16x32_bf16 v[48:51], v[124:127], v[180:183], v[48:51]
	v_mfma_f32_16x16x32_bf16 v[52:55], v[124:127], v[184:187], v[52:55]
	v_mfma_f32_16x16x32_bf16 v[56:59], v[124:127], v[188:191], v[56:59]
	v_mfma_f32_16x16x32_bf16 v[60:63], v[124:127], v[192:195], v[60:63]
	s_waitcnt vmcnt(19) lgkmcnt(0)
	v_mfma_f32_16x16x32_bf16 v[64:67], v[144:147], v[196:199], v[64:67]
	v_add_u32 v18, 131072, v14
	ds_read_b64_tr_b16 v[124:125], v18 offset:0
	ds_read_b64_tr_b16 v[126:127], v18 offset:2048
	v_mfma_f32_16x16x32_bf16 v[68:71], v[144:147], v[200:203], v[68:71]
	v_add_u32 v19, 131072, v15
	ds_read_b64_tr_b16 v[128:129], v19 offset:0
	ds_read_b64_tr_b16 v[130:131], v19 offset:2048
	v_mfma_f32_16x16x32_bf16 v[72:75], v[144:147], v[204:207], v[72:75]
	v_add_u32 v20, 131072, v16
	ds_read_b64_tr_b16 v[132:133], v20 offset:0
	ds_read_b64_tr_b16 v[134:135], v20 offset:2048
	v_mfma_f32_16x16x32_bf16 v[76:79], v[144:147], v[208:211], v[76:79]
	v_mfma_f32_16x16x32_bf16 v[80:83], v[144:147], v[212:215], v[80:83]
	v_add_u32 v21, 131072, v17
	ds_read_b64_tr_b16 v[136:137], v21 offset:0
	ds_read_b64_tr_b16 v[138:139], v21 offset:2048
	v_mfma_f32_16x16x32_bf16 v[84:87], v[148:151], v[196:199], v[84:87]
	buffer_load_dwordx4 v[176:179], v12, s[40:43], s82 offen sc1
	v_mfma_f32_16x16x32_bf16 v[88:91], v[148:151], v[200:203], v[88:91]
	buffer_load_dwordx4 v[180:183], v12, s[40:43], s82 offen offset:1024 sc1
	v_mfma_f32_16x16x32_bf16 v[92:95], v[148:151], v[204:207], v[92:95]
	v_mfma_f32_16x16x32_bf16 v[96:99], v[148:151], v[208:211], v[96:99]
	buffer_load_dwordx4 v[184:187], v12, s[40:43], s82 offen offset:2048 sc1
	v_mfma_f32_16x16x32_bf16 v[100:103], v[148:151], v[212:215], v[100:103]
	buffer_load_dwordx4 v[188:191], v12, s[40:43], s82 offen offset:3072 sc1
	v_mfma_f32_16x16x32_bf16 v[104:107], v[152:155], v[196:199], v[104:107]
	buffer_load_dwordx4 v[192:195], v13, s[40:43], s82 offen sc1
	s_add_u32 s82, s82, 5120
	v_mfma_f32_16x16x32_bf16 v[108:111], v[152:155], v[200:203], v[108:111]
	v_mfma_f32_16x16x32_bf16 v[112:115], v[152:155], v[204:207], v[112:115]
	v_mfma_f32_16x16x32_bf16 v[116:119], v[152:155], v[208:211], v[116:119]
	v_mfma_f32_16x16x32_bf16 v[120:123], v[152:155], v[212:215], v[120:123]
	v_mfma_f32_16x16x32_bf16 v[44:47], v[140:143], v[196:199], v[44:47]
	v_mfma_f32_16x16x32_bf16 v[48:51], v[140:143], v[200:203], v[48:51]
	v_mfma_f32_16x16x32_bf16 v[52:55], v[140:143], v[204:207], v[52:55]
	v_mfma_f32_16x16x32_bf16 v[56:59], v[140:143], v[208:211], v[56:59]
	v_mfma_f32_16x16x32_bf16 v[60:63], v[140:143], v[212:215], v[60:63]
	s_waitcnt vmcnt(17) lgkmcnt(0)
	v_mfma_f32_16x16x32_bf16 v[64:67], v[128:131], v[216:219], v[64:67]
	ds_read_b64_tr_b16 v[140:141], v18 offset:16384
	ds_read_b64_tr_b16 v[142:143], v18 offset:18432
	v_mfma_f32_16x16x32_bf16 v[68:71], v[128:131], v[220:223], v[68:71]
	ds_read_b64_tr_b16 v[144:145], v19 offset:16384
	ds_read_b64_tr_b16 v[146:147], v19 offset:18432
	v_mfma_f32_16x16x32_bf16 v[72:75], v[128:131], v[224:227], v[72:75]
	ds_read_b64_tr_b16 v[148:149], v20 offset:16384
	ds_read_b64_tr_b16 v[150:151], v20 offset:18432
	v_mfma_f32_16x16x32_bf16 v[76:79], v[128:131], v[228:231], v[76:79]
	v_mfma_f32_16x16x32_bf16 v[80:83], v[128:131], v[232:235], v[80:83]
	ds_read_b64_tr_b16 v[152:153], v21 offset:16384
	ds_read_b64_tr_b16 v[154:155], v21 offset:18432
	v_mfma_f32_16x16x32_bf16 v[84:87], v[132:135], v[216:219], v[84:87]
	buffer_load_dwordx4 v[196:199], v12, s[40:43], s82 offen sc1
	v_mfma_f32_16x16x32_bf16 v[88:91], v[132:135], v[220:223], v[88:91]
	buffer_load_dwordx4 v[200:203], v12, s[40:43], s82 offen offset:1024 sc1
	v_mfma_f32_16x16x32_bf16 v[92:95], v[132:135], v[224:227], v[92:95]
	v_mfma_f32_16x16x32_bf16 v[96:99], v[132:135], v[228:231], v[96:99]
	buffer_load_dwordx4 v[204:207], v12, s[40:43], s82 offen offset:2048 sc1
	v_mfma_f32_16x16x32_bf16 v[100:103], v[132:135], v[232:235], v[100:103]
	buffer_load_dwordx4 v[208:211], v12, s[40:43], s82 offen offset:3072 sc1
	v_mfma_f32_16x16x32_bf16 v[104:107], v[136:139], v[216:219], v[104:107]
	buffer_load_dwordx4 v[212:215], v13, s[40:43], s82 offen sc1
	s_add_u32 s82, s82, 5120
	v_mfma_f32_16x16x32_bf16 v[108:111], v[136:139], v[220:223], v[108:111]
	v_mfma_f32_16x16x32_bf16 v[112:115], v[136:139], v[224:227], v[112:115]
	v_mfma_f32_16x16x32_bf16 v[116:119], v[136:139], v[228:231], v[116:119]
	v_mfma_f32_16x16x32_bf16 v[120:123], v[136:139], v[232:235], v[120:123]
	v_mfma_f32_16x16x32_bf16 v[44:47], v[124:127], v[216:219], v[44:47]
	v_mfma_f32_16x16x32_bf16 v[48:51], v[124:127], v[220:223], v[48:51]
	v_mfma_f32_16x16x32_bf16 v[52:55], v[124:127], v[224:227], v[52:55]
	v_mfma_f32_16x16x32_bf16 v[56:59], v[124:127], v[228:231], v[56:59]
	v_mfma_f32_16x16x32_bf16 v[60:63], v[124:127], v[232:235], v[60:63]
	s_waitcnt vmcnt(15) lgkmcnt(0)
	s_barrier
	v_mfma_f32_16x16x32_bf16 v[64:67], v[144:147], v[236:239], v[64:67]
	ds_read_b64_tr_b16 v[124:125], v14 offset:0
	ds_read_b64_tr_b16 v[126:127], v14 offset:2048
	v_mfma_f32_16x16x32_bf16 v[68:71], v[144:147], v[240:243], v[68:71]
	ds_read_b64_tr_b16 v[128:129], v15 offset:0
	ds_read_b64_tr_b16 v[130:131], v15 offset:2048
	v_mfma_f32_16x16x32_bf16 v[72:75], v[144:147], v[244:247], v[72:75]
	ds_read_b64_tr_b16 v[132:133], v16 offset:0
	ds_read_b64_tr_b16 v[134:135], v16 offset:2048
	v_mfma_f32_16x16x32_bf16 v[76:79], v[144:147], v[248:251], v[76:79]
	v_mfma_f32_16x16x32_bf16 v[80:83], v[144:147], v[252:255], v[80:83]
	ds_read_b64_tr_b16 v[136:137], v17 offset:0
	ds_read_b64_tr_b16 v[138:139], v17 offset:2048
	v_mfma_f32_16x16x32_bf16 v[84:87], v[148:151], v[236:239], v[84:87]
	buffer_load_dwordx4 v[216:219], v12, s[40:43], s82 offen sc1
	v_mfma_f32_16x16x32_bf16 v[88:91], v[148:151], v[240:243], v[88:91]
	buffer_load_dwordx4 v[220:223], v12, s[40:43], s82 offen offset:1024 sc1
	v_mfma_f32_16x16x32_bf16 v[92:95], v[148:151], v[244:247], v[92:95]
	v_mfma_f32_16x16x32_bf16 v[96:99], v[148:151], v[248:251], v[96:99]
	buffer_load_dwordx4 v[224:227], v12, s[40:43], s82 offen offset:2048 sc1
	v_mfma_f32_16x16x32_bf16 v[100:103], v[148:151], v[252:255], v[100:103]
	buffer_load_dwordx4 v[228:231], v12, s[40:43], s82 offen offset:3072 sc1
	v_mfma_f32_16x16x32_bf16 v[104:107], v[152:155], v[236:239], v[104:107]
	buffer_load_dwordx4 v[232:235], v13, s[40:43], s82 offen sc1
	s_add_u32 s82, s82, 5120
	v_mfma_f32_16x16x32_bf16 v[108:111], v[152:155], v[240:243], v[108:111]
	v_mfma_f32_16x16x32_bf16 v[112:115], v[152:155], v[244:247], v[112:115]
	v_mfma_f32_16x16x32_bf16 v[116:119], v[152:155], v[248:251], v[116:119]
	v_mfma_f32_16x16x32_bf16 v[120:123], v[152:155], v[252:255], v[120:123]
	v_mfma_f32_16x16x32_bf16 v[44:47], v[140:143], v[236:239], v[44:47]
	v_mfma_f32_16x16x32_bf16 v[48:51], v[140:143], v[240:243], v[48:51]
	v_mfma_f32_16x16x32_bf16 v[52:55], v[140:143], v[244:247], v[52:55]
	v_mfma_f32_16x16x32_bf16 v[56:59], v[140:143], v[248:251], v[56:59]
	v_mfma_f32_16x16x32_bf16 v[60:63], v[140:143], v[252:255], v[60:63]
	s_waitcnt vmcnt(15) lgkmcnt(0)
	s_barrier
	v_mfma_f32_16x16x32_bf16 v[64:67], v[128:131], v[156:159], v[64:67]
	ds_read_b64_tr_b16 v[140:141], v14 offset:16384
	ds_read_b64_tr_b16 v[142:143], v14 offset:18432
	v_mfma_f32_16x16x32_bf16 v[68:71], v[128:131], v[160:163], v[68:71]
	ds_read_b64_tr_b16 v[144:145], v15 offset:16384
	ds_read_b64_tr_b16 v[146:147], v15 offset:18432
	v_mfma_f32_16x16x32_bf16 v[72:75], v[128:131], v[164:167], v[72:75]
	ds_read_b64_tr_b16 v[148:149], v16 offset:16384
	ds_read_b64_tr_b16 v[150:151], v16 offset:18432
	v_mfma_f32_16x16x32_bf16 v[76:79], v[128:131], v[168:171], v[76:79]
	v_mfma_f32_16x16x32_bf16 v[80:83], v[128:131], v[172:175], v[80:83]
	ds_read_b64_tr_b16 v[152:153], v17 offset:16384
	ds_read_b64_tr_b16 v[154:155], v17 offset:18432
	v_mfma_f32_16x16x32_bf16 v[84:87], v[132:135], v[156:159], v[84:87]
	buffer_load_dwordx4 v[236:239], v12, s[40:43], s82 offen sc1
	v_mfma_f32_16x16x32_bf16 v[88:91], v[132:135], v[160:163], v[88:91]
	buffer_load_dwordx4 v[240:243], v12, s[40:43], s82 offen offset:1024 sc1
	v_mfma_f32_16x16x32_bf16 v[92:95], v[132:135], v[164:167], v[92:95]
	v_mfma_f32_16x16x32_bf16 v[96:99], v[132:135], v[168:171], v[96:99]
	buffer_load_dwordx4 v[244:247], v12, s[40:43], s82 offen offset:2048 sc1
	v_mfma_f32_16x16x32_bf16 v[100:103], v[132:135], v[172:175], v[100:103]
	buffer_load_dwordx4 v[248:251], v12, s[40:43], s82 offen offset:3072 sc1
	v_mfma_f32_16x16x32_bf16 v[104:107], v[136:139], v[156:159], v[104:107]
	buffer_load_dwordx4 v[252:255], v13, s[40:43], s82 offen sc1
	s_add_u32 s82, s82, 5120
	v_mfma_f32_16x16x32_bf16 v[108:111], v[136:139], v[160:163], v[108:111]
	v_mfma_f32_16x16x32_bf16 v[112:115], v[136:139], v[164:167], v[112:115]
	v_mfma_f32_16x16x32_bf16 v[116:119], v[136:139], v[168:171], v[116:119]
	v_mfma_f32_16x16x32_bf16 v[120:123], v[136:139], v[172:175], v[120:123]
	v_mfma_f32_16x16x32_bf16 v[44:47], v[124:127], v[156:159], v[44:47]
	v_mfma_f32_16x16x32_bf16 v[48:51], v[124:127], v[160:163], v[48:51]
	v_mfma_f32_16x16x32_bf16 v[52:55], v[124:127], v[164:167], v[52:55]
	v_mfma_f32_16x16x32_bf16 v[56:59], v[124:127], v[168:171], v[56:59]
	v_mfma_f32_16x16x32_bf16 v[60:63], v[124:127], v[172:175], v[60:63]
	s_waitcnt vmcnt(15) lgkmcnt(0)
	s_barrier
	v_mfma_f32_16x16x32_bf16 v[64:67], v[144:147], v[176:179], v[64:67]
	ds_read_b64_tr_b16 v[124:125], v14 offset:32768
	ds_read_b64_tr_b16 v[126:127], v14 offset:34816
	v_mfma_f32_16x16x32_bf16 v[68:71], v[144:147], v[180:183], v[68:71]
	ds_read_b64_tr_b16 v[128:129], v15 offset:32768
	ds_read_b64_tr_b16 v[130:131], v15 offset:34816
	v_mfma_f32_16x16x32_bf16 v[72:75], v[144:147], v[184:187], v[72:75]
	ds_read_b64_tr_b16 v[132:133], v16 offset:32768
	ds_read_b64_tr_b16 v[134:135], v16 offset:34816
	v_mfma_f32_16x16x32_bf16 v[76:79], v[144:147], v[188:191], v[76:79]
	v_mfma_f32_16x16x32_bf16 v[80:83], v[144:147], v[192:195], v[80:83]
	ds_read_b64_tr_b16 v[136:137], v17 offset:32768
	ds_read_b64_tr_b16 v[138:139], v17 offset:34816
	v_mfma_f32_16x16x32_bf16 v[84:87], v[148:151], v[176:179], v[84:87]
	buffer_load_dwordx4 v[156:159], v12, s[40:43], s82 offen sc1
	v_mfma_f32_16x16x32_bf16 v[88:91], v[148:151], v[180:183], v[88:91]
	buffer_load_dwordx4 v[160:163], v12, s[40:43], s82 offen offset:1024 sc1
	v_mfma_f32_16x16x32_bf16 v[92:95], v[148:151], v[184:187], v[92:95]
	v_mfma_f32_16x16x32_bf16 v[96:99], v[148:151], v[188:191], v[96:99]
	buffer_load_dwordx4 v[164:167], v12, s[40:43], s82 offen offset:2048 sc1
	v_mfma_f32_16x16x32_bf16 v[100:103], v[148:151], v[192:195], v[100:103]
	buffer_load_dwordx4 v[168:171], v12, s[40:43], s82 offen offset:3072 sc1
	v_mfma_f32_16x16x32_bf16 v[104:107], v[152:155], v[176:179], v[104:107]
	buffer_load_dwordx4 v[172:175], v13, s[40:43], s82 offen sc1
	s_add_u32 s82, s82, 5120
	v_mfma_f32_16x16x32_bf16 v[108:111], v[152:155], v[180:183], v[108:111]
	v_mfma_f32_16x16x32_bf16 v[112:115], v[152:155], v[184:187], v[112:115]
	v_mfma_f32_16x16x32_bf16 v[116:119], v[152:155], v[188:191], v[116:119]
	v_mfma_f32_16x16x32_bf16 v[120:123], v[152:155], v[192:195], v[120:123]
	v_mfma_f32_16x16x32_bf16 v[44:47], v[140:143], v[176:179], v[44:47]
	v_mfma_f32_16x16x32_bf16 v[48:51], v[140:143], v[180:183], v[48:51]
	v_mfma_f32_16x16x32_bf16 v[52:55], v[140:143], v[184:187], v[52:55]
	v_mfma_f32_16x16x32_bf16 v[56:59], v[140:143], v[188:191], v[56:59]
	v_mfma_f32_16x16x32_bf16 v[60:63], v[140:143], v[192:195], v[60:63]
	s_waitcnt vmcnt(15) lgkmcnt(0)
	s_barrier
	v_mfma_f32_16x16x32_bf16 v[64:67], v[128:131], v[196:199], v[64:67]
	ds_read_b64_tr_b16 v[140:141], v14 offset:49152
	ds_read_b64_tr_b16 v[142:143], v14 offset:51200
	v_mfma_f32_16x16x32_bf16 v[68:71], v[128:131], v[200:203], v[68:71]
	ds_read_b64_tr_b16 v[144:145], v15 offset:49152
	ds_read_b64_tr_b16 v[146:147], v15 offset:51200
	v_mfma_f32_16x16x32_bf16 v[72:75], v[128:131], v[204:207], v[72:75]
	ds_read_b64_tr_b16 v[148:149], v16 offset:49152
	ds_read_b64_tr_b16 v[150:151], v16 offset:51200
	v_mfma_f32_16x16x32_bf16 v[76:79], v[128:131], v[208:211], v[76:79]
	v_mfma_f32_16x16x32_bf16 v[80:83], v[128:131], v[212:215], v[80:83]
	ds_read_b64_tr_b16 v[152:153], v17 offset:49152
	ds_read_b64_tr_b16 v[154:155], v17 offset:51200
	v_mfma_f32_16x16x32_bf16 v[84:87], v[132:135], v[196:199], v[84:87]
	v_mfma_f32_16x16x32_bf16 v[88:91], v[132:135], v[200:203], v[88:91]
	v_mfma_f32_16x16x32_bf16 v[92:95], v[132:135], v[204:207], v[92:95]
	v_mfma_f32_16x16x32_bf16 v[96:99], v[132:135], v[208:211], v[96:99]
	v_mfma_f32_16x16x32_bf16 v[100:103], v[132:135], v[212:215], v[100:103]
	v_mfma_f32_16x16x32_bf16 v[104:107], v[136:139], v[196:199], v[104:107]
	v_mfma_f32_16x16x32_bf16 v[108:111], v[136:139], v[200:203], v[108:111]
	v_mfma_f32_16x16x32_bf16 v[112:115], v[136:139], v[204:207], v[112:115]
	v_mfma_f32_16x16x32_bf16 v[116:119], v[136:139], v[208:211], v[116:119]
	v_mfma_f32_16x16x32_bf16 v[120:123], v[136:139], v[212:215], v[120:123]
	v_mfma_f32_16x16x32_bf16 v[44:47], v[124:127], v[196:199], v[44:47]
	v_mfma_f32_16x16x32_bf16 v[48:51], v[124:127], v[200:203], v[48:51]
	v_mfma_f32_16x16x32_bf16 v[52:55], v[124:127], v[204:207], v[52:55]
	v_mfma_f32_16x16x32_bf16 v[56:59], v[124:127], v[208:211], v[56:59]
	v_mfma_f32_16x16x32_bf16 v[60:63], v[124:127], v[212:215], v[60:63]
	s_waitcnt vmcnt(10) lgkmcnt(0)
	s_barrier
	v_mfma_f32_16x16x32_bf16 v[64:67], v[144:147], v[216:219], v[64:67]
	v_add_u32 v18, 65536, v14
	ds_read_b64_tr_b16 v[124:125], v18 offset:0
	ds_read_b64_tr_b16 v[126:127], v18 offset:2048
	v_mfma_f32_16x16x32_bf16 v[68:71], v[144:147], v[220:223], v[68:71]
	v_add_u32 v19, 65536, v15
	ds_read_b64_tr_b16 v[128:129], v19 offset:0
	ds_read_b64_tr_b16 v[130:131], v19 offset:2048
	v_mfma_f32_16x16x32_bf16 v[72:75], v[144:147], v[224:227], v[72:75]
	v_add_u32 v20, 65536, v16
	ds_read_b64_tr_b16 v[132:133], v20 offset:0
	ds_read_b64_tr_b16 v[134:135], v20 offset:2048
	v_mfma_f32_16x16x32_bf16 v[76:79], v[144:147], v[228:231], v[76:79]
	v_mfma_f32_16x16x32_bf16 v[80:83], v[144:147], v[232:235], v[80:83]
	v_add_u32 v21, 65536, v17
	ds_read_b64_tr_b16 v[136:137], v21 offset:0
	ds_read_b64_tr_b16 v[138:139], v21 offset:2048
	v_mfma_f32_16x16x32_bf16 v[84:87], v[148:151], v[216:219], v[84:87]
	v_mfma_f32_16x16x32_bf16 v[88:91], v[148:151], v[220:223], v[88:91]
	v_mfma_f32_16x16x32_bf16 v[92:95], v[148:151], v[224:227], v[92:95]
	v_mfma_f32_16x16x32_bf16 v[96:99], v[148:151], v[228:231], v[96:99]
	v_mfma_f32_16x16x32_bf16 v[100:103], v[148:151], v[232:235], v[100:103]
	v_mfma_f32_16x16x32_bf16 v[104:107], v[152:155], v[216:219], v[104:107]
	v_mfma_f32_16x16x32_bf16 v[108:111], v[152:155], v[220:223], v[108:111]
	v_mfma_f32_16x16x32_bf16 v[112:115], v[152:155], v[224:227], v[112:115]
	v_mfma_f32_16x16x32_bf16 v[116:119], v[152:155], v[228:231], v[116:119]
	v_mfma_f32_16x16x32_bf16 v[120:123], v[152:155], v[232:235], v[120:123]
	v_mfma_f32_16x16x32_bf16 v[44:47], v[140:143], v[216:219], v[44:47]
	v_mfma_f32_16x16x32_bf16 v[48:51], v[140:143], v[220:223], v[48:51]
	v_mfma_f32_16x16x32_bf16 v[52:55], v[140:143], v[224:227], v[52:55]
	v_mfma_f32_16x16x32_bf16 v[56:59], v[140:143], v[228:231], v[56:59]
	v_mfma_f32_16x16x32_bf16 v[60:63], v[140:143], v[232:235], v[60:63]
	s_waitcnt vmcnt(5) lgkmcnt(0)
	s_barrier
	v_mfma_f32_16x16x32_bf16 v[64:67], v[128:131], v[236:239], v[64:67]
	ds_read_b64_tr_b16 v[140:141], v18 offset:16384
	ds_read_b64_tr_b16 v[142:143], v18 offset:18432
	v_mfma_f32_16x16x32_bf16 v[68:71], v[128:131], v[240:243], v[68:71]
	ds_read_b64_tr_b16 v[144:145], v19 offset:16384
	ds_read_b64_tr_b16 v[146:147], v19 offset:18432
	v_mfma_f32_16x16x32_bf16 v[72:75], v[128:131], v[244:247], v[72:75]
	ds_read_b64_tr_b16 v[148:149], v20 offset:16384
	ds_read_b64_tr_b16 v[150:151], v20 offset:18432
	v_mfma_f32_16x16x32_bf16 v[76:79], v[128:131], v[248:251], v[76:79]
	v_mfma_f32_16x16x32_bf16 v[80:83], v[128:131], v[252:255], v[80:83]
	ds_read_b64_tr_b16 v[152:153], v21 offset:16384
	ds_read_b64_tr_b16 v[154:155], v21 offset:18432
	v_mfma_f32_16x16x32_bf16 v[84:87], v[132:135], v[236:239], v[84:87]
	v_mfma_f32_16x16x32_bf16 v[88:91], v[132:135], v[240:243], v[88:91]
	v_mfma_f32_16x16x32_bf16 v[92:95], v[132:135], v[244:247], v[92:95]
	v_mfma_f32_16x16x32_bf16 v[96:99], v[132:135], v[248:251], v[96:99]
	v_mfma_f32_16x16x32_bf16 v[100:103], v[132:135], v[252:255], v[100:103]
	v_mfma_f32_16x16x32_bf16 v[104:107], v[136:139], v[236:239], v[104:107]
	v_mfma_f32_16x16x32_bf16 v[108:111], v[136:139], v[240:243], v[108:111]
	v_mfma_f32_16x16x32_bf16 v[112:115], v[136:139], v[244:247], v[112:115]
	v_mfma_f32_16x16x32_bf16 v[116:119], v[136:139], v[248:251], v[116:119]
	v_mfma_f32_16x16x32_bf16 v[120:123], v[136:139], v[252:255], v[120:123]
	v_mfma_f32_16x16x32_bf16 v[44:47], v[124:127], v[236:239], v[44:47]
	v_mfma_f32_16x16x32_bf16 v[48:51], v[124:127], v[240:243], v[48:51]
	v_mfma_f32_16x16x32_bf16 v[52:55], v[124:127], v[244:247], v[52:55]
	v_mfma_f32_16x16x32_bf16 v[56:59], v[124:127], v[248:251], v[56:59]
	v_mfma_f32_16x16x32_bf16 v[60:63], v[124:127], v[252:255], v[60:63]
	s_waitcnt vmcnt(0) lgkmcnt(0)
	s_mul_i32 s7, s91, 102400
	s_xor_b32 s4, s3, 1
	s_mul_i32 s4, s4, 15360
	s_add_u32 s4, s4, 0
	s_add_u32 s4, s4, s7
	v_add_u32 v25, s4, v12
	s_xor_b32 s4, s3, 2
	s_mul_i32 s4, s4, 15360
	s_add_u32 s4, s4, 5120
	s_add_u32 s4, s4, s7
	v_add_u32 v26, s4, v12
	s_xor_b32 s4, s3, 3
	s_mul_i32 s4, s4, 15360
	s_add_u32 s4, s4, 10240
	s_add_u32 s4, s4, s7
	v_add_u32 v27, s4, v12
	v_mfma_f32_16x16x32_bf16 v[64:67], v[144:147], v[156:159], v[64:67]
	v_mfma_f32_16x16x32_bf16 v[68:71], v[144:147], v[160:163], v[68:71]
	v_mfma_f32_16x16x32_bf16 v[72:75], v[144:147], v[164:167], v[72:75]
	v_mfma_f32_16x16x32_bf16 v[76:79], v[144:147], v[168:171], v[76:79]
	v_mfma_f32_16x16x32_bf16 v[80:83], v[144:147], v[172:175], v[80:83]
	v_mfma_f32_16x16x32_bf16 v[84:87], v[148:151], v[156:159], v[84:87]
	s_nop 2
	ds_write_b128 v25, v[64:67] offset:0
	v_mfma_f32_16x16x32_bf16 v[88:91], v[148:151], v[160:163], v[88:91]
	ds_write_b128 v25, v[68:71] offset:1024
	v_mfma_f32_16x16x32_bf16 v[92:95], v[148:151], v[164:167], v[92:95]
	ds_write_b128 v25, v[72:75] offset:2048
	v_mfma_f32_16x16x32_bf16 v[96:99], v[148:151], v[168:171], v[96:99]
	ds_write_b128 v25, v[76:79] offset:3072
	v_mfma_f32_16x16x32_bf16 v[100:103], v[148:151], v[172:175], v[100:103]
	ds_write_b128 v25, v[80:83] offset:4096
	v_mfma_f32_16x16x32_bf16 v[104:107], v[152:155], v[156:159], v[104:107]
	ds_write_b128 v26, v[84:87] offset:0
	v_mfma_f32_16x16x32_bf16 v[108:111], v[152:155], v[160:163], v[108:111]
	ds_write_b128 v26, v[88:91] offset:1024
	v_mfma_f32_16x16x32_bf16 v[112:115], v[152:155], v[164:167], v[112:115]
	ds_write_b128 v26, v[92:95] offset:2048
	v_mfma_f32_16x16x32_bf16 v[116:119], v[152:155], v[168:171], v[116:119]
	ds_write_b128 v26, v[96:99] offset:3072
	v_mfma_f32_16x16x32_bf16 v[120:123], v[152:155], v[172:175], v[120:123]
	ds_write_b128 v26, v[100:103] offset:4096
	v_mfma_f32_16x16x32_bf16 v[44:47], v[140:143], v[156:159], v[44:47]
	ds_write_b128 v27, v[104:107] offset:0
	v_mfma_f32_16x16x32_bf16 v[48:51], v[140:143], v[160:163], v[48:51]
	ds_write_b128 v27, v[108:111] offset:1024
	v_mfma_f32_16x16x32_bf16 v[52:55], v[140:143], v[164:167], v[52:55]
	ds_write_b128 v27, v[112:115] offset:2048
	v_mfma_f32_16x16x32_bf16 v[56:59], v[140:143], v[168:171], v[56:59]
	ds_write_b128 v27, v[116:119] offset:3072
	v_mfma_f32_16x16x32_bf16 v[60:63], v[140:143], v[172:175], v[60:63]
	ds_write_b128 v27, v[120:123] offset:4096
	s_mul_i32 s4, s3, 15360
	s_add_u32 s4, s4, s7
	v_add_u32 v24, s4, v12
	s_waitcnt lgkmcnt(0)
	s_barrier
	ds_read_b128 v[64:67], v24 offset:0
	ds_read_b128 v[68:71], v24 offset:1024
	ds_read_b128 v[72:75], v24 offset:2048
	ds_read_b128 v[76:79], v24 offset:3072
	ds_read_b128 v[80:83], v24 offset:4096
	ds_read_b128 v[84:87], v24 offset:5120
	ds_read_b128 v[88:91], v24 offset:6144
	ds_read_b128 v[92:95], v24 offset:7168
	ds_read_b128 v[96:99], v24 offset:8192
	ds_read_b128 v[100:103], v24 offset:9216
	ds_read_b128 v[104:107], v24 offset:10240
	ds_read_b128 v[108:111], v24 offset:11264
	ds_read_b128 v[112:115], v24 offset:12288
	ds_read_b128 v[116:119], v24 offset:13312
	ds_read_b128 v[120:123], v24 offset:14336
	s_waitcnt lgkmcnt(14)
	v_pk_add_f32 v[44:45], v[44:45], v[64:65]
	v_pk_add_f32 v[46:47], v[46:47], v[66:67]
	s_waitcnt lgkmcnt(13)
	v_pk_add_f32 v[48:49], v[48:49], v[68:69]
	v_pk_add_f32 v[50:51], v[50:51], v[70:71]
	s_waitcnt lgkmcnt(12)
	v_pk_add_f32 v[52:53], v[52:53], v[72:73]
	v_pk_add_f32 v[54:55], v[54:55], v[74:75]
	s_waitcnt lgkmcnt(11)
	v_pk_add_f32 v[56:57], v[56:57], v[76:77]
	v_pk_add_f32 v[58:59], v[58:59], v[78:79]
	s_waitcnt lgkmcnt(10)
	v_pk_add_f32 v[60:61], v[60:61], v[80:81]
	v_pk_add_f32 v[62:63], v[62:63], v[82:83]
	s_waitcnt lgkmcnt(9)
	v_pk_add_f32 v[44:45], v[44:45], v[84:85]
	v_pk_add_f32 v[46:47], v[46:47], v[86:87]
	s_waitcnt lgkmcnt(8)
	v_pk_add_f32 v[48:49], v[48:49], v[88:89]
	v_pk_add_f32 v[50:51], v[50:51], v[90:91]
	s_waitcnt lgkmcnt(7)
	v_pk_add_f32 v[52:53], v[52:53], v[92:93]
	v_pk_add_f32 v[54:55], v[54:55], v[94:95]
	s_waitcnt lgkmcnt(6)
	v_pk_add_f32 v[56:57], v[56:57], v[96:97]
	v_pk_add_f32 v[58:59], v[58:59], v[98:99]
	s_waitcnt lgkmcnt(5)
	v_pk_add_f32 v[60:61], v[60:61], v[100:101]
	v_pk_add_f32 v[62:63], v[62:63], v[102:103]
	s_waitcnt lgkmcnt(4)
	v_pk_add_f32 v[44:45], v[44:45], v[104:105]
	v_pk_add_f32 v[46:47], v[46:47], v[106:107]
	s_waitcnt lgkmcnt(3)
	v_pk_add_f32 v[48:49], v[48:49], v[108:109]
	v_pk_add_f32 v[50:51], v[50:51], v[110:111]
	s_waitcnt lgkmcnt(2)
	v_pk_add_f32 v[52:53], v[52:53], v[112:113]
	v_pk_add_f32 v[54:55], v[54:55], v[114:115]
	s_waitcnt lgkmcnt(1)
	v_pk_add_f32 v[56:57], v[56:57], v[116:117]
	v_pk_add_f32 v[58:59], v[58:59], v[118:119]
	s_waitcnt lgkmcnt(0)
	v_pk_add_f32 v[60:61], v[60:61], v[120:121]
	v_pk_add_f32 v[62:63], v[62:63], v[122:123]
	v_lshlrev_b32 v34, 16, v38
	v_and_b32 v35, 0xffff0000, v38
	v_lshlrev_b32 v36, 16, v39
	v_and_b32 v37, 0xffff0000, v39
	s_mov_b32 s4, 0xbdd2d3e8
	s_mov_b32 s5, 0xbdd2d3e8
	v_mov_b32 v24, 0xc0135761
	v_mov_b32 v26, 1.0
	v_pk_mul_f32 v[64:65], v[44:45], v[44:45]
	v_pk_mul_f32 v[66:67], v[46:47], v[46:47]
	v_pk_mul_f32 v[68:69], v[48:49], v[48:49]
	v_pk_mul_f32 v[70:71], v[50:51], v[50:51]
	v_pk_mul_f32 v[72:73], v[52:53], v[52:53]
	v_pk_mul_f32 v[74:75], v[54:55], v[54:55]
	v_pk_mul_f32 v[76:77], v[56:57], v[56:57]
	v_pk_mul_f32 v[78:79], v[58:59], v[58:59]
	v_pk_mul_f32 v[80:81], v[60:61], v[60:61]
	v_pk_mul_f32 v[82:83], v[62:63], v[62:63]
	v_pk_fma_f32 v[64:65], v[64:65], s[4:5], v[24:25] op_sel_hi:[1,0,0]
	v_pk_fma_f32 v[66:67], v[66:67], s[4:5], v[24:25] op_sel_hi:[1,0,0]
	v_pk_fma_f32 v[68:69], v[68:69], s[4:5], v[24:25] op_sel_hi:[1,0,0]
	v_pk_fma_f32 v[70:71], v[70:71], s[4:5], v[24:25] op_sel_hi:[1,0,0]
	v_pk_fma_f32 v[72:73], v[72:73], s[4:5], v[24:25] op_sel_hi:[1,0,0]
	v_pk_fma_f32 v[74:75], v[74:75], s[4:5], v[24:25] op_sel_hi:[1,0,0]
	v_pk_fma_f32 v[76:77], v[76:77], s[4:5], v[24:25] op_sel_hi:[1,0,0]
	v_pk_fma_f32 v[78:79], v[78:79], s[4:5], v[24:25] op_sel_hi:[1,0,0]
	v_pk_fma_f32 v[80:81], v[80:81], s[4:5], v[24:25] op_sel_hi:[1,0,0]
	v_pk_fma_f32 v[82:83], v[82:83], s[4:5], v[24:25] op_sel_hi:[1,0,0]
	v_pk_mul_f32 v[64:65], v[64:65], v[44:45]
	v_pk_mul_f32 v[66:67], v[66:67], v[46:47]
	v_pk_mul_f32 v[68:69], v[68:69], v[48:49]
	v_pk_mul_f32 v[70:71], v[70:71], v[50:51]
	v_pk_mul_f32 v[72:73], v[72:73], v[52:53]
	v_pk_mul_f32 v[74:75], v[74:75], v[54:55]
	v_pk_mul_f32 v[76:77], v[76:77], v[56:57]
	v_pk_mul_f32 v[78:79], v[78:79], v[58:59]
	v_pk_mul_f32 v[80:81], v[80:81], v[60:61]
	v_pk_mul_f32 v[82:83], v[82:83], v[62:63]
	v_exp_f32 v64, v64
	v_exp_f32 v65, v65
	v_exp_f32 v66, v66
	v_exp_f32 v67, v67
	v_exp_f32 v68, v68
	v_exp_f32 v69, v69
	v_exp_f32 v70, v70
	v_exp_f32 v71, v71
	v_exp_f32 v72, v72
	v_exp_f32 v73, v73
	v_exp_f32 v74, v74
	v_exp_f32 v75, v75
	v_exp_f32 v76, v76
	v_exp_f32 v77, v77
	v_exp_f32 v78, v78
	v_exp_f32 v79, v79
	v_exp_f32 v80, v80
	v_exp_f32 v81, v81
	v_exp_f32 v82, v82
	v_exp_f32 v83, v83
	v_pk_add_f32 v[64:65], v[64:65], v[26:27] op_sel_hi:[1,0]
	v_pk_add_f32 v[66:67], v[66:67], v[26:27] op_sel_hi:[1,0]
	v_pk_add_f32 v[68:69], v[68:69], v[26:27] op_sel_hi:[1,0]
	v_pk_add_f32 v[70:71], v[70:71], v[26:27] op_sel_hi:[1,0]
	v_pk_add_f32 v[72:73], v[72:73], v[26:27] op_sel_hi:[1,0]
	v_pk_add_f32 v[74:75], v[74:75], v[26:27] op_sel_hi:[1,0]
	v_pk_add_f32 v[76:77], v[76:77], v[26:27] op_sel_hi:[1,0]
	v_pk_add_f32 v[78:79], v[78:79], v[26:27] op_sel_hi:[1,0]
	v_pk_add_f32 v[80:81], v[80:81], v[26:27] op_sel_hi:[1,0]
	v_pk_add_f32 v[82:83], v[82:83], v[26:27] op_sel_hi:[1,0]
	v_rcp_f32 v64, v64
	v_rcp_f32 v65, v65
	v_rcp_f32 v66, v66
	v_rcp_f32 v67, v67
	v_rcp_f32 v68, v68
	v_rcp_f32 v69, v69
	v_rcp_f32 v70, v70
	v_rcp_f32 v71, v71
	v_rcp_f32 v72, v72
	v_rcp_f32 v73, v73
	v_rcp_f32 v74, v74
	v_rcp_f32 v75, v75
	v_rcp_f32 v76, v76
	v_rcp_f32 v77, v77
	v_rcp_f32 v78, v78
	v_rcp_f32 v79, v79
	v_rcp_f32 v80, v80
	v_rcp_f32 v81, v81
	v_rcp_f32 v82, v82
	v_rcp_f32 v83, v83
	v_pk_mul_f32 v[64:65], v[64:65], v[44:45]
	v_pk_mul_f32 v[66:67], v[66:67], v[46:47]
	v_pk_mul_f32 v[68:69], v[68:69], v[48:49]
	v_pk_mul_f32 v[70:71], v[70:71], v[50:51]
	v_pk_mul_f32 v[72:73], v[72:73], v[52:53]
	v_pk_mul_f32 v[74:75], v[74:75], v[54:55]
	v_pk_mul_f32 v[76:77], v[76:77], v[56:57]
	v_pk_mul_f32 v[78:79], v[78:79], v[58:59]
	v_pk_mul_f32 v[80:81], v[80:81], v[60:61]
	v_pk_mul_f32 v[82:83], v[82:83], v[62:63]
	s_mul_i32 s4, s90, 2560
	s_add_u32 s4, s4, 81920
	v_lshl_add_u32 v24, v1, 3, s4
	v_cvt_pk_bf16_f32 v44, v64, v65
	v_cvt_pk_bf16_f32 v45, v66, v67
	ds_write_b64 v24, v[44:45] offset:0
	v_cvt_pk_bf16_f32 v48, v68, v69
	v_cvt_pk_bf16_f32 v49, v70, v71
	ds_write_b64 v24, v[48:49] offset:512
	v_cvt_pk_bf16_f32 v52, v72, v73
	v_cvt_pk_bf16_f32 v53, v74, v75
	ds_write_b64 v24, v[52:53] offset:1024
	v_cvt_pk_bf16_f32 v56, v76, v77
	v_cvt_pk_bf16_f32 v57, v78, v79
	ds_write_b64 v24, v[56:57] offset:1536
	v_cvt_pk_bf16_f32 v60, v80, v81
	v_cvt_pk_bf16_f32 v61, v82, v83
	ds_write_b64 v24, v[60:61] offset:2048
	s_mul_i32 s4, s80, 74
	s_lshl_b32 s5, s81, 1
	s_add_u32 s4, s4, s5
	s_mul_i32 s4, s4, 5120
	s_add_u32 s15, s4, 2621440
	s_mul_i32 s4, s91, 10240
	s_add_u32 s4, s4, 81920
	v_lshl_add_u32 v25, v1, 3, s4
	s_waitcnt lgkmcnt(0)
	s_barrier
	s_add_u32 s4, s3, 0
	s_min_u32 s5, s4, 9
	s_cmp_ge_u32 s5, 5
	s_cselect_b32 s6, 2560, 0
	s_mul_i32 s5, s5, 512
	s_add_u32 s5, s5, s6
	v_add_u32 v24, s5, v25
	s_lshl_b32 s5, s4, 10
	s_add_u32 s5, s5, s15
	s_cmp_ge_u32 s4, 10
	s_cselect_b32 s5, 1073741824, s5
	v_lshl_add_u32 v34, v1, 4, s5
	ds_read_b64 v[84:85], v24
	ds_read_b64 v[86:87], v24 offset:2560
	s_add_u32 s4, s3, 4
	s_min_u32 s5, s4, 9
	s_cmp_ge_u32 s5, 5
	s_cselect_b32 s6, 2560, 0
	s_mul_i32 s5, s5, 512
	s_add_u32 s5, s5, s6
	v_add_u32 v24, s5, v25
	s_lshl_b32 s5, s4, 10
	s_add_u32 s5, s5, s15
	s_cmp_ge_u32 s4, 10
	s_cselect_b32 s5, 1073741824, s5
	v_lshl_add_u32 v35, v1, 4, s5
	ds_read_b64 v[88:89], v24
	ds_read_b64 v[90:91], v24 offset:2560
	s_add_u32 s4, s3, 8
	s_min_u32 s5, s4, 9
	s_cmp_ge_u32 s5, 5
	s_cselect_b32 s6, 2560, 0
	s_mul_i32 s5, s5, 512
	s_add_u32 s5, s5, s6
	v_add_u32 v24, s5, v25
	s_lshl_b32 s5, s4, 10
	s_add_u32 s5, s5, s15
	s_cmp_ge_u32 s4, 10
	s_cselect_b32 s5, 1073741824, s5
	v_lshl_add_u32 v36, v1, 4, s5
	ds_read_b64 v[92:93], v24
	ds_read_b64 v[94:95], v24 offset:2560
	s_waitcnt lgkmcnt(4)
	buffer_store_dwordx4 v[84:87], v34, s[40:43], 0 offen sc1
	s_waitcnt lgkmcnt(2)
	buffer_store_dwordx4 v[88:91], v35, s[40:43], 0 offen sc1
	s_waitcnt lgkmcnt(0)
	buffer_store_dwordx4 v[92:95], v36, s[40:43], 0 offen sc1
	s_lshl_b32 s4, s80, 5
	s_add_u32 s4, s4, s81
	s_lshl_b32 s4, s4, 2
	s_add_u32 s4, s4, s3
	s_lshl_b32 s4, s4, 7
	s_add_u32 s10, s4, 20000768
	s_branch L_join
L_role_r:
	s_sub_u32 s6, s70, 240
	s_lshl_b32 s11, s6, 1
	s_add_u32 s11, s11, s91
	s_waitcnt lgkmcnt(0)
	s_add_u32 s75, s75, 1
	s_setprio 3
	s_lshl_b32 s4, s11, 11
	s_add_u32 s4, s4, 19853312
	v_lshl_add_u32 v22, v3, 7, s4
	s_lshl_b32 s5, s3, 11
	v_lshl_add_u32 v24, v1, 4, s5
	v_lshrrev_b32 v25, 5, v1
	v_and_b32 v26, 31, v1
	v_lshlrev_b32 v26, 4, v26
	v_lshl_add_u32 v25, v25, 11, v26
	v_add_u32 v25, 1024, v25
	s_cmp_eq_u32 s3, 2
	s_cselect_b64 vcc, -1, 0
	v_cndmask_b32 v24, v24, v25, vcc
	v_lshrrev_b32 v25, 3, v1
	v_and_b32 v26, 7, v1
	v_lshlrev_b32 v26, 4, v26
	v_lshl_add_u32 v25, v25, 8, v26
	v_add_u32 v25, 4096, v25
	s_cmp_eq_u32 s3, 3
	s_cselect_b64 vcc, -1, 0
	v_cndmask_b32 v24, v24, v25, vcc
	s_mul_i32 s4, s11, 98304
	s_add_u32 s4, s4, 13357056
	buffer_load_dword v23, v22, s[40:43], 0 offen sc1
	s_waitcnt vmcnt(0)
	v_cmp_ne_u32 vcc, s75, v23
	s_nop 4
	s_cbranch_vccz L_ok_21
	s_mov_b32 s84, 0
L_poll_22:
	s_sleep 4
	buffer_load_dword v23, v22, s[40:43], 0 offen sc1
	s_waitcnt vmcnt(0)
	v_cmp_ne_u32 vcc, s75, v23
	s_nop 4
	s_cbranch_vccz L_ok_21
	s_add_u32 s84, s84, 1
	s_cmp_lt_u32 s84, 0x8000
	s_cbranch_scc1 L_poll_22
L_ok_21:
	buffer_load_dwordx4 v[128:131], v24, s[40:43], s4 offen sc1
	s_add_u32 s4, s4, 6144
	buffer_load_dwordx4 v[132:135], v24, s[40:43], s4 offen sc1
	s_add_u32 s4, s4, 6144
	buffer_load_dwordx4 v[136:139], v24, s[40:43], s4 offen sc1
	s_add_u32 s4, s4, 6144
	buffer_load_dwordx4 v[140:143], v24, s[40:43], s4 offen sc1
	s_add_u32 s4, s4, 6144
	buffer_load_dwordx4 v[144:147], v24, s[40:43], s4 offen sc1
	s_add_u32 s4, s4, 6144
	buffer_load_dwordx4 v[148:151], v24, s[40:43], s4 offen sc1
	s_add_u32 s4, s4, 6144
	buffer_load_dwordx4 v[152:155], v24, s[40:43], s4 offen sc1
	s_add_u32 s4, s4, 6144
	buffer_load_dwordx4 v[156:159], v24, s[40:43], s4 offen sc1
	s_add_u32 s4, s4, 6144
	buffer_load_dwordx4 v[160:163], v24, s[40:43], s4 offen sc1
	s_add_u32 s4, s4, 6144
	buffer_load_dwordx4 v[164:167], v24, s[40:43], s4 offen sc1
	s_add_u32 s4, s4, 6144
	buffer_load_dwordx4 v[168:171], v24, s[40:43], s4 offen sc1
	s_add_u32 s4, s4, 6144
	buffer_load_dwordx4 v[172:175], v24, s[40:43], s4 offen sc1
	s_add_u32 s4, s4, 6144
	buffer_load_dwordx4 v[176:179], v24, s[40:43], s4 offen sc1
	s_add_u32 s4, s4, 6144
	buffer_load_dwordx4 v[180:183], v24, s[40:43], s4 offen sc1
	s_add_u32 s4, s4, 6144
	buffer_load_dwordx4 v[184:187], v24, s[40:43], s4 offen sc1
	s_add_u32 s4, s4, 6144
	buffer_load_dwordx4 v[188:191], v24, s[40:43], s4 offen sc1
	s_add_u32 s4, s4, 6144
	s_waitcnt vmcnt(14)
	v_pk_add_f32 v[128:129], v[128:129], v[132:133]
	v_pk_add_f32 v[130:131], v[130:131], v[134:135]
	s_waitcnt vmcnt(13)
	v_pk_add_f32 v[128:129], v[128:129], v[136:137]
	v_pk_add_f32 v[130:131], v[130:131], v[138:139]
	s_waitcnt vmcnt(12)
	v_pk_add_f32 v[128:129], v[128:129], v[140:141]
	v_pk_add_f32 v[130:131], v[130:131], v[142:143]
	s_waitcnt vmcnt(11)
	v_pk_add_f32 v[128:129], v[128:129], v[144:145]
	v_pk_add_f32 v[130:131], v[130:131], v[146:147]
	s_waitcnt vmcnt(10)
	v_pk_add_f32 v[128:129], v[128:129], v[148:149]
	v_pk_add_f32 v[130:131], v[130:131], v[150:151]
	s_waitcnt vmcnt(9)
	v_pk_add_f32 v[128:129], v[128:129], v[152:153]
	v_pk_add_f32 v[130:131], v[130:131], v[154:155]
	s_waitcnt vmcnt(8)
	v_pk_add_f32 v[128:129], v[128:129], v[156:157]
	v_pk_add_f32 v[130:131], v[130:131], v[158:159]
	s_waitcnt vmcnt(7)
	v_pk_add_f32 v[128:129], v[128:129], v[160:161]
	v_pk_add_f32 v[130:131], v[130:131], v[162:163]
	s_waitcnt vmcnt(6)
	v_pk_add_f32 v[128:129], v[128:129], v[164:165]
	v_pk_add_f32 v[130:131], v[130:131], v[166:167]
	s_waitcnt vmcnt(5)
	v_pk_add_f32 v[128:129], v[128:129], v[168:169]
	v_pk_add_f32 v[130:131], v[130:131], v[170:171]
	s_waitcnt vmcnt(4)
	v_pk_add_f32 v[128:129], v[128:129], v[172:173]
	v_pk_add_f32 v[130:131], v[130:131], v[174:175]
	s_waitcnt vmcnt(3)
	v_pk_add_f32 v[128:129], v[128:129], v[176:177]
	v_pk_add_f32 v[130:131], v[130:131], v[178:179]
	s_waitcnt vmcnt(2)
	v_pk_add_f32 v[128:129], v[128:129], v[180:181]
	v_pk_add_f32 v[130:131], v[130:131], v[182:183]
	s_waitcnt vmcnt(1)
	v_pk_add_f32 v[128:129], v[128:129], v[184:185]
	v_pk_add_f32 v[130:131], v[130:131], v[186:187]
	s_waitcnt vmcnt(0)
	v_pk_add_f32 v[128:129], v[128:129], v[188:189]
	v_pk_add_f32 v[130:131], v[130:131], v[190:191]
	v_cvt_pk_bf16_f32 v34, v128, v129
	v_cvt_pk_bf16_f32 v35, v130, v131
	s_lshl_b32 s4, s11, 11
	s_add_u32 s4, s4, 19652608
	v_lshl_add_u32 v24, v40, 3, s4
	buffer_store_dwordx2 v[34:35], v24, s[40:43], 0 offen sc1
	s_lshl_b32 s4, s11, 2
	s_add_u32 s4, s4, s3
	s_lshl_b32 s4, s4, 7
	s_add_u32 s10, s4, 19984384
	s_waitcnt vmcnt(0)
	v_lshl_add_u32 v42, v1, 2, s10
	v_mov_b32 v43, s75
	s_mov_b64 exec, 0xffffffff
	buffer_store_dword v43, v42, s[40:43], 0 offen sc1
	s_mov_b64 exec, -1
	s_mov_b32 s10, 1073741824
	s_barrier
	s_branch L_join
L_role_wot:
	s_lshr_b32 s6, s4, 1
	s_lshl_b32 s11, s6, 1
	s_add_u32 s11, s11, s91
	s_mov_b32 s60, s22
	s_and_b32 s61, s23, 0xffff
	s_mov_b32 s62, 819200
	s_mov_b32 s63, 0x20000
	v_lshlrev_b32 v12, 4, v1
	v_add_u32 v13, 4096, v12
	s_waitcnt lgkmcnt(0)
	s_add_u32 s75, s75, 1
	v_add_u32 v24, 0, v1
	v_mul_u32_u24 v25, 6554, v24
	v_lshrrev_b32 v25, 16, v25
	v_mul_u32_u24 v26, 10, v25
	v_sub_u32 v24, v24, v26
	v_mul_u32_u24 v25, 1280, v25
	v_lshl_add_u32 v34, v24, 4, v25
	v_add_u32 v24, 64, v1
	v_mul_u32_u24 v25, 6554, v24
	v_lshrrev_b32 v25, 16, v25
	v_mul_u32_u24 v26, 10, v25
	v_sub_u32 v24, v24, v26
	v_mul_u32_u24 v25, 1280, v25
	v_lshl_add_u32 v35, v24, 4, v25
	v_subrev_u32 v35, 1024, v35
	v_add_u32 v24, 128, v1
	v_mul_u32_u24 v25, 6554, v24
	v_lshrrev_b32 v25, 16, v25
	v_mul_u32_u24 v26, 10, v25
	v_sub_u32 v24, v24, v26
	v_mul_u32_u24 v25, 1280, v25
	v_lshl_add_u32 v36, v24, 4, v25
	v_subrev_u32 v36, 2048, v36
	v_add_u32 v24, 192, v1
	v_mul_u32_u24 v25, 6554, v24
	v_lshrrev_b32 v25, 16, v25
	v_mul_u32_u24 v26, 10, v25
	v_sub_u32 v24, v24, v26
	v_mul_u32_u24 v25, 1280, v25
	v_lshl_add_u32 v37, v24, 4, v25
	v_subrev_u32 v37, 3072, v37
	v_add_u32 v24, 256, v1
	v_mul_u32_u24 v25, 6554, v24
	v_lshrrev_b32 v25, 16, v25
	v_mul_u32_u24 v26, 10, v25
	v_sub_u32 v24, v24, v26
	v_mul_u32_u24 v25, 1280, v25
	v_lshl_add_u32 v38, v24, 4, v25
	s_mul_i32 s4, s11, 160
	s_mul_i32 s5, s3, 204800
	s_add_u32 s7, s4, s5
	s_mul_i32 s6, s90, 20480
	v_mul_u32_u24 v24, 20, v2
	v_add_u32 v24, v24, v4
	v_mul_u32_u24 v24, 160, v24
	v_mul_u32_u24 v25, 40, v5
	v_add_u32 v24, v24, v25
	v_add_u32 v24, s6, v24
	s_mul_i32 s4, s11, 74
	s_mul_i32 s5, s3, 5
	s_add_u32 s4, s4, s5
	s_add_u32 s4, s4, 54
	s_mul_i32 s4, s4, 5120
	s_add_u32 s4, s4, 2621440
	s_add_u32 s8, s7, 0
	s_add_u32 m0, s6, 0
	s_nop 0
	buffer_load_dwordx4 v34, s[60:63], s8 offen lds
	buffer_load_dwordx4 v35, s[60:63], s8 offen offset:1024 lds
	buffer_load_dwordx4 v36, s[60:63], s8 offen offset:2048 lds
	buffer_load_dwordx4 v37, s[60:63], s8 offen offset:3072 lds
	s_add_u32 m0, s6, 4096
	s_nop 0
	buffer_load_dwordx4 v38, s[60:63], s8 offen lds
	s_add_u32 s8, s7, 40960
	s_add_u32 m0, s6, 5120
	s_nop 0
	buffer_load_dwordx4 v34, s[60:63], s8 offen lds
	buffer_load_dwordx4 v35, s[60:63], s8 offen offset:1024 lds
	buffer_load_dwordx4 v36, s[60:63], s8 offen offset:2048 lds
	buffer_load_dwordx4 v37, s[60:63], s8 offen offset:3072 lds
	s_add_u32 m0, s6, 9216
	s_nop 0
	buffer_load_dwordx4 v38, s[60:63], s8 offen lds
	s_add_u32 s8, s7, 81920
	s_add_u32 m0, s6, 10240
	s_nop 0
	buffer_load_dwordx4 v34, s[60:63], s8 offen lds
	buffer_load_dwordx4 v35, s[60:63], s8 offen offset:1024 lds
	buffer_load_dwordx4 v36, s[60:63], s8 offen offset:2048 lds
	buffer_load_dwordx4 v37, s[60:63], s8 offen offset:3072 lds
	s_add_u32 m0, s6, 14336
	s_nop 0
	buffer_load_dwordx4 v38, s[60:63], s8 offen lds
	s_waitcnt vmcnt(0)
	ds_read_b64_tr_b16 v[156:157], v24 offset:0
	ds_read_b64_tr_b16 v[160:161], v24 offset:8
	ds_read_b64_tr_b16 v[164:165], v24 offset:16
	ds_read_b64_tr_b16 v[168:169], v24 offset:24
	ds_read_b64_tr_b16 v[172:173], v24 offset:32
	s_waitcnt lgkmcnt(0)
	ds_read_b64_tr_b16 v[158:159], v24 offset:640
	ds_read_b64_tr_b16 v[162:163], v24 offset:648
	ds_read_b64_tr_b16 v[166:167], v24 offset:656
	ds_read_b64_tr_b16 v[170:171], v24 offset:664
	ds_read_b64_tr_b16 v[174:175], v24 offset:672
	s_waitcnt lgkmcnt(0)
	ds_read_b64_tr_b16 v[176:177], v24 offset:1280
	ds_read_b64_tr_b16 v[180:181], v24 offset:1288
	ds_read_b64_tr_b16 v[184:185], v24 offset:1296
	ds_read_b64_tr_b16 v[188:189], v24 offset:1304
	ds_read_b64_tr_b16 v[192:193], v24 offset:1312
	s_waitcnt lgkmcnt(0)
	ds_read_b64_tr_b16 v[178:179], v24 offset:1920
	ds_read_b64_tr_b16 v[182:183], v24 offset:1928
	ds_read_b64_tr_b16 v[186:187], v24 offset:1936
	ds_read_b64_tr_b16 v[190:191], v24 offset:1944
	ds_read_b64_tr_b16 v[194:195], v24 offset:1952
	s_waitcnt lgkmcnt(0)
	ds_read_b64_tr_b16 v[196:197], v24 offset:2560
	ds_read_b64_tr_b16 v[200:201], v24 offset:2568
	ds_read_b64_tr_b16 v[204:205], v24 offset:2576
	ds_read_b64_tr_b16 v[208:209], v24 offset:2584
	ds_read_b64_tr_b16 v[212:213], v24 offset:2592
	s_waitcnt lgkmcnt(0)
	s_add_u32 s8, s7, 102400
	s_add_u32 m0, s6, 0
	s_nop 0
	buffer_load_dwordx4 v34, s[60:63], s8 offen lds
	buffer_load_dwordx4 v35, s[60:63], s8 offen offset:1024 lds
	buffer_load_dwordx4 v36, s[60:63], s8 offen offset:2048 lds
	buffer_load_dwordx4 v37, s[60:63], s8 offen offset:3072 lds
	s_add_u32 m0, s6, 4096
	s_nop 0
	buffer_load_dwordx4 v38, s[60:63], s8 offen lds
	s_add_u32 s8, s7, 143360
	s_add_u32 m0, s6, 5120
	s_nop 0
	buffer_load_dwordx4 v34, s[60:63], s8 offen lds
	buffer_load_dwordx4 v35, s[60:63], s8 offen offset:1024 lds
	buffer_load_dwordx4 v36, s[60:63], s8 offen offset:2048 lds
	buffer_load_dwordx4 v37, s[60:63], s8 offen offset:3072 lds
	s_add_u32 m0, s6, 9216
	s_nop 0
	buffer_load_dwordx4 v38, s[60:63], s8 offen lds
	s_add_u32 s8, s7, 184320
	s_add_u32 m0, s6, 10240
	s_nop 0
	buffer_load_dwordx4 v34, s[60:63], s8 offen lds
	buffer_load_dwordx4 v35, s[60:63], s8 offen offset:1024 lds
	buffer_load_dwordx4 v36, s[60:63], s8 offen offset:2048 lds
	buffer_load_dwordx4 v37, s[60:63], s8 offen offset:3072 lds
	s_add_u32 m0, s6, 14336
	s_nop 0
	buffer_load_dwordx4 v38, s[60:63], s8 offen lds
	s_waitcnt vmcnt(0)
	ds_read_b64_tr_b16 v[198:199], v24 offset:2560
	ds_read_b64_tr_b16 v[202:203], v24 offset:2568
	ds_read_b64_tr_b16 v[206:207], v24 offset:2576
	ds_read_b64_tr_b16 v[210:211], v24 offset:2584
	ds_read_b64_tr_b16 v[214:215], v24 offset:2592
	s_waitcnt lgkmcnt(0)
	ds_read_b64_tr_b16 v[216:217], v24 offset:0
	ds_read_b64_tr_b16 v[220:221], v24 offset:8
	ds_read_b64_tr_b16 v[224:225], v24 offset:16
	ds_read_b64_tr_b16 v[228:229], v24 offset:24
	ds_read_b64_tr_b16 v[232:233], v24 offset:32
	s_waitcnt lgkmcnt(0)
	ds_read_b64_tr_b16 v[218:219], v24 offset:640
	ds_read_b64_tr_b16 v[222:223], v24 offset:648
	ds_read_b64_tr_b16 v[226:227], v24 offset:656
	ds_read_b64_tr_b16 v[230:231], v24 offset:664
	ds_read_b64_tr_b16 v[234:235], v24 offset:672
	s_waitcnt lgkmcnt(0)
	ds_read_b64_tr_b16 v[236:237], v24 offset:1280
	ds_read_b64_tr_b16 v[240:241], v24 offset:1288
	ds_read_b64_tr_b16 v[244:245], v24 offset:1296
	ds_read_b64_tr_b16 v[248:249], v24 offset:1304
	ds_read_b64_tr_b16 v[252:253], v24 offset:1312
	s_waitcnt lgkmcnt(0)
	ds_read_b64_tr_b16 v[238:239], v24 offset:1920
	ds_read_b64_tr_b16 v[242:243], v24 offset:1928
	ds_read_b64_tr_b16 v[246:247], v24 offset:1936
	ds_read_b64_tr_b16 v[250:251], v24 offset:1944
	ds_read_b64_tr_b16 v[254:255], v24 offset:1952
	s_waitcnt lgkmcnt(0)
	buffer_store_dwordx4 v[156:159], v12, s[40:43], s4 offen offset:0 sc1
	buffer_store_dwordx4 v[160:163], v12, s[40:43], s4 offen offset:1024 sc1
	buffer_store_dwordx4 v[164:167], v12, s[40:43], s4 offen offset:2048 sc1
	buffer_store_dwordx4 v[168:171], v12, s[40:43], s4 offen offset:3072 sc1
	buffer_store_dwordx4 v[172:175], v13, s[40:43], s4 offen offset:0 sc1
	s_add_u32 s4, s4, 5120
	buffer_store_dwordx4 v[176:179], v12, s[40:43], s4 offen offset:0 sc1
	buffer_store_dwordx4 v[180:183], v12, s[40:43], s4 offen offset:1024 sc1
	buffer_store_dwordx4 v[184:187], v12, s[40:43], s4 offen offset:2048 sc1
	buffer_store_dwordx4 v[188:191], v12, s[40:43], s4 offen offset:3072 sc1
	buffer_store_dwordx4 v[192:195], v13, s[40:43], s4 offen offset:0 sc1
	s_add_u32 s4, s4, 5120
	buffer_store_dwordx4 v[196:199], v12, s[40:43], s4 offen offset:0 sc1
	buffer_store_dwordx4 v[200:203], v12, s[40:43], s4 offen offset:1024 sc1
	buffer_store_dwordx4 v[204:207], v12, s[40:43], s4 offen offset:2048 sc1
	buffer_store_dwordx4 v[208:211], v12, s[40:43], s4 offen offset:3072 sc1
	buffer_store_dwordx4 v[212:215], v13, s[40:43], s4 offen offset:0 sc1
	s_add_u32 s4, s4, 5120
	buffer_store_dwordx4 v[216:219], v12, s[40:43], s4 offen offset:0 sc1
	buffer_store_dwordx4 v[220:223], v12, s[40:43], s4 offen offset:1024 sc1
	buffer_store_dwordx4 v[224:227], v12, s[40:43], s4 offen offset:2048 sc1
	buffer_store_dwordx4 v[228:231], v12, s[40:43], s4 offen offset:3072 sc1
	buffer_store_dwordx4 v[232:235], v13, s[40:43], s4 offen offset:0 sc1
	s_add_u32 s4, s4, 5120
	buffer_store_dwordx4 v[236:239], v12, s[40:43], s4 offen offset:0 sc1
	buffer_store_dwordx4 v[240:243], v12, s[40:43], s4 offen offset:1024 sc1
	buffer_store_dwordx4 v[244:247], v12, s[40:43], s4 offen offset:2048 sc1
	buffer_store_dwordx4 v[248:251], v12, s[40:43], s4 offen offset:3072 sc1
	buffer_store_dwordx4 v[252:255], v13, s[40:43], s4 offen offset:0 sc1
	s_add_u32 s4, s4, 5120
	s_lshl_b32 s4, s11, 2
	s_add_u32 s4, s4, s3
	s_lshl_b32 s4, s4, 7
	s_add_u32 s10, s4, 20262912
	s_barrier
L_join:
	s_waitcnt vmcnt(0) lgkmcnt(0)
	v_lshl_add_u32 v42, v1, 2, s10
	v_mov_b32 v43, s75
	s_mov_b64 exec, 0xffffffff
	buffer_store_dword v43, v42, s[40:43], 0 offen sc1
	s_mov_b64 exec, -1
	s_setprio 0
	s_cmp_lg_u32 s91, 0
	s_cbranch_scc1 L_fin
	s_and_b32 s4, s70, 7
	s_lshr_b32 s5, s70, 3
	s_and_b32 s68, s5, 7
	s_lshl_b32 s6, s4, 2
	s_lshr_b32 s7, s5, 3
	s_add_u32 s69, s6, s7
	s_lshl_b32 s4, s69, 6
	s_lshl_b32 s5, s3, 4
	s_add_u32 s4, s4, s5
	v_add_u32 v6, s4, v3
	v_lshlrev_b32 v12, 4, v1
	v_add_u32 v13, 4096, v12
	s_lshl_b32 s83, s3, 12
	v_bfe_u32 v25, v7, 1, 2
	v_xor_b32 v25, s3, v25
	v_lshlrev_b32 v26, 7, v7
	v_lshl_add_u32 v26, v5, 3, v26
	v_add_u32 v26, s83, v26
	v_xor_b32 v27, 0, v25
	v_lshl_add_u32 v14, v27, 5, v26
	v_xor_b32 v27, 1, v25
	v_lshl_add_u32 v15, v27, 5, v26
	v_xor_b32 v27, 2, v25
	v_lshl_add_u32 v16, v27, 5, v26
	v_xor_b32 v27, 3, v25
	v_lshl_add_u32 v17, v27, 5, v26
	v_lshrrev_b32 v24, 3, v1
	v_mul_u32_u24 v24, 4096, v24
	v_and_b32 v25, 7, v1
	v_lshlrev_b32 v26, 1, v2
	v_xor_b32 v25, v25, v26
	v_lshl_add_u32 v24, v25, 4, v24
	s_lshl_b32 s4, s69, 7
	s_mul_i32 s5, s3, 1835008
	s_add_u32 s5, s5, s4
	s_mov_b32 s74, s83
	s_add_u32 s6, s5, 0
	v_add_u32 v8, s6, v24
	s_add_u32 s6, s5, 31744
	v_add_u32 v9, s6, v24
	s_add_u32 s6, s5, 63488
	v_add_u32 v10, s6, v24
	s_add_u32 s6, s5, 95232
	v_add_u32 v11, s6, v24
	s_mul_i32 s4, s68, 74
	s_mul_i32 s5, s3, 14
	s_add_u32 s4, s4, s5
	s_mul_i32 s4, s4, 5120
	s_add_u32 s82, s4, 2621440
	s_lshl_b32 s4, s68, 14
	s_mul_i32 s5, s3, 3584
	s_add_u32 s4, s4, s5
	s_add_u32 s4, s4, 20000768
	s_mul_i32 s5, s68, 378880
	s_add_u32 s85, s5, 2892800
	s_cmp_eq_u32 s3, 3
	s_cselect_b32 s5, 23, 27
	v_min_u32 v24, s5, v1
	v_lshl_add_u32 v22, v24, 7, s4
	s_mov_b32 s60, s32
	s_and_b32 s61, s33, 0xffff
	s_mov_b32 s62, 4096
	s_mov_b32 s63, 0x20000
	v_mul_u32_u24 v32, 1280, v6
	v_mul_u32_u24 v33, 40, v2
	s_mul_i32 s4, s68, 160
	v_add3_u32 v32, v32, v33, s4
	v_lshlrev_b32 v33, 1, v6
	buffer_load_ushort v36, v33, s[60:63], 0 offen
	buffer_load_dwordx4 v[64:67], v32, s[44:47], 0 offen
	buffer_load_dwordx4 v[68:71], v32, s[44:47], 0 offen offset:16
	buffer_load_dwordx2 v[72:73], v32, s[44:47], 0 offen offset:32
	s_add_u32 m0, s74, 0
	s_nop 0
	buffer_load_dwordx4 v8, s[56:59], 0 offen lds
	v_add_u32 v8, 131072, v8
	buffer_load_dwordx4 v9, s[56:59], 0 offen offset:1024 lds
	v_add_u32 v9, 131072, v9
	buffer_load_dwordx4 v10, s[56:59], 0 offen offset:2048 lds
	v_add_u32 v10, 131072, v10
	buffer_load_dwordx4 v11, s[56:59], 0 offen offset:3072 lds
	v_add_u32 v11, 131072, v11
	s_add_u32 m0, s74, 16384
	s_nop 0
	buffer_load_dwordx4 v8, s[56:59], 0 offen lds
	v_add_u32 v8, 131072, v8
	buffer_load_dwordx4 v9, s[56:59], 0 offen offset:1024 lds
	v_add_u32 v9, 131072, v9
	buffer_load_dwordx4 v10, s[56:59], 0 offen offset:2048 lds
	v_add_u32 v10, 131072, v10
	buffer_load_dwordx4 v11, s[56:59], 0 offen offset:3072 lds
	v_add_u32 v11, 131072, v11
	s_add_u32 m0, s74, 32768
	s_nop 0
	buffer_load_dwordx4 v8, s[56:59], 0 offen lds
	v_add_u32 v8, 131072, v8
	buffer_load_dwordx4 v9, s[56:59], 0 offen offset:1024 lds
	v_add_u32 v9, 131072, v9
	buffer_load_dwordx4 v10, s[56:59], 0 offen offset:2048 lds
	v_add_u32 v10, 131072, v10
	buffer_load_dwordx4 v11, s[56:59], 0 offen offset:3072 lds
	v_add_u32 v11, 131072, v11
	s_add_u32 m0, s74, 49152
	s_nop 0
	buffer_load_dwordx4 v8, s[56:59], 0 offen lds
	v_add_u32 v8, 131072, v8
	buffer_load_dwordx4 v9, s[56:59], 0 offen offset:1024 lds
	v_add_u32 v9, 131072, v9
	buffer_load_dwordx4 v10, s[56:59], 0 offen offset:2048 lds
	v_add_u32 v10, 131072, v10
	buffer_load_dwordx4 v11, s[56:59], 0 offen offset:3072 lds
	v_add_u32 v11, 131072, v11
	s_add_u32 m0, s74, 65536
	s_nop 0
	buffer_load_dwordx4 v8, s[56:59], 0 offen lds
	v_add_u32 v8, 131072, v8
	buffer_load_dwordx4 v9, s[56:59], 0 offen offset:1024 lds
	v_add_u32 v9, 131072, v9
	buffer_load_dwordx4 v10, s[56:59], 0 offen offset:2048 lds
	v_add_u32 v10, 131072, v10
	buffer_load_dwordx4 v11, s[56:59], 0 offen offset:3072 lds
	v_add_u32 v11, 131072, v11
	s_mov_b32 s64, s34
	s_and_b32 s65, s35, 0xffff
	s_mov_b32 s66, 2621440
	s_mov_b32 s67, 0x20000
	s_mov_b32 s60, s32
	s_and_b32 s61, s33, 0xffff
	s_mov_b32 s62, 4096
	s_mov_b32 s63, 0x20000
	s_lshl_b32 s4, s69, 12
	s_lshl_b32 s5, s3, 10
	s_add_u32 s4, s4, s5
	s_add_u32 s4, s4, 20131840
	v_lshl_add_u32 v34, v5, 8, s4
	s_lshl_b32 s4, s68, 2
	s_add_u32 s4, s4, s3
	s_lshl_b32 s4, s4, 7
	s_add_u32 s4, s4, 20262912
	v_mov_b32 v35, s4
	v_cmp_gt_u32 vcc, 63, v1
	s_nop 1
	v_cndmask_b32 v22, v35, v22, vcc
	s_xor_b32 s4, s3, 0
	s_lshl_b32 s4, s4, 10
	v_add_u32 v28, s4, v12
	s_xor_b32 s4, s3, 1
	s_lshl_b32 s4, s4, 10
	v_add_u32 v29, s4, v12
	s_xor_b32 s4, s3, 2
	s_lshl_b32 s4, s4, 10
	v_add_u32 v30, s4, v12
	s_xor_b32 s4, s3, 3
	s_lshl_b32 s4, s4, 10
	v_add_u32 v31, s4, v12
	s_mul_i32 s4, s69, 20
	s_mul_i32 s5, s3, 5
	s_add_u32 s4, s4, s5
	s_lshl_b32 s4, s4, 12
	s_add_u32 s11, s4, 5652480
	v_mul_u32_u24 v32, 1280, v6
	v_mul_u32_u24 v33, 40, v2
	v_add_u32 v32, v32, v33
	s_mul_i32 s4, s68, 160
	v_add_u32 v32, s4, v32
	v_lshlrev_b32 v33, 1, v6
	s_lshl_b32 s5, s69, 2
	s_add_u32 s5, s5, s3
	s_mul_i32 s5, s5, 20480
	s_add_u32 s4, s4, s5
	v_add_u32 v24, 0, v1
	v_mul_u32_u24 v25, 6554, v24
	v_lshrrev_b32 v25, 16, v25
	v_mul_u32_u24 v25, 1120, v25
	v_lshl_add_u32 v25, v24, 4, v25
	v_add_u32 v37, s4, v25
	v_add_u32 v24, 64, v1
	v_mul_u32_u24 v25, 6554, v24
	v_lshrrev_b32 v25, 16, v25
	v_mul_u32_u24 v25, 1120, v25
	v_lshl_add_u32 v25, v24, 4, v25
	v_add_u32 v38, s4, v25
	v_add_u32 v24, 128, v1
	v_mul_u32_u24 v25, 6554, v24
	v_lshrrev_b32 v25, 16, v25
	v_mul_u32_u24 v25, 1120, v25
	v_lshl_add_u32 v25, v24, 4, v25
	v_add_u32 v39, s4, v25
	v_mov_b32 v24, 1073741824
	v_cmp_gt_u32 vcc, 32, v1
	s_nop 1
	v_cndmask_b32 v39, v24, v39, vcc
	buffer_load_dword v23, v22, s[40:43], 0 offen sc1
	s_waitcnt vmcnt(0)
	v_cmp_ne_u32 vcc, s75, v23
	s_nop 4
	s_cbranch_vccz L_ok_23
	s_mov_b32 s84, 0
L_poll_24:
	s_sleep 2
	buffer_load_dword v23, v22, s[40:43], 0 offen sc1
	s_waitcnt vmcnt(0)
	v_cmp_ne_u32 vcc, s75, v23
	s_nop 4
	s_cbranch_vccz L_ok_23
	s_add_u32 s84, s84, 1
	s_cmp_lt_u32 s84, 0x8000
	s_cbranch_scc1 L_poll_24
L_ok_23:
	buffer_load_dwordx4 v[156:159], v12, s[40:43], s82 offen sc1
	buffer_load_dwordx4 v[160:163], v12, s[40:43], s82 offen offset:1024 sc1
	buffer_load_dwordx4 v[164:167], v12, s[40:43], s82 offen offset:2048 sc1
	buffer_load_dwordx4 v[168:171], v12, s[40:43], s82 offen offset:3072 sc1
	buffer_load_dwordx4 v[172:175], v13, s[40:43], s82 offen sc1
	s_add_u32 s82, s82, 5120
	s_min_u32 s82, s82, s85
	buffer_load_dwordx4 v[176:179], v12, s[40:43], s82 offen sc1
	buffer_load_dwordx4 v[180:183], v12, s[40:43], s82 offen offset:1024 sc1
	buffer_load_dwordx4 v[184:187], v12, s[40:43], s82 offen offset:2048 sc1
	buffer_load_dwordx4 v[188:191], v12, s[40:43], s82 offen offset:3072 sc1
	buffer_load_dwordx4 v[192:195], v13, s[40:43], s82 offen sc1
	s_add_u32 s82, s82, 5120
	s_min_u32 s82, s82, s85
	buffer_load_dwordx4 v[196:199], v12, s[40:43], s82 offen sc1
	buffer_load_dwordx4 v[200:203], v12, s[40:43], s82 offen offset:1024 sc1
	buffer_load_dwordx4 v[204:207], v12, s[40:43], s82 offen offset:2048 sc1
	buffer_load_dwordx4 v[208:211], v12, s[40:43], s82 offen offset:3072 sc1
	buffer_load_dwordx4 v[212:215], v13, s[40:43], s82 offen sc1
	s_add_u32 s82, s82, 5120
	s_min_u32 s82, s82, s85
	buffer_load_dwordx4 v[216:219], v12, s[40:43], s82 offen sc1
	buffer_load_dwordx4 v[220:223], v12, s[40:43], s82 offen offset:1024 sc1
	buffer_load_dwordx4 v[224:227], v12, s[40:43], s82 offen offset:2048 sc1
	buffer_load_dwordx4 v[228:231], v12, s[40:43], s82 offen offset:3072 sc1
	buffer_load_dwordx4 v[232:235], v13, s[40:43], s82 offen sc1
	s_add_u32 s82, s82, 5120
	s_min_u32 s82, s82, s85
	buffer_load_dwordx4 v[236:239], v12, s[40:43], s82 offen sc1
	buffer_load_dwordx4 v[240:243], v12, s[40:43], s82 offen offset:1024 sc1
	buffer_load_dwordx4 v[244:247], v12, s[40:43], s82 offen offset:2048 sc1
	buffer_load_dwordx4 v[248:251], v12, s[40:43], s82 offen offset:3072 sc1
	buffer_load_dwordx4 v[252:255], v13, s[40:43], s82 offen sc1
	s_add_u32 s82, s82, 5120
	s_min_u32 s82, s82, s85
	v_lshlrev_b32 v36, 16, v36
	v_lshlrev_b32 v44, 16, v64
	v_and_b32 v45, 0xffff0000, v64
	v_pk_add_f32 v[44:45], v[44:45], v[36:37] op_sel_hi:[1,0]
	v_lshlrev_b32 v46, 16, v65
	v_and_b32 v47, 0xffff0000, v65
	v_pk_add_f32 v[46:47], v[46:47], v[36:37] op_sel_hi:[1,0]
	v_lshlrev_b32 v48, 16, v66
	v_and_b32 v49, 0xffff0000, v66
	v_pk_add_f32 v[48:49], v[48:49], v[36:37] op_sel_hi:[1,0]
	v_lshlrev_b32 v50, 16, v67
	v_and_b32 v51, 0xffff0000, v67
	v_pk_add_f32 v[50:51], v[50:51], v[36:37] op_sel_hi:[1,0]
	v_lshlrev_b32 v52, 16, v68
	v_and_b32 v53, 0xffff0000, v68
	v_pk_add_f32 v[52:53], v[52:53], v[36:37] op_sel_hi:[1,0]
	v_lshlrev_b32 v54, 16, v69
	v_and_b32 v55, 0xffff0000, v69
	v_pk_add_f32 v[54:55], v[54:55], v[36:37] op_sel_hi:[1,0]
	v_lshlrev_b32 v56, 16, v70
	v_and_b32 v57, 0xffff0000, v70
	v_pk_add_f32 v[56:57], v[56:57], v[36:37] op_sel_hi:[1,0]
	v_lshlrev_b32 v58, 16, v71
	v_and_b32 v59, 0xffff0000, v71
	v_pk_add_f32 v[58:59], v[58:59], v[36:37] op_sel_hi:[1,0]
	v_lshlrev_b32 v60, 16, v72
	v_and_b32 v61, 0xffff0000, v72
	v_pk_add_f32 v[60:61], v[60:61], v[36:37] op_sel_hi:[1,0]
	v_lshlrev_b32 v62, 16, v73
	v_and_b32 v63, 0xffff0000, v73
	v_pk_add_f32 v[62:63], v[62:63], v[36:37] op_sel_hi:[1,0]
	ds_read_b64_tr_b16 v[124:125], v14 offset:0
	ds_read_b64_tr_b16 v[126:127], v14 offset:2048
	ds_read_b64_tr_b16 v[128:129], v15 offset:0
	ds_read_b64_tr_b16 v[130:131], v15 offset:2048
	ds_read_b64_tr_b16 v[132:133], v16 offset:0
	ds_read_b64_tr_b16 v[134:135], v16 offset:2048
	ds_read_b64_tr_b16 v[136:137], v17 offset:0
	ds_read_b64_tr_b16 v[138:139], v17 offset:2048
	s_waitcnt vmcnt(20) lgkmcnt(0)
	v_mfma_f32_16x16x32_bf16 v[64:67], v[156:159], v[128:131], 0
	ds_read_b64_tr_b16 v[140:141], v14 offset:16384
	ds_read_b64_tr_b16 v[142:143], v14 offset:18432
	v_mfma_f32_16x16x32_bf16 v[68:71], v[160:163], v[128:131], 0
	ds_read_b64_tr_b16 v[144:145], v15 offset:16384
	ds_read_b64_tr_b16 v[146:147], v15 offset:18432
	v_mfma_f32_16x16x32_bf16 v[72:75], v[164:167], v[128:131], 0
	ds_read_b64_tr_b16 v[148:149], v16 offset:16384
	ds_read_b64_tr_b16 v[150:151], v16 offset:18432
	v_mfma_f32_16x16x32_bf16 v[76:79], v[168:171], v[128:131], 0
	ds_read_b64_tr_b16 v[152:153], v17 offset:16384
	ds_read_b64_tr_b16 v[154:155], v17 offset:18432
	v_mfma_f32_16x16x32_bf16 v[80:83], v[172:175], v[128:131], 0
	v_mfma_f32_16x16x32_bf16 v[84:87], v[156:159], v[132:135], 0
	v_mfma_f32_16x16x32_bf16 v[88:91], v[160:163], v[132:135], 0
	v_mfma_f32_16x16x32_bf16 v[92:95], v[164:167], v[132:135], 0
	v_mfma_f32_16x16x32_bf16 v[96:99], v[168:171], v[132:135], 0
	v_mfma_f32_16x16x32_bf16 v[100:103], v[172:175], v[132:135], 0
	v_mfma_f32_16x16x32_bf16 v[104:107], v[156:159], v[136:139], 0
	v_mfma_f32_16x16x32_bf16 v[108:111], v[160:163], v[136:139], 0
	v_mfma_f32_16x16x32_bf16 v[112:115], v[164:167], v[136:139], 0
	v_mfma_f32_16x16x32_bf16 v[116:119], v[168:171], v[136:139], 0
	v_mfma_f32_16x16x32_bf16 v[120:123], v[172:175], v[136:139], 0
	v_mfma_f32_16x16x32_bf16 v[44:47], v[156:159], v[124:127], v[44:47]
	v_mfma_f32_16x16x32_bf16 v[48:51], v[160:163], v[124:127], v[48:51]
	v_mfma_f32_16x16x32_bf16 v[52:55], v[164:167], v[124:127], v[52:55]
	v_mfma_f32_16x16x32_bf16 v[56:59], v[168:171], v[124:127], v[56:59]
	v_mfma_f32_16x16x32_bf16 v[60:63], v[172:175], v[124:127], v[60:63]
	s_add_u32 m0, s74, 0
	s_nop 0
	buffer_load_dwordx4 v8, s[56:59], 0 offen lds
	v_add_u32 v8, 131072, v8
	buffer_load_dwordx4 v9, s[56:59], 0 offen offset:1024 lds
	v_add_u32 v9, 131072, v9
	buffer_load_dwordx4 v10, s[56:59], 0 offen offset:2048 lds
	v_add_u32 v10, 131072, v10
	buffer_load_dwordx4 v11, s[56:59], 0 offen offset:3072 lds
	v_add_u32 v11, 131072, v11
	s_waitcnt vmcnt(19) lgkmcnt(0)
	v_mfma_f32_16x16x32_bf16 v[64:67], v[176:179], v[144:147], v[64:67]
	ds_read_b64_tr_b16 v[124:125], v14 offset:32768
	ds_read_b64_tr_b16 v[126:127], v14 offset:34816
	v_mfma_f32_16x16x32_bf16 v[68:71], v[180:183], v[144:147], v[68:71]
	ds_read_b64_tr_b16 v[128:129], v15 offset:32768
	ds_read_b64_tr_b16 v[130:131], v15 offset:34816
	v_mfma_f32_16x16x32_bf16 v[72:75], v[184:187], v[144:147], v[72:75]
	ds_read_b64_tr_b16 v[132:133], v16 offset:32768
	ds_read_b64_tr_b16 v[134:135], v16 offset:34816
	v_mfma_f32_16x16x32_bf16 v[76:79], v[188:191], v[144:147], v[76:79]
	ds_read_b64_tr_b16 v[136:137], v17 offset:32768
	ds_read_b64_tr_b16 v[138:139], v17 offset:34816
	v_mfma_f32_16x16x32_bf16 v[80:83], v[192:195], v[144:147], v[80:83]
	v_mfma_f32_16x16x32_bf16 v[84:87], v[176:179], v[148:151], v[84:87]
	v_mfma_f32_16x16x32_bf16 v[88:91], v[180:183], v[148:151], v[88:91]
	v_mfma_f32_16x16x32_bf16 v[92:95], v[184:187], v[148:151], v[92:95]
	v_mfma_f32_16x16x32_bf16 v[96:99], v[188:191], v[148:151], v[96:99]
	v_mfma_f32_16x16x32_bf16 v[100:103], v[192:195], v[148:151], v[100:103]
	v_mfma_f32_16x16x32_bf16 v[104:107], v[176:179], v[152:155], v[104:107]
	v_mfma_f32_16x16x32_bf16 v[108:111], v[180:183], v[152:155], v[108:111]
	v_mfma_f32_16x16x32_bf16 v[112:115], v[184:187], v[152:155], v[112:115]
	v_mfma_f32_16x16x32_bf16 v[116:119], v[188:191], v[152:155], v[116:119]
	v_mfma_f32_16x16x32_bf16 v[120:123], v[192:195], v[152:155], v[120:123]
	v_mfma_f32_16x16x32_bf16 v[44:47], v[176:179], v[140:143], v[44:47]
	v_mfma_f32_16x16x32_bf16 v[48:51], v[180:183], v[140:143], v[48:51]
	v_mfma_f32_16x16x32_bf16 v[52:55], v[184:187], v[140:143], v[52:55]
	v_mfma_f32_16x16x32_bf16 v[56:59], v[188:191], v[140:143], v[56:59]
	v_mfma_f32_16x16x32_bf16 v[60:63], v[192:195], v[140:143], v[60:63]
	s_add_u32 m0, s74, 16384
	s_nop 0
	buffer_load_dwordx4 v8, s[56:59], 0 offen lds
	v_add_u32 v8, 131072, v8
	buffer_load_dwordx4 v9, s[56:59], 0 offen offset:1024 lds
	v_add_u32 v9, 131072, v9
	buffer_load_dwordx4 v10, s[56:59], 0 offen offset:2048 lds
	v_add_u32 v10, 131072, v10
	buffer_load_dwordx4 v11, s[56:59], 0 offen offset:3072 lds
	v_add_u32 v11, 131072, v11
	buffer_load_dwordx4 v[156:159], v12, s[40:43], s82 offen sc1
	buffer_load_dwordx4 v[160:163], v12, s[40:43], s82 offen offset:1024 sc1
	buffer_load_dwordx4 v[164:167], v12, s[40:43], s82 offen offset:2048 sc1
	buffer_load_dwordx4 v[168:171], v12, s[40:43], s82 offen offset:3072 sc1
	buffer_load_dwordx4 v[172:175], v13, s[40:43], s82 offen sc1
	s_add_u32 s82, s82, 5120
	s_min_u32 s82, s82, s85
	s_waitcnt vmcnt(23) lgkmcnt(0)
	v_mfma_f32_16x16x32_bf16 v[64:67], v[196:199], v[128:131], v[64:67]
	ds_read_b64_tr_b16 v[140:141], v14 offset:49152
	ds_read_b64_tr_b16 v[142:143], v14 offset:51200
	v_mfma_f32_16x16x32_bf16 v[68:71], v[200:203], v[128:131], v[68:71]
	ds_read_b64_tr_b16 v[144:145], v15 offset:49152
	ds_read_b64_tr_b16 v[146:147], v15 offset:51200
	v_mfma_f32_16x16x32_bf16 v[72:75], v[204:207], v[128:131], v[72:75]
	ds_read_b64_tr_b16 v[148:149], v16 offset:49152
	ds_read_b64_tr_b16 v[150:151], v16 offset:51200
	v_mfma_f32_16x16x32_bf16 v[76:79], v[208:211], v[128:131], v[76:79]
	ds_read_b64_tr_b16 v[152:153], v17 offset:49152
	ds_read_b64_tr_b16 v[154:155], v17 offset:51200
	v_mfma_f32_16x16x32_bf16 v[80:83], v[212:215], v[128:131], v[80:83]
	v_mfma_f32_16x16x32_bf16 v[84:87], v[196:199], v[132:135], v[84:87]
	v_mfma_f32_16x16x32_bf16 v[88:91], v[200:203], v[132:135], v[88:91]
	v_mfma_f32_16x16x32_bf16 v[92:95], v[204:207], v[132:135], v[92:95]
	v_mfma_f32_16x16x32_bf16 v[96:99], v[208:211], v[132:135], v[96:99]
	v_mfma_f32_16x16x32_bf16 v[100:103], v[212:215], v[132:135], v[100:103]
	v_mfma_f32_16x16x32_bf16 v[104:107], v[196:199], v[136:139], v[104:107]
	v_mfma_f32_16x16x32_bf16 v[108:111], v[200:203], v[136:139], v[108:111]
	v_mfma_f32_16x16x32_bf16 v[112:115], v[204:207], v[136:139], v[112:115]
	v_mfma_f32_16x16x32_bf16 v[116:119], v[208:211], v[136:139], v[116:119]
	v_mfma_f32_16x16x32_bf16 v[120:123], v[212:215], v[136:139], v[120:123]
	v_mfma_f32_16x16x32_bf16 v[44:47], v[196:199], v[124:127], v[44:47]
	v_mfma_f32_16x16x32_bf16 v[48:51], v[200:203], v[124:127], v[48:51]
	v_mfma_f32_16x16x32_bf16 v[52:55], v[204:207], v[124:127], v[52:55]
	v_mfma_f32_16x16x32_bf16 v[56:59], v[208:211], v[124:127], v[56:59]
	v_mfma_f32_16x16x32_bf16 v[60:63], v[212:215], v[124:127], v[60:63]
	s_add_u32 m0, s74, 32768
	s_nop 0
	buffer_load_dwordx4 v8, s[56:59], 0 offen lds
	v_add_u32 v8, 131072, v8
	buffer_load_dwordx4 v9, s[56:59], 0 offen offset:1024 lds
	v_add_u32 v9, 131072, v9
	buffer_load_dwordx4 v10, s[56:59], 0 offen offset:2048 lds
	v_add_u32 v10, 131072, v10
	buffer_load_dwordx4 v11, s[56:59], 0 offen offset:3072 lds
	v_add_u32 v11, 131072, v11
	buffer_load_dwordx4 v[176:179], v12, s[40:43], s82 offen sc1
	buffer_load_dwordx4 v[180:183], v12, s[40:43], s82 offen offset:1024 sc1
	buffer_load_dwordx4 v[184:187], v12, s[40:43], s82 offen offset:2048 sc1
	buffer_load_dwordx4 v[188:191], v12, s[40:43], s82 offen offset:3072 sc1
	buffer_load_dwordx4 v[192:195], v13, s[40:43], s82 offen sc1
	s_add_u32 s82, s82, 5120
	s_min_u32 s82, s82, s85
	s_waitcnt vmcnt(27) lgkmcnt(0)
	v_mfma_f32_16x16x32_bf16 v[64:67], v[216:219], v[144:147], v[64:67]
	v_add_u32 v18, 65536, v14
	ds_read_b64_tr_b16 v[124:125], v18 offset:0
	ds_read_b64_tr_b16 v[126:127], v18 offset:2048
	v_mfma_f32_16x16x32_bf16 v[68:71], v[220:223], v[144:147], v[68:71]
	v_add_u32 v19, 65536, v15
	ds_read_b64_tr_b16 v[128:129], v19 offset:0
	ds_read_b64_tr_b16 v[130:131], v19 offset:2048
	v_mfma_f32_16x16x32_bf16 v[72:75], v[224:227], v[144:147], v[72:75]
	v_add_u32 v20, 65536, v16
	ds_read_b64_tr_b16 v[132:133], v20 offset:0
	ds_read_b64_tr_b16 v[134:135], v20 offset:2048
	v_mfma_f32_16x16x32_bf16 v[76:79], v[228:231], v[144:147], v[76:79]
	v_add_u32 v21, 65536, v17
	ds_read_b64_tr_b16 v[136:137], v21 offset:0
	ds_read_b64_tr_b16 v[138:139], v21 offset:2048
	v_mfma_f32_16x16x32_bf16 v[80:83], v[232:235], v[144:147], v[80:83]
	v_mfma_f32_16x16x32_bf16 v[84:87], v[216:219], v[148:151], v[84:87]
	v_mfma_f32_16x16x32_bf16 v[88:91], v[220:223], v[148:151], v[88:91]
	v_mfma_f32_16x16x32_bf16 v[92:95], v[224:227], v[148:151], v[92:95]
	v_mfma_f32_16x16x32_bf16 v[96:99], v[228:231], v[148:151], v[96:99]
	v_mfma_f32_16x16x32_bf16 v[100:103], v[232:235], v[148:151], v[100:103]
	v_mfma_f32_16x16x32_bf16 v[104:107], v[216:219], v[152:155], v[104:107]
	v_mfma_f32_16x16x32_bf16 v[108:111], v[220:223], v[152:155], v[108:111]
	v_mfma_f32_16x16x32_bf16 v[112:115], v[224:227], v[152:155], v[112:115]
	v_mfma_f32_16x16x32_bf16 v[116:119], v[228:231], v[152:155], v[116:119]
	v_mfma_f32_16x16x32_bf16 v[120:123], v[232:235], v[152:155], v[120:123]
	v_mfma_f32_16x16x32_bf16 v[44:47], v[216:219], v[140:143], v[44:47]
	v_mfma_f32_16x16x32_bf16 v[48:51], v[220:223], v[140:143], v[48:51]
	v_mfma_f32_16x16x32_bf16 v[52:55], v[224:227], v[140:143], v[52:55]
	v_mfma_f32_16x16x32_bf16 v[56:59], v[228:231], v[140:143], v[56:59]
	v_mfma_f32_16x16x32_bf16 v[60:63], v[232:235], v[140:143], v[60:63]
	s_add_u32 m0, s74, 49152
	s_nop 0
	buffer_load_dwordx4 v8, s[56:59], 0 offen lds
	v_add_u32 v8, 131072, v8
	buffer_load_dwordx4 v9, s[56:59], 0 offen offset:1024 lds
	v_add_u32 v9, 131072, v9
	buffer_load_dwordx4 v10, s[56:59], 0 offen offset:2048 lds
	v_add_u32 v10, 131072, v10
	buffer_load_dwordx4 v11, s[56:59], 0 offen offset:3072 lds
	v_add_u32 v11, 131072, v11
	buffer_load_dwordx4 v[196:199], v12, s[40:43], s82 offen sc1
	buffer_load_dwordx4 v[200:203], v12, s[40:43], s82 offen offset:1024 sc1
	buffer_load_dwordx4 v[204:207], v12, s[40:43], s82 offen offset:2048 sc1
	buffer_load_dwordx4 v[208:211], v12, s[40:43], s82 offen offset:3072 sc1
	buffer_load_dwordx4 v[212:215], v13, s[40:43], s82 offen sc1
	s_add_u32 s82, s82, 5120
	s_min_u32 s82, s82, s85
	s_waitcnt vmcnt(27)
	s_waitcnt lgkmcnt(0)
	v_mfma_f32_16x16x32_bf16 v[64:67], v[236:239], v[128:131], v[64:67]
	ds_read_b64_tr_b16 v[140:141], v14 offset:0
	ds_read_b64_tr_b16 v[142:143], v14 offset:2048
	v_mfma_f32_16x16x32_bf16 v[68:71], v[240:243], v[128:131], v[68:71]
	ds_read_b64_tr_b16 v[144:145], v15 offset:0
	ds_read_b64_tr_b16 v[146:147], v15 offset:2048
	v_mfma_f32_16x16x32_bf16 v[72:75], v[244:247], v[128:131], v[72:75]
	ds_read_b64_tr_b16 v[148:149], v16 offset:0
	ds_read_b64_tr_b16 v[150:151], v16 offset:2048
	v_mfma_f32_16x16x32_bf16 v[76:79], v[248:251], v[128:131], v[76:79]
	ds_read_b64_tr_b16 v[152:153], v17 offset:0
	ds_read_b64_tr_b16 v[154:155], v17 offset:2048
	v_mfma_f32_16x16x32_bf16 v[80:83], v[252:255], v[128:131], v[80:83]
	v_mfma_f32_16x16x32_bf16 v[84:87], v[236:239], v[132:135], v[84:87]
	v_mfma_f32_16x16x32_bf16 v[88:91], v[240:243], v[132:135], v[88:91]
	v_mfma_f32_16x16x32_bf16 v[92:95], v[244:247], v[132:135], v[92:95]
	v_mfma_f32_16x16x32_bf16 v[96:99], v[248:251], v[132:135], v[96:99]
	v_mfma_f32_16x16x32_bf16 v[100:103], v[252:255], v[132:135], v[100:103]
	v_mfma_f32_16x16x32_bf16 v[104:107], v[236:239], v[136:139], v[104:107]
	v_mfma_f32_16x16x32_bf16 v[108:111], v[240:243], v[136:139], v[108:111]
	v_mfma_f32_16x16x32_bf16 v[112:115], v[244:247], v[136:139], v[112:115]
	v_mfma_f32_16x16x32_bf16 v[116:119], v[248:251], v[136:139], v[116:119]
	v_mfma_f32_16x16x32_bf16 v[120:123], v[252:255], v[136:139], v[120:123]
	v_mfma_f32_16x16x32_bf16 v[44:47], v[236:239], v[124:127], v[44:47]
	v_mfma_f32_16x16x32_bf16 v[48:51], v[240:243], v[124:127], v[48:51]
	v_mfma_f32_16x16x32_bf16 v[52:55], v[244:247], v[124:127], v[52:55]
	v_mfma_f32_16x16x32_bf16 v[56:59], v[248:251], v[124:127], v[56:59]
	v_mfma_f32_16x16x32_bf16 v[60:63], v[252:255], v[124:127], v[60:63]
	s_add_u32 m0, s74, 65536
	s_nop 0
	buffer_load_dwordx4 v8, s[56:59], 0 offen lds
	v_add_u32 v8, 131072, v8
	buffer_load_dwordx4 v9, s[56:59], 0 offen offset:1024 lds
	v_add_u32 v9, 131072, v9
	buffer_load_dwordx4 v10, s[56:59], 0 offen offset:2048 lds
	v_add_u32 v10, 131072, v10
	buffer_load_dwordx4 v11, s[56:59], 0 offen offset:3072 lds
	v_add_u32 v11, 131072, v11
	buffer_load_dwordx4 v[216:219], v12, s[40:43], s82 offen sc1
	buffer_load_dwordx4 v[220:223], v12, s[40:43], s82 offen offset:1024 sc1
	buffer_load_dwordx4 v[224:227], v12, s[40:43], s82 offen offset:2048 sc1
	buffer_load_dwordx4 v[228:231], v12, s[40:43], s82 offen offset:3072 sc1
	buffer_load_dwordx4 v[232:235], v13, s[40:43], s82 offen sc1
	s_add_u32 s82, s82, 5120
	s_min_u32 s82, s82, s85
	s_waitcnt vmcnt(32)
	s_waitcnt vmcnt(27) lgkmcnt(0)
	v_mfma_f32_16x16x32_bf16 v[64:67], v[156:159], v[144:147], v[64:67]
	ds_read_b64_tr_b16 v[124:125], v14 offset:16384
	ds_read_b64_tr_b16 v[126:127], v14 offset:18432
	v_mfma_f32_16x16x32_bf16 v[68:71], v[160:163], v[144:147], v[68:71]
	ds_read_b64_tr_b16 v[128:129], v15 offset:16384
	ds_read_b64_tr_b16 v[130:131], v15 offset:18432
	v_mfma_f32_16x16x32_bf16 v[72:75], v[164:167], v[144:147], v[72:75]
	ds_read_b64_tr_b16 v[132:133], v16 offset:16384
	ds_read_b64_tr_b16 v[134:135], v16 offset:18432
	v_mfma_f32_16x16x32_bf16 v[76:79], v[168:171], v[144:147], v[76:79]
	ds_read_b64_tr_b16 v[136:137], v17 offset:16384
	ds_read_b64_tr_b16 v[138:139], v17 offset:18432
	v_mfma_f32_16x16x32_bf16 v[80:83], v[172:175], v[144:147], v[80:83]
	v_mfma_f32_16x16x32_bf16 v[84:87], v[156:159], v[148:151], v[84:87]
	v_mfma_f32_16x16x32_bf16 v[88:91], v[160:163], v[148:151], v[88:91]
	v_mfma_f32_16x16x32_bf16 v[92:95], v[164:167], v[148:151], v[92:95]
	v_mfma_f32_16x16x32_bf16 v[96:99], v[168:171], v[148:151], v[96:99]
	v_mfma_f32_16x16x32_bf16 v[100:103], v[172:175], v[148:151], v[100:103]
	v_mfma_f32_16x16x32_bf16 v[104:107], v[156:159], v[152:155], v[104:107]
	v_mfma_f32_16x16x32_bf16 v[108:111], v[160:163], v[152:155], v[108:111]
	v_mfma_f32_16x16x32_bf16 v[112:115], v[164:167], v[152:155], v[112:115]
	v_mfma_f32_16x16x32_bf16 v[116:119], v[168:171], v[152:155], v[116:119]
	v_mfma_f32_16x16x32_bf16 v[120:123], v[172:175], v[152:155], v[120:123]
	v_mfma_f32_16x16x32_bf16 v[44:47], v[156:159], v[140:143], v[44:47]
	v_mfma_f32_16x16x32_bf16 v[48:51], v[160:163], v[140:143], v[48:51]
	v_mfma_f32_16x16x32_bf16 v[52:55], v[164:167], v[140:143], v[52:55]
	v_mfma_f32_16x16x32_bf16 v[56:59], v[168:171], v[140:143], v[56:59]
	v_mfma_f32_16x16x32_bf16 v[60:63], v[172:175], v[140:143], v[60:63]
	s_add_u32 m0, s74, 0
	s_nop 0
	buffer_load_dwordx4 v8, s[56:59], 0 offen lds
	v_add_u32 v8, 131072, v8
	buffer_load_dwordx4 v9, s[56:59], 0 offen offset:1024 lds
	v_add_u32 v9, 131072, v9
	buffer_load_dwordx4 v10, s[56:59], 0 offen offset:2048 lds
	v_add_u32 v10, 131072, v10
	buffer_load_dwordx4 v11, s[56:59], 0 offen offset:3072 lds
	v_add_u32 v11, 131072, v11
	buffer_load_dwordx4 v[236:239], v12, s[40:43], s82 offen sc1
	buffer_load_dwordx4 v[240:243], v12, s[40:43], s82 offen offset:1024 sc1
	buffer_load_dwordx4 v[244:247], v12, s[40:43], s82 offen offset:2048 sc1
	buffer_load_dwordx4 v[248:251], v12, s[40:43], s82 offen offset:3072 sc1
	buffer_load_dwordx4 v[252:255], v13, s[40:43], s82 offen sc1
	s_add_u32 s82, s82, 5120
	s_min_u32 s82, s82, s85
	s_waitcnt vmcnt(32)
	s_waitcnt vmcnt(27) lgkmcnt(0)
	v_mfma_f32_16x16x32_bf16 v[64:67], v[176:179], v[128:131], v[64:67]
	ds_read_b64_tr_b16 v[140:141], v14 offset:32768
	ds_read_b64_tr_b16 v[142:143], v14 offset:34816
	v_mfma_f32_16x16x32_bf16 v[68:71], v[180:183], v[128:131], v[68:71]
	ds_read_b64_tr_b16 v[144:145], v15 offset:32768
	ds_read_b64_tr_b16 v[146:147], v15 offset:34816
	v_mfma_f32_16x16x32_bf16 v[72:75], v[184:187], v[128:131], v[72:75]
	ds_read_b64_tr_b16 v[148:149], v16 offset:32768
	ds_read_b64_tr_b16 v[150:151], v16 offset:34816
	v_mfma_f32_16x16x32_bf16 v[76:79], v[188:191], v[128:131], v[76:79]
	ds_read_b64_tr_b16 v[152:153], v17 offset:32768
	ds_read_b64_tr_b16 v[154:155], v17 offset:34816
	v_mfma_f32_16x16x32_bf16 v[80:83], v[192:195], v[128:131], v[80:83]
	v_mfma_f32_16x16x32_bf16 v[84:87], v[176:179], v[132:135], v[84:87]
	v_mfma_f32_16x16x32_bf16 v[88:91], v[180:183], v[132:135], v[88:91]
	v_mfma_f32_16x16x32_bf16 v[92:95], v[184:187], v[132:135], v[92:95]
	v_mfma_f32_16x16x32_bf16 v[96:99], v[188:191], v[132:135], v[96:99]
	v_mfma_f32_16x16x32_bf16 v[100:103], v[192:195], v[132:135], v[100:103]
	v_mfma_f32_16x16x32_bf16 v[104:107], v[176:179], v[136:139], v[104:107]
	v_mfma_f32_16x16x32_bf16 v[108:111], v[180:183], v[136:139], v[108:111]
	v_mfma_f32_16x16x32_bf16 v[112:115], v[184:187], v[136:139], v[112:115]
	v_mfma_f32_16x16x32_bf16 v[116:119], v[188:191], v[136:139], v[116:119]
	v_mfma_f32_16x16x32_bf16 v[120:123], v[192:195], v[136:139], v[120:123]
	v_mfma_f32_16x16x32_bf16 v[44:47], v[176:179], v[124:127], v[44:47]
	v_mfma_f32_16x16x32_bf16 v[48:51], v[180:183], v[124:127], v[48:51]
	v_mfma_f32_16x16x32_bf16 v[52:55], v[184:187], v[124:127], v[52:55]
	v_mfma_f32_16x16x32_bf16 v[56:59], v[188:191], v[124:127], v[56:59]
	v_mfma_f32_16x16x32_bf16 v[60:63], v[192:195], v[124:127], v[60:63]
	s_add_u32 m0, s74, 16384
	s_nop 0
	buffer_load_dwordx4 v8, s[56:59], 0 offen lds
	v_add_u32 v8, 131072, v8
	buffer_load_dwordx4 v9, s[56:59], 0 offen offset:1024 lds
	v_add_u32 v9, 131072, v9
	buffer_load_dwordx4 v10, s[56:59], 0 offen offset:2048 lds
	v_add_u32 v10, 131072, v10
	buffer_load_dwordx4 v11, s[56:59], 0 offen offset:3072 lds
	v_add_u32 v11, 131072, v11
	buffer_load_dwordx4 v[156:159], v12, s[40:43], s82 offen sc1
	buffer_load_dwordx4 v[160:163], v12, s[40:43], s82 offen offset:1024 sc1
	buffer_load_dwordx4 v[164:167], v12, s[40:43], s82 offen offset:2048 sc1
	buffer_load_dwordx4 v[168:171], v12, s[40:43], s82 offen offset:3072 sc1
	buffer_load_dwordx4 v[172:175], v13, s[40:43], s82 offen sc1
	s_add_u32 s82, s82, 5120
	s_min_u32 s82, s82, s85
	s_waitcnt vmcnt(32)
	s_waitcnt vmcnt(27) lgkmcnt(0)
	v_mfma_f32_16x16x32_bf16 v[64:67], v[196:199], v[144:147], v[64:67]
	ds_read_b64_tr_b16 v[124:125], v14 offset:49152
	ds_read_b64_tr_b16 v[126:127], v14 offset:51200
	v_mfma_f32_16x16x32_bf16 v[68:71], v[200:203], v[144:147], v[68:71]
	ds_read_b64_tr_b16 v[128:129], v15 offset:49152
	ds_read_b64_tr_b16 v[130:131], v15 offset:51200
	v_mfma_f32_16x16x32_bf16 v[72:75], v[204:207], v[144:147], v[72:75]
	ds_read_b64_tr_b16 v[132:133], v16 offset:49152
	ds_read_b64_tr_b16 v[134:135], v16 offset:51200
	v_mfma_f32_16x16x32_bf16 v[76:79], v[208:211], v[144:147], v[76:79]
	ds_read_b64_tr_b16 v[136:137], v17 offset:49152
	ds_read_b64_tr_b16 v[138:139], v17 offset:51200
	v_mfma_f32_16x16x32_bf16 v[80:83], v[212:215], v[144:147], v[80:83]
	v_mfma_f32_16x16x32_bf16 v[84:87], v[196:199], v[148:151], v[84:87]
	v_mfma_f32_16x16x32_bf16 v[88:91], v[200:203], v[148:151], v[88:91]
	v_mfma_f32_16x16x32_bf16 v[92:95], v[204:207], v[148:151], v[92:95]
	v_mfma_f32_16x16x32_bf16 v[96:99], v[208:211], v[148:151], v[96:99]
	v_mfma_f32_16x16x32_bf16 v[100:103], v[212:215], v[148:151], v[100:103]
	v_mfma_f32_16x16x32_bf16 v[104:107], v[196:199], v[152:155], v[104:107]
	v_mfma_f32_16x16x32_bf16 v[108:111], v[200:203], v[152:155], v[108:111]
	v_mfma_f32_16x16x32_bf16 v[112:115], v[204:207], v[152:155], v[112:115]
	v_mfma_f32_16x16x32_bf16 v[116:119], v[208:211], v[152:155], v[116:119]
	v_mfma_f32_16x16x32_bf16 v[120:123], v[212:215], v[152:155], v[120:123]
	v_mfma_f32_16x16x32_bf16 v[44:47], v[196:199], v[140:143], v[44:47]
	v_mfma_f32_16x16x32_bf16 v[48:51], v[200:203], v[140:143], v[48:51]
	v_mfma_f32_16x16x32_bf16 v[52:55], v[204:207], v[140:143], v[52:55]
	v_mfma_f32_16x16x32_bf16 v[56:59], v[208:211], v[140:143], v[56:59]
	v_mfma_f32_16x16x32_bf16 v[60:63], v[212:215], v[140:143], v[60:63]
	s_add_u32 m0, s74, 32768
	s_nop 0
	buffer_load_dwordx4 v8, s[56:59], 0 offen lds
	v_add_u32 v8, 131072, v8
	buffer_load_dwordx4 v9, s[56:59], 0 offen offset:1024 lds
	v_add_u32 v9, 131072, v9
	buffer_load_dwordx4 v10, s[56:59], 0 offen offset:2048 lds
	v_add_u32 v10, 131072, v10
	buffer_load_dwordx4 v11, s[56:59], 0 offen offset:3072 lds
	v_add_u32 v11, 131072, v11
	buffer_load_dwordx4 v[176:179], v12, s[40:43], s82 offen sc1
	buffer_load_dwordx4 v[180:183], v12, s[40:43], s82 offen offset:1024 sc1
	buffer_load_dwordx4 v[184:187], v12, s[40:43], s82 offen offset:2048 sc1
	buffer_load_dwordx4 v[188:191], v12, s[40:43], s82 offen offset:3072 sc1
	buffer_load_dwordx4 v[192:195], v13, s[40:43], s82 offen sc1
	s_add_u32 s82, s82, 5120
	s_min_u32 s82, s82, s85
	s_waitcnt vmcnt(32)
	s_waitcnt vmcnt(27) lgkmcnt(0)
	v_mfma_f32_16x16x32_bf16 v[64:67], v[216:219], v[128:131], v[64:67]
	v_add_u32 v18, 65536, v14
	ds_read_b64_tr_b16 v[140:141], v18 offset:0
	ds_read_b64_tr_b16 v[142:143], v18 offset:2048
	v_mfma_f32_16x16x32_bf16 v[68:71], v[220:223], v[128:131], v[68:71]
	v_add_u32 v19, 65536, v15
	ds_read_b64_tr_b16 v[144:145], v19 offset:0
	ds_read_b64_tr_b16 v[146:147], v19 offset:2048
	v_mfma_f32_16x16x32_bf16 v[72:75], v[224:227], v[128:131], v[72:75]
	v_add_u32 v20, 65536, v16
	ds_read_b64_tr_b16 v[148:149], v20 offset:0
	ds_read_b64_tr_b16 v[150:151], v20 offset:2048
	v_mfma_f32_16x16x32_bf16 v[76:79], v[228:231], v[128:131], v[76:79]
	v_add_u32 v21, 65536, v17
	ds_read_b64_tr_b16 v[152:153], v21 offset:0
	ds_read_b64_tr_b16 v[154:155], v21 offset:2048
	v_mfma_f32_16x16x32_bf16 v[80:83], v[232:235], v[128:131], v[80:83]
	v_mfma_f32_16x16x32_bf16 v[84:87], v[216:219], v[132:135], v[84:87]
	v_mfma_f32_16x16x32_bf16 v[88:91], v[220:223], v[132:135], v[88:91]
	v_mfma_f32_16x16x32_bf16 v[92:95], v[224:227], v[132:135], v[92:95]
	v_mfma_f32_16x16x32_bf16 v[96:99], v[228:231], v[132:135], v[96:99]
	v_mfma_f32_16x16x32_bf16 v[100:103], v[232:235], v[132:135], v[100:103]
	v_mfma_f32_16x16x32_bf16 v[104:107], v[216:219], v[136:139], v[104:107]
	v_mfma_f32_16x16x32_bf16 v[108:111], v[220:223], v[136:139], v[108:111]
	v_mfma_f32_16x16x32_bf16 v[112:115], v[224:227], v[136:139], v[112:115]
	v_mfma_f32_16x16x32_bf16 v[116:119], v[228:231], v[136:139], v[116:119]
	v_mfma_f32_16x16x32_bf16 v[120:123], v[232:235], v[136:139], v[120:123]
	v_mfma_f32_16x16x32_bf16 v[44:47], v[216:219], v[124:127], v[44:47]
	v_mfma_f32_16x16x32_bf16 v[48:51], v[220:223], v[124:127], v[48:51]
	v_mfma_f32_16x16x32_bf16 v[52:55], v[224:227], v[124:127], v[52:55]
	v_mfma_f32_16x16x32_bf16 v[56:59], v[228:231], v[124:127], v[56:59]
	v_mfma_f32_16x16x32_bf16 v[60:63], v[232:235], v[124:127], v[60:63]
	s_add_u32 m0, s74, 49152
	s_nop 0
	buffer_load_dwordx4 v8, s[56:59], 0 offen lds
	v_add_u32 v8, 131072, v8
	buffer_load_dwordx4 v9, s[56:59], 0 offen offset:1024 lds
	v_add_u32 v9, 131072, v9
	buffer_load_dwordx4 v10, s[56:59], 0 offen offset:2048 lds
	v_add_u32 v10, 131072, v10
	buffer_load_dwordx4 v11, s[56:59], 0 offen offset:3072 lds
	v_add_u32 v11, 131072, v11
	buffer_load_dwordx4 v[196:199], v12, s[40:43], s82 offen sc1
	buffer_load_dwordx4 v[200:203], v12, s[40:43], s82 offen offset:1024 sc1
	buffer_load_dwordx4 v[204:207], v12, s[40:43], s82 offen offset:2048 sc1
	buffer_load_dwordx4 v[208:211], v12, s[40:43], s82 offen offset:3072 sc1
	buffer_load_dwordx4 v[212:215], v13, s[40:43], s82 offen sc1
	s_add_u32 s82, s82, 5120
	s_min_u32 s82, s82, s85
	s_waitcnt vmcnt(32)
	s_waitcnt vmcnt(27) lgkmcnt(0)
	v_mfma_f32_16x16x32_bf16 v[64:67], v[236:239], v[144:147], v[64:67]
	ds_read_b64_tr_b16 v[124:125], v14 offset:0
	ds_read_b64_tr_b16 v[126:127], v14 offset:2048
	v_mfma_f32_16x16x32_bf16 v[68:71], v[240:243], v[144:147], v[68:71]
	ds_read_b64_tr_b16 v[128:129], v15 offset:0
	ds_read_b64_tr_b16 v[130:131], v15 offset:2048
	v_mfma_f32_16x16x32_bf16 v[72:75], v[244:247], v[144:147], v[72:75]
	ds_read_b64_tr_b16 v[132:133], v16 offset:0
	ds_read_b64_tr_b16 v[134:135], v16 offset:2048
	v_mfma_f32_16x16x32_bf16 v[76:79], v[248:251], v[144:147], v[76:79]
	ds_read_b64_tr_b16 v[136:137], v17 offset:0
	ds_read_b64_tr_b16 v[138:139], v17 offset:2048
	v_mfma_f32_16x16x32_bf16 v[80:83], v[252:255], v[144:147], v[80:83]
	v_mfma_f32_16x16x32_bf16 v[84:87], v[236:239], v[148:151], v[84:87]
	v_mfma_f32_16x16x32_bf16 v[88:91], v[240:243], v[148:151], v[88:91]
	v_mfma_f32_16x16x32_bf16 v[92:95], v[244:247], v[148:151], v[92:95]
	v_mfma_f32_16x16x32_bf16 v[96:99], v[248:251], v[148:151], v[96:99]
	v_mfma_f32_16x16x32_bf16 v[100:103], v[252:255], v[148:151], v[100:103]
	v_mfma_f32_16x16x32_bf16 v[104:107], v[236:239], v[152:155], v[104:107]
	v_mfma_f32_16x16x32_bf16 v[108:111], v[240:243], v[152:155], v[108:111]
	v_mfma_f32_16x16x32_bf16 v[112:115], v[244:247], v[152:155], v[112:115]
	v_mfma_f32_16x16x32_bf16 v[116:119], v[248:251], v[152:155], v[116:119]
	v_mfma_f32_16x16x32_bf16 v[120:123], v[252:255], v[152:155], v[120:123]
	v_mfma_f32_16x16x32_bf16 v[44:47], v[236:239], v[140:143], v[44:47]
	v_mfma_f32_16x16x32_bf16 v[48:51], v[240:243], v[140:143], v[48:51]
	v_mfma_f32_16x16x32_bf16 v[52:55], v[244:247], v[140:143], v[52:55]
	v_mfma_f32_16x16x32_bf16 v[56:59], v[248:251], v[140:143], v[56:59]
	v_mfma_f32_16x16x32_bf16 v[60:63], v[252:255], v[140:143], v[60:63]
	buffer_load_dword v35, v34, s[40:43], 0 offen sc1
	buffer_load_dwordx4 v[216:219], v12, s[40:43], s82 offen sc1
	buffer_load_dwordx4 v[220:223], v12, s[40:43], s82 offen offset:1024 sc1
	buffer_load_dwordx4 v[224:227], v12, s[40:43], s82 offen offset:2048 sc1
	buffer_load_dwordx4 v[228:231], v12, s[40:43], s82 offen offset:3072 sc1
	buffer_load_dwordx4 v[232:235], v13, s[40:43], s82 offen sc1
	s_add_u32 s82, s82, 5120
	s_min_u32 s82, s82, s85
	s_waitcnt vmcnt(29)
	s_waitcnt vmcnt(24) lgkmcnt(0)
	v_mfma_f32_16x16x32_bf16 v[64:67], v[156:159], v[128:131], v[64:67]
	ds_read_b64_tr_b16 v[140:141], v14 offset:16384
	ds_read_b64_tr_b16 v[142:143], v14 offset:18432
	v_mfma_f32_16x16x32_bf16 v[68:71], v[160:163], v[128:131], v[68:71]
	ds_read_b64_tr_b16 v[144:145], v15 offset:16384
	ds_read_b64_tr_b16 v[146:147], v15 offset:18432
	v_mfma_f32_16x16x32_bf16 v[72:75], v[164:167], v[128:131], v[72:75]
	ds_read_b64_tr_b16 v[148:149], v16 offset:16384
	ds_read_b64_tr_b16 v[150:151], v16 offset:18432
	v_mfma_f32_16x16x32_bf16 v[76:79], v[168:171], v[128:131], v[76:79]
	ds_read_b64_tr_b16 v[152:153], v17 offset:16384
	ds_read_b64_tr_b16 v[154:155], v17 offset:18432
	v_mfma_f32_16x16x32_bf16 v[80:83], v[172:175], v[128:131], v[80:83]
	v_mfma_f32_16x16x32_bf16 v[84:87], v[156:159], v[132:135], v[84:87]
	v_mfma_f32_16x16x32_bf16 v[88:91], v[160:163], v[132:135], v[88:91]
	v_mfma_f32_16x16x32_bf16 v[92:95], v[164:167], v[132:135], v[92:95]
	v_mfma_f32_16x16x32_bf16 v[96:99], v[168:171], v[132:135], v[96:99]
	v_mfma_f32_16x16x32_bf16 v[100:103], v[172:175], v[132:135], v[100:103]
	v_mfma_f32_16x16x32_bf16 v[104:107], v[156:159], v[136:139], v[104:107]
	v_mfma_f32_16x16x32_bf16 v[108:111], v[160:163], v[136:139], v[108:111]
	v_mfma_f32_16x16x32_bf16 v[112:115], v[164:167], v[136:139], v[112:115]
	v_mfma_f32_16x16x32_bf16 v[116:119], v[168:171], v[136:139], v[116:119]
	v_mfma_f32_16x16x32_bf16 v[120:123], v[172:175], v[136:139], v[120:123]
	v_mfma_f32_16x16x32_bf16 v[44:47], v[156:159], v[124:127], v[44:47]
	v_mfma_f32_16x16x32_bf16 v[48:51], v[160:163], v[124:127], v[48:51]
	v_mfma_f32_16x16x32_bf16 v[52:55], v[164:167], v[124:127], v[52:55]
	v_mfma_f32_16x16x32_bf16 v[56:59], v[168:171], v[124:127], v[56:59]
	v_mfma_f32_16x16x32_bf16 v[60:63], v[172:175], v[124:127], v[60:63]
	s_mul_i32 s4, s68, 74
	s_mul_i32 s5, s3, 5
	s_add_u32 s4, s4, s5
	s_add_u32 s4, s4, 54
	s_mul_i32 s4, s4, 5120
	s_add_u32 s82, s4, 2621440
	buffer_load_dwordx4 v[236:239], v12, s[40:43], s82 offen sc1
	buffer_load_dwordx4 v[240:243], v12, s[40:43], s82 offen offset:1024 sc1
	buffer_load_dwordx4 v[244:247], v12, s[40:43], s82 offen offset:2048 sc1
	buffer_load_dwordx4 v[248:251], v12, s[40:43], s82 offen offset:3072 sc1
	buffer_load_dwordx4 v[252:255], v13, s[40:43], s82 offen sc1
	s_add_u32 s82, s82, 5120
	s_waitcnt vmcnt(25)
	s_waitcnt vmcnt(20) lgkmcnt(0)
	v_mfma_f32_16x16x32_bf16 v[64:67], v[176:179], v[144:147], v[64:67]
	ds_read_b64_tr_b16 v[124:125], v14 offset:32768
	ds_read_b64_tr_b16 v[126:127], v14 offset:34816
	v_mfma_f32_16x16x32_bf16 v[68:71], v[180:183], v[144:147], v[68:71]
	ds_read_b64_tr_b16 v[128:129], v15 offset:32768
	ds_read_b64_tr_b16 v[130:131], v15 offset:34816
	v_mfma_f32_16x16x32_bf16 v[72:75], v[184:187], v[144:147], v[72:75]
	ds_read_b64_tr_b16 v[132:133], v16 offset:32768
	ds_read_b64_tr_b16 v[134:135], v16 offset:34816
	v_mfma_f32_16x16x32_bf16 v[76:79], v[188:191], v[144:147], v[76:79]
	ds_read_b64_tr_b16 v[136:137], v17 offset:32768
	ds_read_b64_tr_b16 v[138:139], v17 offset:34816
	v_mfma_f32_16x16x32_bf16 v[80:83], v[192:195], v[144:147], v[80:83]
	v_mfma_f32_16x16x32_bf16 v[84:87], v[176:179], v[148:151], v[84:87]
	v_mfma_f32_16x16x32_bf16 v[88:91], v[180:183], v[148:151], v[88:91]
	v_mfma_f32_16x16x32_bf16 v[92:95], v[184:187], v[148:151], v[92:95]
	v_mfma_f32_16x16x32_bf16 v[96:99], v[188:191], v[148:151], v[96:99]
	v_mfma_f32_16x16x32_bf16 v[100:103], v[192:195], v[148:151], v[100:103]
	v_mfma_f32_16x16x32_bf16 v[104:107], v[176:179], v[152:155], v[104:107]
	v_mfma_f32_16x16x32_bf16 v[108:111], v[180:183], v[152:155], v[108:111]
	v_mfma_f32_16x16x32_bf16 v[112:115], v[184:187], v[152:155], v[112:115]
	v_mfma_f32_16x16x32_bf16 v[116:119], v[188:191], v[152:155], v[116:119]
	v_mfma_f32_16x16x32_bf16 v[120:123], v[192:195], v[152:155], v[120:123]
	v_mfma_f32_16x16x32_bf16 v[44:47], v[176:179], v[140:143], v[44:47]
	v_mfma_f32_16x16x32_bf16 v[48:51], v[180:183], v[140:143], v[48:51]
	v_mfma_f32_16x16x32_bf16 v[52:55], v[184:187], v[140:143], v[52:55]
	v_mfma_f32_16x16x32_bf16 v[56:59], v[188:191], v[140:143], v[56:59]
	v_mfma_f32_16x16x32_bf16 v[60:63], v[192:195], v[140:143], v[60:63]
	s_waitcnt vmcnt(10)
	v_cmp_ne_u32 vcc, s75, v35
	s_nop 5
	s_cbranch_vccz L_ok_25
	s_mov_b32 s84, 0
L_poll_26:
	s_sleep 2
	buffer_load_dword v35, v34, s[40:43], 0 offen sc1
	s_waitcnt vmcnt(0)
	v_cmp_ne_u32 vcc, s75, v35
	s_nop 4
	s_cbranch_vccz L_ok_25
	s_add_u32 s84, s84, 1
	s_cmp_lt_u32 s84, 0x8000
	s_cbranch_scc1 L_poll_26
L_ok_25:
	buffer_load_dwordx4 v[156:159], v28, s[40:43], s11 offen sc1
	buffer_load_dwordx4 v[160:163], v29, s[40:43], s11 offen sc1
	buffer_load_dwordx4 v[164:167], v30, s[40:43], s11 offen sc1
	buffer_load_dwordx4 v[168:171], v31, s[40:43], s11 offen sc1
	s_add_u32 s11, s11, 4096
	buffer_load_dwordx4 v[172:175], v12, s[40:43], s82 offen sc1
	s_waitcnt lgkmcnt(0)
	v_mfma_f32_16x16x32_bf16 v[64:67], v[196:199], v[128:131], v[64:67]
	ds_read_b64_tr_b16 v[140:141], v14 offset:49152
	ds_read_b64_tr_b16 v[142:143], v14 offset:51200
	v_mfma_f32_16x16x32_bf16 v[68:71], v[200:203], v[128:131], v[68:71]
	ds_read_b64_tr_b16 v[144:145], v15 offset:49152
	ds_read_b64_tr_b16 v[146:147], v15 offset:51200
	v_mfma_f32_16x16x32_bf16 v[72:75], v[204:207], v[128:131], v[72:75]
	ds_read_b64_tr_b16 v[148:149], v16 offset:49152
	ds_read_b64_tr_b16 v[150:151], v16 offset:51200
	v_mfma_f32_16x16x32_bf16 v[76:79], v[208:211], v[128:131], v[76:79]
	ds_read_b64_tr_b16 v[152:153], v17 offset:49152
	ds_read_b64_tr_b16 v[154:155], v17 offset:51200
	v_mfma_f32_16x16x32_bf16 v[80:83], v[212:215], v[128:131], v[80:83]
	v_mfma_f32_16x16x32_bf16 v[84:87], v[196:199], v[132:135], v[84:87]
	v_mfma_f32_16x16x32_bf16 v[88:91], v[200:203], v[132:135], v[88:91]
	v_mfma_f32_16x16x32_bf16 v[92:95], v[204:207], v[132:135], v[92:95]
	v_mfma_f32_16x16x32_bf16 v[96:99], v[208:211], v[132:135], v[96:99]
	v_mfma_f32_16x16x32_bf16 v[100:103], v[212:215], v[132:135], v[100:103]
	v_mfma_f32_16x16x32_bf16 v[104:107], v[196:199], v[136:139], v[104:107]
	v_mfma_f32_16x16x32_bf16 v[108:111], v[200:203], v[136:139], v[108:111]
	v_mfma_f32_16x16x32_bf16 v[112:115], v[204:207], v[136:139], v[112:115]
	v_mfma_f32_16x16x32_bf16 v[116:119], v[208:211], v[136:139], v[116:119]
	v_mfma_f32_16x16x32_bf16 v[120:123], v[212:215], v[136:139], v[120:123]
	v_mfma_f32_16x16x32_bf16 v[44:47], v[196:199], v[124:127], v[44:47]
	v_mfma_f32_16x16x32_bf16 v[48:51], v[200:203], v[124:127], v[48:51]
	v_mfma_f32_16x16x32_bf16 v[52:55], v[204:207], v[124:127], v[52:55]
	v_mfma_f32_16x16x32_bf16 v[56:59], v[208:211], v[124:127], v[56:59]
	v_mfma_f32_16x16x32_bf16 v[60:63], v[212:215], v[124:127], v[60:63]
	buffer_load_dwordx4 v[176:179], v12, s[40:43], s82 offen offset:1024 sc1
	buffer_load_dwordx4 v[180:183], v12, s[40:43], s82 offen offset:2048 sc1
	buffer_load_dwordx4 v[184:187], v12, s[40:43], s82 offen offset:3072 sc1
	buffer_load_dwordx4 v[188:191], v13, s[40:43], s82 offen sc1
	s_add_u32 s82, s82, 5120
	buffer_load_dwordx4 v[192:195], v28, s[40:43], s11 offen sc1
	s_waitcnt vmcnt(15) lgkmcnt(0)
	v_mfma_f32_16x16x32_bf16 v[64:67], v[216:219], v[144:147], v[64:67]
	v_mfma_f32_16x16x32_bf16 v[68:71], v[220:223], v[144:147], v[68:71]
	v_mfma_f32_16x16x32_bf16 v[72:75], v[224:227], v[144:147], v[72:75]
	v_mfma_f32_16x16x32_bf16 v[76:79], v[228:231], v[144:147], v[76:79]
	v_mfma_f32_16x16x32_bf16 v[80:83], v[232:235], v[144:147], v[80:83]
	v_mfma_f32_16x16x32_bf16 v[84:87], v[216:219], v[148:151], v[84:87]
	v_mfma_f32_16x16x32_bf16 v[88:91], v[220:223], v[148:151], v[88:91]
	v_mfma_f32_16x16x32_bf16 v[92:95], v[224:227], v[148:151], v[92:95]
	v_mfma_f32_16x16x32_bf16 v[96:99], v[228:231], v[148:151], v[96:99]
	v_mfma_f32_16x16x32_bf16 v[100:103], v[232:235], v[148:151], v[100:103]
	v_mfma_f32_16x16x32_bf16 v[104:107], v[216:219], v[152:155], v[104:107]
	v_mfma_f32_16x16x32_bf16 v[108:111], v[220:223], v[152:155], v[108:111]
	v_mfma_f32_16x16x32_bf16 v[112:115], v[224:227], v[152:155], v[112:115]
	v_mfma_f32_16x16x32_bf16 v[116:119], v[228:231], v[152:155], v[116:119]
	v_mfma_f32_16x16x32_bf16 v[120:123], v[232:235], v[152:155], v[120:123]
	v_mfma_f32_16x16x32_bf16 v[44:47], v[216:219], v[140:143], v[44:47]
	v_mfma_f32_16x16x32_bf16 v[48:51], v[220:223], v[140:143], v[48:51]
	v_mfma_f32_16x16x32_bf16 v[52:55], v[224:227], v[140:143], v[52:55]
	v_mfma_f32_16x16x32_bf16 v[56:59], v[228:231], v[140:143], v[56:59]
	v_mfma_f32_16x16x32_bf16 v[60:63], v[232:235], v[140:143], v[60:63]
	buffer_load_dwordx4 v[196:199], v29, s[40:43], s11 offen sc1
	buffer_load_dwordx4 v[200:203], v30, s[40:43], s11 offen sc1
	buffer_load_dwordx4 v[204:207], v31, s[40:43], s11 offen sc1
	s_add_u32 s11, s11, 4096
	buffer_load_dwordx4 v[208:211], v12, s[40:43], s82 offen sc1
	buffer_load_dwordx4 v[212:215], v12, s[40:43], s82 offen offset:1024 sc1
	buffer_load_dwordx4 v[124:127], v12, s[40:43], s82 offen offset:2048 sc1
	buffer_load_dwordx4 v[128:131], v12, s[40:43], s82 offen offset:3072 sc1
	buffer_load_dwordx4 v[132:135], v13, s[40:43], s82 offen sc1
	s_add_u32 s82, s82, 5120
	v_lshlrev_b32 v24, 3, v1
	v_sub_u32 v24, v28, v24
	buffer_load_dwordx2 v[136:137], v24, s[40:43], s11 offen sc1
	buffer_load_dwordx2 v[138:139], v24, s[40:43], s11 offen offset:512 sc1
	s_waitcnt vmcnt(16)
	v_mfma_f32_16x16x32_bf16 v[64:67], v[236:239], v[160:163], v[64:67]
	v_mfma_f32_16x16x32_bf16 v[68:71], v[240:243], v[160:163], v[68:71]
	v_mfma_f32_16x16x32_bf16 v[72:75], v[244:247], v[160:163], v[72:75]
	v_mfma_f32_16x16x32_bf16 v[76:79], v[248:251], v[160:163], v[76:79]
	v_mfma_f32_16x16x32_bf16 v[80:83], v[252:255], v[160:163], v[80:83]
	v_mfma_f32_16x16x32_bf16 v[84:87], v[236:239], v[164:167], v[84:87]
	v_mfma_f32_16x16x32_bf16 v[88:91], v[240:243], v[164:167], v[88:91]
	v_mfma_f32_16x16x32_bf16 v[92:95], v[244:247], v[164:167], v[92:95]
	v_mfma_f32_16x16x32_bf16 v[96:99], v[248:251], v[164:167], v[96:99]
	v_mfma_f32_16x16x32_bf16 v[100:103], v[252:255], v[164:167], v[100:103]
	v_mfma_f32_16x16x32_bf16 v[104:107], v[236:239], v[168:171], v[104:107]
	v_mfma_f32_16x16x32_bf16 v[108:111], v[240:243], v[168:171], v[108:111]
	v_mfma_f32_16x16x32_bf16 v[112:115], v[244:247], v[168:171], v[112:115]
	v_mfma_f32_16x16x32_bf16 v[116:119], v[248:251], v[168:171], v[116:119]
	v_mfma_f32_16x16x32_bf16 v[120:123], v[252:255], v[168:171], v[120:123]
	v_mfma_f32_16x16x32_bf16 v[44:47], v[236:239], v[156:159], v[44:47]
	v_mfma_f32_16x16x32_bf16 v[48:51], v[240:243], v[156:159], v[48:51]
	v_mfma_f32_16x16x32_bf16 v[52:55], v[244:247], v[156:159], v[52:55]
	v_mfma_f32_16x16x32_bf16 v[56:59], v[248:251], v[156:159], v[56:59]
	v_mfma_f32_16x16x32_bf16 v[60:63], v[252:255], v[156:159], v[60:63]
	v_lshlrev_b32 v24, 3, v1
	v_sub_u32 v24, v29, v24
	buffer_load_dwordx2 v[216:217], v24, s[40:43], s11 offen sc1
	buffer_load_dwordx2 v[218:219], v24, s[40:43], s11 offen offset:512 sc1
	v_lshlrev_b32 v24, 3, v1
	v_sub_u32 v24, v30, v24
	buffer_load_dwordx2 v[220:221], v24, s[40:43], s11 offen sc1
	buffer_load_dwordx2 v[222:223], v24, s[40:43], s11 offen offset:512 sc1
	v_lshlrev_b32 v24, 3, v1
	v_sub_u32 v24, v31, v24
	buffer_load_dwordx2 v[224:225], v24, s[40:43], s11 offen sc1
	buffer_load_dwordx2 v[226:227], v24, s[40:43], s11 offen offset:512 sc1
	s_add_u32 s11, s11, 4096
	buffer_load_dwordx4 v[228:231], v12, s[40:43], s82 offen sc1
	buffer_load_dwordx4 v[232:235], v12, s[40:43], s82 offen offset:1024 sc1
	buffer_load_dwordx4 v[140:143], v12, s[40:43], s82 offen offset:2048 sc1
	buffer_load_dwordx4 v[144:147], v12, s[40:43], s82 offen offset:3072 sc1
	buffer_load_dwordx4 v[148:151], v13, s[40:43], s82 offen sc1
	s_add_u32 s82, s82, 5120
	buffer_load_dwordx4 v[152:155], v28, s[40:43], s11 offen sc1
	s_waitcnt vmcnt(19)
	v_mfma_f32_16x16x32_bf16 v[64:67], v[172:175], v[196:199], v[64:67]
	v_mfma_f32_16x16x32_bf16 v[68:71], v[176:179], v[196:199], v[68:71]
	v_mfma_f32_16x16x32_bf16 v[72:75], v[180:183], v[196:199], v[72:75]
	v_mfma_f32_16x16x32_bf16 v[76:79], v[184:187], v[196:199], v[76:79]
	v_mfma_f32_16x16x32_bf16 v[80:83], v[188:191], v[196:199], v[80:83]
	v_mfma_f32_16x16x32_bf16 v[84:87], v[172:175], v[200:203], v[84:87]
	v_mfma_f32_16x16x32_bf16 v[88:91], v[176:179], v[200:203], v[88:91]
	v_mfma_f32_16x16x32_bf16 v[92:95], v[180:183], v[200:203], v[92:95]
	v_mfma_f32_16x16x32_bf16 v[96:99], v[184:187], v[200:203], v[96:99]
	v_mfma_f32_16x16x32_bf16 v[100:103], v[188:191], v[200:203], v[100:103]
	v_mfma_f32_16x16x32_bf16 v[104:107], v[172:175], v[204:207], v[104:107]
	v_mfma_f32_16x16x32_bf16 v[108:111], v[176:179], v[204:207], v[108:111]
	v_mfma_f32_16x16x32_bf16 v[112:115], v[180:183], v[204:207], v[112:115]
	v_mfma_f32_16x16x32_bf16 v[116:119], v[184:187], v[204:207], v[116:119]
	v_mfma_f32_16x16x32_bf16 v[120:123], v[188:191], v[204:207], v[120:123]
	v_mfma_f32_16x16x32_bf16 v[44:47], v[172:175], v[192:195], v[44:47]
	v_mfma_f32_16x16x32_bf16 v[48:51], v[176:179], v[192:195], v[48:51]
	v_mfma_f32_16x16x32_bf16 v[52:55], v[180:183], v[192:195], v[52:55]
	v_mfma_f32_16x16x32_bf16 v[56:59], v[184:187], v[192:195], v[56:59]
	v_mfma_f32_16x16x32_bf16 v[60:63], v[188:191], v[192:195], v[60:63]
	buffer_load_dwordx4 v[236:239], v29, s[40:43], s11 offen sc1
	buffer_load_dwordx4 v[240:243], v30, s[40:43], s11 offen sc1
	buffer_load_dwordx4 v[244:247], v31, s[40:43], s11 offen sc1
	s_add_u32 s11, s11, 4096
	buffer_load_dwordx4 v[248:251], v12, s[40:43], s82 offen sc1
	buffer_load_dwordx4 v[252:255], v12, s[40:43], s82 offen offset:1024 sc1
	buffer_load_dwordx4 v[156:159], v12, s[40:43], s82 offen offset:2048 sc1
	buffer_load_dwordx4 v[160:163], v12, s[40:43], s82 offen offset:3072 sc1
	buffer_load_dwordx4 v[164:167], v13, s[40:43], s82 offen sc1
	s_add_u32 s82, s82, 5120
	buffer_load_dwordx4 v[168:171], v28, s[40:43], s11 offen sc1
	s_waitcnt vmcnt(15)
	s_barrier
	v_mfma_f32_16x16x32_bf16 v[64:67], v[208:211], v[216:219], v[64:67]
	v_mfma_f32_16x16x32_bf16 v[68:71], v[212:215], v[216:219], v[68:71]
	v_mfma_f32_16x16x32_bf16 v[72:75], v[124:127], v[216:219], v[72:75]
	v_mfma_f32_16x16x32_bf16 v[76:79], v[128:131], v[216:219], v[76:79]
	v_mfma_f32_16x16x32_bf16 v[80:83], v[132:135], v[216:219], v[80:83]
	v_mfma_f32_16x16x32_bf16 v[84:87], v[208:211], v[220:223], v[84:87]
	v_mfma_f32_16x16x32_bf16 v[88:91], v[212:215], v[220:223], v[88:91]
	v_mfma_f32_16x16x32_bf16 v[92:95], v[124:127], v[220:223], v[92:95]
	v_mfma_f32_16x16x32_bf16 v[96:99], v[128:131], v[220:223], v[96:99]
	v_mfma_f32_16x16x32_bf16 v[100:103], v[132:135], v[220:223], v[100:103]
	v_mfma_f32_16x16x32_bf16 v[104:107], v[208:211], v[224:227], v[104:107]
	v_mfma_f32_16x16x32_bf16 v[108:111], v[212:215], v[224:227], v[108:111]
	v_mfma_f32_16x16x32_bf16 v[112:115], v[124:127], v[224:227], v[112:115]
	v_mfma_f32_16x16x32_bf16 v[116:119], v[128:131], v[224:227], v[116:119]
	v_mfma_f32_16x16x32_bf16 v[120:123], v[132:135], v[224:227], v[120:123]
	v_mfma_f32_16x16x32_bf16 v[44:47], v[208:211], v[136:139], v[44:47]
	v_mfma_f32_16x16x32_bf16 v[48:51], v[212:215], v[136:139], v[48:51]
	v_mfma_f32_16x16x32_bf16 v[52:55], v[124:127], v[136:139], v[52:55]
	v_mfma_f32_16x16x32_bf16 v[56:59], v[128:131], v[136:139], v[56:59]
	v_mfma_f32_16x16x32_bf16 v[60:63], v[132:135], v[136:139], v[60:63]
	buffer_load_dwordx4 v[172:175], v29, s[40:43], s11 offen sc1
	buffer_load_dwordx4 v[176:179], v30, s[40:43], s11 offen sc1
	buffer_load_dwordx4 v[180:183], v31, s[40:43], s11 offen sc1
	s_add_u32 s11, s11, 4096
	s_waitcnt vmcnt(9)
	v_mfma_f32_16x16x32_bf16 v[64:67], v[228:231], v[236:239], v[64:67]
	v_mfma_f32_16x16x32_bf16 v[68:71], v[232:235], v[236:239], v[68:71]
	v_mfma_f32_16x16x32_bf16 v[72:75], v[140:143], v[236:239], v[72:75]
	v_mfma_f32_16x16x32_bf16 v[76:79], v[144:147], v[236:239], v[76:79]
	v_mfma_f32_16x16x32_bf16 v[80:83], v[148:151], v[236:239], v[80:83]
	v_mfma_f32_16x16x32_bf16 v[84:87], v[228:231], v[240:243], v[84:87]
	v_mfma_f32_16x16x32_bf16 v[88:91], v[232:235], v[240:243], v[88:91]
	v_mfma_f32_16x16x32_bf16 v[92:95], v[140:143], v[240:243], v[92:95]
	v_mfma_f32_16x16x32_bf16 v[96:99], v[144:147], v[240:243], v[96:99]
	v_mfma_f32_16x16x32_bf16 v[100:103], v[148:151], v[240:243], v[100:103]
	v_mfma_f32_16x16x32_bf16 v[104:107], v[228:231], v[244:247], v[104:107]
	v_mfma_f32_16x16x32_bf16 v[108:111], v[232:235], v[244:247], v[108:111]
	v_mfma_f32_16x16x32_bf16 v[112:115], v[140:143], v[244:247], v[112:115]
	v_mfma_f32_16x16x32_bf16 v[116:119], v[144:147], v[244:247], v[116:119]
	v_mfma_f32_16x16x32_bf16 v[120:123], v[148:151], v[244:247], v[120:123]
	v_mfma_f32_16x16x32_bf16 v[44:47], v[228:231], v[152:155], v[44:47]
	v_mfma_f32_16x16x32_bf16 v[48:51], v[232:235], v[152:155], v[48:51]
	v_mfma_f32_16x16x32_bf16 v[52:55], v[140:143], v[152:155], v[52:55]
	v_mfma_f32_16x16x32_bf16 v[56:59], v[144:147], v[152:155], v[56:59]
	v_mfma_f32_16x16x32_bf16 v[60:63], v[148:151], v[152:155], v[60:63]
	s_waitcnt vmcnt(0)
	s_mul_i32 s7, s91, 102400
	s_xor_b32 s4, s3, 1
	s_mul_i32 s4, s4, 15360
	s_add_u32 s4, s4, 0
	s_add_u32 s4, s4, s7
	v_add_u32 v25, s4, v12
	s_xor_b32 s4, s3, 2
	s_mul_i32 s4, s4, 15360
	s_add_u32 s4, s4, 5120
	s_add_u32 s4, s4, s7
	v_add_u32 v26, s4, v12
	s_xor_b32 s4, s3, 3
	s_mul_i32 s4, s4, 15360
	s_add_u32 s4, s4, 10240
	s_add_u32 s4, s4, s7
	v_add_u32 v27, s4, v12
	v_mfma_f32_16x16x32_bf16 v[64:67], v[248:251], v[172:175], v[64:67]
	v_mfma_f32_16x16x32_bf16 v[68:71], v[252:255], v[172:175], v[68:71]
	v_mfma_f32_16x16x32_bf16 v[72:75], v[156:159], v[172:175], v[72:75]
	v_mfma_f32_16x16x32_bf16 v[76:79], v[160:163], v[172:175], v[76:79]
	v_mfma_f32_16x16x32_bf16 v[80:83], v[164:167], v[172:175], v[80:83]
	v_mfma_f32_16x16x32_bf16 v[84:87], v[248:251], v[176:179], v[84:87]
	s_nop 2
	ds_write_b128 v25, v[64:67] offset:0
	v_mfma_f32_16x16x32_bf16 v[88:91], v[252:255], v[176:179], v[88:91]
	ds_write_b128 v25, v[68:71] offset:1024
	v_mfma_f32_16x16x32_bf16 v[92:95], v[156:159], v[176:179], v[92:95]
	ds_write_b128 v25, v[72:75] offset:2048
	v_mfma_f32_16x16x32_bf16 v[96:99], v[160:163], v[176:179], v[96:99]
	ds_write_b128 v25, v[76:79] offset:3072
	v_mfma_f32_16x16x32_bf16 v[100:103], v[164:167], v[176:179], v[100:103]
	ds_write_b128 v25, v[80:83] offset:4096
	v_mfma_f32_16x16x32_bf16 v[104:107], v[248:251], v[180:183], v[104:107]
	ds_write_b128 v26, v[84:87] offset:0
	v_mfma_f32_16x16x32_bf16 v[108:111], v[252:255], v[180:183], v[108:111]
	ds_write_b128 v26, v[88:91] offset:1024
	v_mfma_f32_16x16x32_bf16 v[112:115], v[156:159], v[180:183], v[112:115]
	ds_write_b128 v26, v[92:95] offset:2048
	v_mfma_f32_16x16x32_bf16 v[116:119], v[160:163], v[180:183], v[116:119]
	ds_write_b128 v26, v[96:99] offset:3072
	v_mfma_f32_16x16x32_bf16 v[120:123], v[164:167], v[180:183], v[120:123]
	ds_write_b128 v26, v[100:103] offset:4096
	v_mfma_f32_16x16x32_bf16 v[44:47], v[248:251], v[168:171], v[44:47]
	ds_write_b128 v27, v[104:107] offset:0
	v_mfma_f32_16x16x32_bf16 v[48:51], v[252:255], v[168:171], v[48:51]
	ds_write_b128 v27, v[108:111] offset:1024
	v_mfma_f32_16x16x32_bf16 v[52:55], v[156:159], v[168:171], v[52:55]
	ds_write_b128 v27, v[112:115] offset:2048
	v_mfma_f32_16x16x32_bf16 v[56:59], v[160:163], v[168:171], v[56:59]
	ds_write_b128 v27, v[116:119] offset:3072
	v_mfma_f32_16x16x32_bf16 v[60:63], v[164:167], v[168:171], v[60:63]
	ds_write_b128 v27, v[120:123] offset:4096
	s_mul_i32 s4, s3, 15360
	s_add_u32 s4, s4, s7
	v_add_u32 v24, s4, v12
	s_waitcnt lgkmcnt(0)
	s_barrier
	ds_read_b128 v[64:67], v24 offset:0
	ds_read_b128 v[68:71], v24 offset:1024
	ds_read_b128 v[72:75], v24 offset:2048
	ds_read_b128 v[76:79], v24 offset:3072
	ds_read_b128 v[80:83], v24 offset:4096
	ds_read_b128 v[84:87], v24 offset:5120
	ds_read_b128 v[88:91], v24 offset:6144
	ds_read_b128 v[92:95], v24 offset:7168
	ds_read_b128 v[96:99], v24 offset:8192
	ds_read_b128 v[100:103], v24 offset:9216
	ds_read_b128 v[104:107], v24 offset:10240
	ds_read_b128 v[108:111], v24 offset:11264
	ds_read_b128 v[112:115], v24 offset:12288
	ds_read_b128 v[116:119], v24 offset:13312
	ds_read_b128 v[120:123], v24 offset:14336
	s_waitcnt lgkmcnt(14)
	v_pk_add_f32 v[44:45], v[44:45], v[64:65]
	v_pk_add_f32 v[46:47], v[46:47], v[66:67]
	s_waitcnt lgkmcnt(13)
	v_pk_add_f32 v[48:49], v[48:49], v[68:69]
	v_pk_add_f32 v[50:51], v[50:51], v[70:71]
	s_waitcnt lgkmcnt(12)
	v_pk_add_f32 v[52:53], v[52:53], v[72:73]
	v_pk_add_f32 v[54:55], v[54:55], v[74:75]
	s_waitcnt lgkmcnt(11)
	v_pk_add_f32 v[56:57], v[56:57], v[76:77]
	v_pk_add_f32 v[58:59], v[58:59], v[78:79]
	s_waitcnt lgkmcnt(10)
	v_pk_add_f32 v[60:61], v[60:61], v[80:81]
	v_pk_add_f32 v[62:63], v[62:63], v[82:83]
	s_waitcnt lgkmcnt(9)
	v_pk_add_f32 v[44:45], v[44:45], v[84:85]
	v_pk_add_f32 v[46:47], v[46:47], v[86:87]
	s_waitcnt lgkmcnt(8)
	v_pk_add_f32 v[48:49], v[48:49], v[88:89]
	v_pk_add_f32 v[50:51], v[50:51], v[90:91]
	s_waitcnt lgkmcnt(7)
	v_pk_add_f32 v[52:53], v[52:53], v[92:93]
	v_pk_add_f32 v[54:55], v[54:55], v[94:95]
	s_waitcnt lgkmcnt(6)
	v_pk_add_f32 v[56:57], v[56:57], v[96:97]
	v_pk_add_f32 v[58:59], v[58:59], v[98:99]
	s_waitcnt lgkmcnt(5)
	v_pk_add_f32 v[60:61], v[60:61], v[100:101]
	v_pk_add_f32 v[62:63], v[62:63], v[102:103]
	s_waitcnt lgkmcnt(4)
	v_pk_add_f32 v[44:45], v[44:45], v[104:105]
	v_pk_add_f32 v[46:47], v[46:47], v[106:107]
	s_waitcnt lgkmcnt(3)
	v_pk_add_f32 v[48:49], v[48:49], v[108:109]
	v_pk_add_f32 v[50:51], v[50:51], v[110:111]
	s_waitcnt lgkmcnt(2)
	v_pk_add_f32 v[52:53], v[52:53], v[112:113]
	v_pk_add_f32 v[54:55], v[54:55], v[114:115]
	s_waitcnt lgkmcnt(1)
	v_pk_add_f32 v[56:57], v[56:57], v[116:117]
	v_pk_add_f32 v[58:59], v[58:59], v[118:119]
	s_waitcnt lgkmcnt(0)
	v_pk_add_f32 v[60:61], v[60:61], v[120:121]
	v_pk_add_f32 v[62:63], v[62:63], v[122:123]
	s_mul_i32 s4, s3, 3072
	s_add_u32 s4, s4, 61440
	v_mul_u32_u24 v24, 160, v3
	v_mul_u32_u24 v25, 40, v2
	v_add3_u32 v24, v24, v25, s4
	v_add_u32 v25, s4, v12
	v_cvt_pk_bf16_f32 v44, v44, v45
	v_cvt_pk_bf16_f32 v45, v46, v47
	ds_write_b64 v24, v[44:45] offset:0
	v_cvt_pk_bf16_f32 v48, v48, v49
	v_cvt_pk_bf16_f32 v49, v50, v51
	ds_write_b64 v24, v[48:49] offset:8
	v_cvt_pk_bf16_f32 v52, v52, v53
	v_cvt_pk_bf16_f32 v53, v54, v55
	ds_write_b64 v24, v[52:53] offset:16
	v_cvt_pk_bf16_f32 v56, v56, v57
	v_cvt_pk_bf16_f32 v57, v58, v59
	ds_write_b64 v24, v[56:57] offset:24
	v_cvt_pk_bf16_f32 v60, v60, v61
	v_cvt_pk_bf16_f32 v61, v62, v63
	ds_write_b64 v24, v[60:61] offset:32
	ds_read_b128 v[84:87], v25 offset:0
	ds_read_b128 v[88:91], v25 offset:1024
	ds_read_b128 v[92:95], v25 offset:2048
	s_waitcnt lgkmcnt(2)
	buffer_store_dwordx4 v[84:87], v37, s[64:67], 0 offen
	s_waitcnt lgkmcnt(1)
	buffer_store_dwordx4 v[88:91], v38, s[64:67], 0 offen
	s_waitcnt lgkmcnt(0)
	buffer_store_dwordx4 v[92:95], v39, s[64:67], 0 offen
	s_nop 1
L_fin:
L_end:
	s_endpgm
.section .rodata,"a"
.p2align 6
.amdhsa_kernel parallel_sum__linear_kernel_hedgehog__mixer_token_mlp__prompt_kernel
  .amdhsa_next_free_vgpr 256
  .amdhsa_next_free_sgpr 102
  .amdhsa_accum_offset 256
  .amdhsa_group_segment_fixed_size 0
  .amdhsa_kernarg_size 96
  .amdhsa_user_sgpr_count 2
  .amdhsa_user_sgpr_kernarg_segment_ptr 1
  .amdhsa_system_sgpr_workgroup_id_x 1
.end_amdhsa_kernel
```
